```python
import torch

def _softmax(x, axis=-1):
    return torch.softmax(x, dim=axis)
def _gelu(x):
    return torch.nn.functional.gelu(x, approximate="tanh")
def _silu(x):
    return torch.nn.functional.silu(x)
def _sigmoid(x):
    return torch.sigmoid(x)
def _layernorm(x, axis=-1, eps=1e-5):
    m = x.mean(dim=axis, keepdim=True)
    v = x.var(dim=axis, keepdim=True, unbiased=False)
    return (x - m) / torch.sqrt(v + eps)
def _scatter_add(tgt, idx, src, axis=0):
    return tgt.clone().index_add_(axis, idx, src)
def _segment_sum(src, seg, n):
    out = torch.zeros((n,) + src.shape[1:], dtype=src.dtype)
    return out.index_add_(0, seg, src)
def _pad(x, pw):
    flat = tuple(v for pair in reversed(pw) for v in pair)
    return torch.nn.functional.pad(x, flat)

kernel_name = 'interleave_layers__ssm_conv_h3__dense_activation_squared_relu__prompt'

def setup_inputs():

    _w = (lambda a: (lambda t: t.to(torch.bfloat16) if t.is_floating_point() else t)(torch.as_tensor(a)))
    def _A_setup():
        B, S, D = 1, 2048, 512
        ks = 4
        return {
            "q": _w((lambda *s: torch.randn(*s, dtype=torch.bfloat16) * 0.05)(B, S, D)),
            "k": _w((lambda *s: torch.randn(*s, dtype=torch.bfloat16) * 0.8)(B, S, D)),
            "v": _w((lambda *s: torch.randn(*s, dtype=torch.bfloat16) * 0.8)(B, S, D)),
            "shift_k": _w((lambda *s: torch.randn(*s, dtype=torch.bfloat16) * 0.8)(D, ks) * 0.5),
            "ssm_k": _w((lambda *s: torch.randn(*s, dtype=torch.bfloat16) * 0.8)(D, S) * (1.0 / S ** 0.5)),
            "ssm_D": _w((lambda *s: torch.randn(*s, dtype=torch.bfloat16) * 0.8)(D)),
        }
    _A_in = _A_setup()

    def _B_setup():
        B, S, D, F = 1, 2048, 512, 1792
        return {
            "x": _w((lambda *s: torch.randn(*s, dtype=torch.bfloat16) * 0.05)(B, S, D)),
            "w1": _w((lambda *s: torch.randn(*s, dtype=torch.bfloat16) * 0.05)(D, F)),
            "b1": _w((lambda *s: torch.randn(*s, dtype=torch.bfloat16) * 0.4)(F)),
            "w2": _w((lambda *s: torch.randn(*s, dtype=torch.bfloat16) * 0.05)(F, D)),
            "b2": _w((lambda *s: torch.randn(*s, dtype=torch.bfloat16) * 1.6)(D)),
        }
    _B_in = _B_setup()

    return {
        "A_q": _A_in["q"],
        "A_k": _A_in["k"],
        "A_v": _A_in["v"],
        "A_shift_k": _A_in["shift_k"],
        "A_ssm_k": _A_in["ssm_k"],
        "A_ssm_D": _A_in["ssm_D"],
        "B_x": _B_in["x"],
        "B_w1": _B_in["w1"],
        "B_b1": _B_in["b1"],
        "B_w2": _B_in["w2"],
        "B_b2": _B_in["b2"],
    }

def reference(A_q, A_k, A_v, A_shift_k, A_ssm_k, A_ssm_D, B_x, B_w1, B_b1, B_w2, B_b2):
    def _A_ref(q, k, v, shift_k, ssm_k, ssm_D):
        B, S, D = q.shape
        ks = shift_k.shape[-1]
        k_pad = _pad(k, ((0, 0), (ks - 1, 0), (0, 0)))
        k_shift = torch.zeros_like(k)
        for t in range(ks):
            k_shift = k_shift + k_pad[:, t:t + S, :] * shift_k[:, ks - 1 - t][None, None, :]
        kv = k_shift * v
        L = 2 * S
        kv_pad = _pad(kv, ((0, 0), (0, S), (0, 0)))
        kf_pad = _pad(ssm_k, ((0, 0), (0, S)))
        kv_f = (lambda x, axes=(-2,-1): torch.fft.rfft2(x.float(), dim=axes))(kv_pad[:, None, :, :], axes=(1, 2))
        kf_f = (lambda x, axes=(-2,-1): torch.fft.rfft2(x.float(), dim=axes))(kf_pad[:, None, :], axes=(1, 2))
        kf_f = (lambda x, *d: x.permute(*d))(kf_f, 1, 2, 0)
        y_f = kv_f * kf_f[None, :, :, :]
        y = (lambda x, s, axes=(-2,-1): torch.fft.irfft2(x, s=s, dim=axes).to(torch.bfloat16))(y_f, (1, L), axes=(1, 2))[:, 0, :S, :]
        y = y + kv * ssm_D[None, None, :]
        return q * y

    def _B_ref(x, w1, b1, w2, b2):
        h = torch.einsum("bsd,df->bsf", x, w1) + b1
        zero = torch.zeros_like(h)
        r = torch.where(h > zero, h, zero)
        h = r * r
        out = torch.einsum("bsf,fd->bsd", h, w2) + b2
        return out

    x = A_q
    x = x + _A_ref(_layernorm(x, axis=-1), A_k, A_v, A_shift_k, A_ssm_k, A_ssm_D)
    x = x + _B_ref(_layernorm(x, axis=-1), B_w1, B_b1, B_w2, B_b2)
    x = x + _A_ref(_layernorm(x, axis=-1), A_k, A_v, A_shift_k, A_ssm_k, A_ssm_D)
    x = x + _B_ref(_layernorm(x, axis=-1), B_w1, B_b1, B_w2, B_b2)
    return x
```

```asm
; @launch grid=(256,1,1) block=(256,1,1) lds=163840
.amdgcn_target "amdgcn-amd-amdhsa--gfx950"
.text
.globl interleave_layers__ssm_conv_h3__dense_activation_squared_relu__prompt_kernel
.p2align 12
.p2align 8
.type interleave_layers__ssm_conv_h3__dense_activation_squared_relu__prompt_kernel,@function
interleave_layers__ssm_conv_h3__dense_activation_squared_relu__prompt_kernel:
    s_cmp_ge_u32 s2, 256
    s_cbranch_scc1 L_end
    s_load_dwordx2 s[16:17], s[0:1], 8
    s_load_dwordx2 s[20:21], s[0:1], 16
    s_load_dwordx2 s[48:49], s[0:1], 24
    s_load_dwordx2 s[24:25], s[0:1], 32
    s_load_dwordx2 s[32:33], s[0:1], 72
    s_load_dwordx2 s[28:29], s[0:1], 56
    s_load_dwordx2 s[12:13], s[0:1], 104
    s_mov_b32 s38, 2097152
    s_mov_b32 s39, 0x20000
    s_mov_b32 s18, 2097152
    s_mov_b32 s19, 0x20000
    s_mov_b32 s22, 2097152
    s_mov_b32 s23, 0x20000
    s_mov_b32 s50, 4096
    s_mov_b32 s51, 0x20000
    s_mov_b32 s26, 2097152
    s_mov_b32 s27, 0x20000
    s_mov_b32 s30, 1835008
    s_mov_b32 s31, 0x20000
    s_mov_b32 s54, 3584
    s_mov_b32 s55, 0x20000
    s_mov_b32 s34, 1835008
    s_mov_b32 s35, 0x20000
    s_mov_b32 s58, 1024
    s_mov_b32 s59, 0x20000
    s_mov_b32 s42, 2097152
    s_mov_b32 s43, 0x20000
    s_mov_b32 s14, 6291456
    s_mov_b32 s15, 0x20000
    s_mov_b32 s46, 262144
    s_mov_b32 s47, 0x20000
    v_lshrrev_b32 v1, 6, v0
    v_and_b32 v0, 63, v0
    v_readfirstlane_b32 s3, v1
    s_and_b32 s4, s2, 7
    s_lshr_b32 s5, s2, 3
    s_and_b32 s7, s5, 7
    s_lshr_b32 s6, s5, 3
    s_lshl2_add_u32 s6, s4, s6
    s_mov_b32 s62, 0xffff0000
    s_and_b32 s99, s3, 1
    s_getreg_b32 s11, hwreg(HW_REG_XCC_ID, 0, 4)
    s_and_b32 s100, s7, 1
    s_mul_i32 s101, s7, 448
    s_lshl_b32 s64, s100, 6
    s_add_u32 s101, s101, s64
    v_cmp_ne_u32 vcc, 0, v0
    v_mov_b32 v2, 2146435072
    s_nop 0
    v_cndmask_b32 v2, 0, v2, vcc
    s_cmp_ge_u32 s3, 2
    s_nop 0
    s_cbranch_scc1 L_roleB
    v_and_b32 v3, 7, v0
    v_lshrrev_b32 v4, 3, v0
    s_lshl_b32 s64, s3, 3
    s_lshl4_add_u32 s64, s4, s64
    v_add_u32 v4, s64, v4
    s_lshl_b32 s65, s5, 6
    v_lshl_add_u32 v3, v3, 3, s65
    v_lshlrev_b32 v5, 10, v3
    v_lshl_add_u32 v5, v4, 3, v5
    v_subrev_u32 v6, 3072, v5
    v_min_u32 v6, 2146435072, v6
    v_lshlrev_b32 v7, 5, v4
    s_movk_i32 s66, 4096
    s_waitcnt lgkmcnt(0)
    buffer_load_dwordx2 v[12:13], v6, s[16:19], 0 offen offset:0
    buffer_load_dwordx2 v[14:15], v6, s[16:19], 0 offen offset:1024
    buffer_load_dwordx2 v[16:17], v6, s[16:19], 0 offen offset:2048
    buffer_load_dwordx2 v[18:19], v5, s[16:19], 0 offen offset:0
    buffer_load_dwordx4 v[50:53], v7, s[48:51], 0 offen
    buffer_load_dwordx4 v[54:57], v7, s[48:51], 0 offen offset:16
    buffer_load_dwordx2 v[34:35], v5, s[20:23], 0 offen offset:0
    buffer_load_dwordx2 v[20:21], v5, s[16:19], 0 offen offset:1024
    buffer_load_dwordx2 v[36:37], v5, s[20:23], 0 offen offset:1024
    buffer_load_dwordx2 v[22:23], v5, s[16:19], 0 offen offset:2048
    buffer_load_dwordx2 v[38:39], v5, s[20:23], 0 offen offset:2048
    buffer_load_dwordx2 v[24:25], v5, s[16:19], 0 offen offset:3072
    buffer_load_dwordx2 v[40:41], v5, s[20:23], 0 offen offset:3072
    buffer_load_dwordx2 v[26:27], v5, s[16:19], s66 offen offset:0
    buffer_load_dwordx2 v[42:43], v5, s[20:23], s66 offen offset:0
    buffer_load_dwordx2 v[28:29], v5, s[16:19], s66 offen offset:1024
    buffer_load_dwordx2 v[44:45], v5, s[20:23], s66 offen offset:1024
    buffer_load_dwordx2 v[30:31], v5, s[16:19], s66 offen offset:2048
    buffer_load_dwordx2 v[46:47], v5, s[20:23], s66 offen offset:2048
    buffer_load_dwordx2 v[32:33], v5, s[16:19], s66 offen offset:3072
    buffer_load_dwordx2 v[48:49], v5, s[20:23], s66 offen offset:3072
    v_min_u32 v10, 3, v0
    v_and_b32 v11, 1, v10
    v_lshlrev_b32 v11, 7, v11
    v_subrev_u32 v10, 1, v10
    v_max_i32 v10, 0, v10
    v_lshl_add_u32 v10, v10, 21, v11
    s_lshl_b32 s67, s4, 8
    s_add_u32 s67, s67, 4096
    buffer_load_dword v74, v10, s[12:15], s67 offen sc1
    s_load_dword s8, s[12:13], 0
    s_load_dwordx2 s[52:53], s[0:1], 64
    s_load_dwordx2 s[36:37], s[0:1], 0
    s_load_dwordx2 s[56:57], s[0:1], 80
    s_load_dwordx2 s[40:41], s[0:1], 88
    s_load_dwordx2 s[60:61], s[0:1], 40
    s_mul_i32 s76, s6, 262144
    s_add_u32 s76, s76, 6291456
    s_add_u32 s44, s12, s76
    s_addc_u32 s45, s13, 0
    s_lshl_b32 s76, s6, 16
    s_add_u32 s76, s76, 2097152
    s_add_u32 s20, s12, s76
    s_addc_u32 s21, s13, 0
    s_mov_b32 s22, 65536
    v_lshlrev_b32 v8, 14, v4
    v_sub_u32 v3, 2040, v3
    v_lshl_add_u32 v8, v3, 1, v8
    v_lshrrev_b32 v10, 2, v0
    v_bfe_u32 v11, v0, 3, 2
    v_and_b32 v112, 3, v0
    v_lshlrev_b32 v112, 3, v112
    v_lshl_add_u32 v10, v10, 7, v112
    v_xor_b32 v112, 0, v11
    v_lshl_add_u32 v112, v112, 5, v10
    v_xor_b32 v113, 1, v11
    v_lshl_add_u32 v113, v113, 5, v10
    v_xor_b32 v114, 2, v11
    v_lshl_add_u32 v114, v114, 5, v10
    v_xor_b32 v115, 3, v11
    v_lshl_add_u32 v115, v115, 5, v10
    s_lshl_b32 s77, s100, 1
    s_cmp_eq_u32 s3, 3
    s_cselect_b32 s77, s77, 0
    s_cselect_b32 s79, 3, 2
    s_cselect_b32 s65, 2, s3
    s_add_u32 s78, s77, 1
    s_lshl_b32 s64, s3, 15
    s_add_u32 s64, s64, 32768
    s_lshl_b32 s65, s65, 15
    s_add_u32 s65, s65, 32768
    v_xor_b32 v116, s77, v11
    v_lshl_add_u32 v116, v116, 5, v10
    v_add_u32 v116, s64, v116
    v_xor_b32 v117, s78, v11
    v_lshl_add_u32 v117, v117, 5, v10
    v_add_u32 v117, s64, v117
    v_xor_b32 v118, s79, v11
    v_lshl_add_u32 v118, v118, 5, v10
    v_add_u32 v118, s65, v118
    v_xor_b32 v119, 3, v11
    v_lshl_add_u32 v119, v119, 5, v10
    v_add_u32 v119, s64, v119
L_pb_1:
    s_waitcnt vmcnt(21)
    v_lshlrev_b32 v128, 16, v12
    v_and_b32 v129, s62, v12
    v_lshlrev_b32 v130, 16, v13
    v_and_b32 v131, s62, v13
    s_waitcnt vmcnt(20)
    v_lshlrev_b32 v132, 16, v14
    v_and_b32 v133, s62, v14
    v_lshlrev_b32 v134, 16, v15
    v_and_b32 v135, s62, v15
    s_waitcnt vmcnt(19)
    v_lshlrev_b32 v136, 16, v16
    v_and_b32 v137, s62, v16
    v_lshlrev_b32 v138, 16, v17
    v_and_b32 v139, s62, v17
    s_waitcnt vmcnt(18)
    v_lshlrev_b32 v140, 16, v18
    v_and_b32 v141, s62, v18
    v_lshlrev_b32 v142, 16, v19
    v_and_b32 v143, s62, v19
    s_waitcnt vmcnt(17)
    v_lshlrev_b32 v58, 16, v50
    v_and_b32 v62, s62, v50
    v_lshlrev_b32 v66, 16, v51
    v_and_b32 v70, s62, v51
    v_lshlrev_b32 v59, 16, v52
    v_and_b32 v63, s62, v52
    v_lshlrev_b32 v67, 16, v53
    v_and_b32 v71, s62, v53
    s_waitcnt vmcnt(16)
    v_lshlrev_b32 v60, 16, v54
    v_and_b32 v64, s62, v54
    v_lshlrev_b32 v68, 16, v55
    v_and_b32 v72, s62, v55
    v_lshlrev_b32 v61, 16, v56
    v_and_b32 v65, s62, v56
    v_lshlrev_b32 v69, 16, v57
    v_and_b32 v73, s62, v57
    s_waitcnt vmcnt(15)
    v_lshlrev_b32 v172, 16, v34
    v_and_b32 v173, s62, v34
    v_lshlrev_b32 v174, 16, v35
    v_and_b32 v175, s62, v35
    v_pk_mul_f32 v[204:205], v[128:129], v[70:71]
    v_pk_mul_f32 v[206:207], v[130:131], v[72:73]
    v_pk_fma_f32 v[204:205], v[132:133], v[66:67], v[204:205]
    v_pk_fma_f32 v[206:207], v[134:135], v[68:69], v[206:207]
    v_pk_fma_f32 v[204:205], v[136:137], v[62:63], v[204:205]
    v_pk_fma_f32 v[206:207], v[138:139], v[64:65], v[206:207]
    v_pk_fma_f32 v[204:205], v[140:141], v[58:59], v[204:205]
    v_pk_fma_f32 v[206:207], v[142:143], v[60:61], v[206:207]
    v_pk_mul_f32 v[204:205], v[204:205], v[172:173]
    v_pk_mul_f32 v[206:207], v[206:207], v[174:175]
    s_waitcnt vmcnt(14)
    v_lshlrev_b32 v144, 16, v20
    v_and_b32 v145, s62, v20
    v_lshlrev_b32 v146, 16, v21
    v_and_b32 v147, s62, v21
    s_waitcnt vmcnt(13)
    v_lshlrev_b32 v176, 16, v36
    v_and_b32 v177, s62, v36
    v_lshlrev_b32 v178, 16, v37
    v_and_b32 v179, s62, v37
    v_pk_mul_f32 v[208:209], v[132:133], v[70:71]
    v_pk_mul_f32 v[210:211], v[134:135], v[72:73]
    v_pk_fma_f32 v[208:209], v[136:137], v[66:67], v[208:209]
    v_pk_fma_f32 v[210:211], v[138:139], v[68:69], v[210:211]
    v_pk_fma_f32 v[208:209], v[140:141], v[62:63], v[208:209]
    v_pk_fma_f32 v[210:211], v[142:143], v[64:65], v[210:211]
    v_pk_fma_f32 v[208:209], v[144:145], v[58:59], v[208:209]
    v_pk_fma_f32 v[210:211], v[146:147], v[60:61], v[210:211]
    v_pk_mul_f32 v[208:209], v[208:209], v[176:177]
    v_pk_mul_f32 v[210:211], v[210:211], v[178:179]
    s_waitcnt vmcnt(12)
    v_lshlrev_b32 v148, 16, v22
    v_and_b32 v149, s62, v22
    v_lshlrev_b32 v150, 16, v23
    v_and_b32 v151, s62, v23
    s_waitcnt vmcnt(11)
    v_lshlrev_b32 v180, 16, v38
    v_and_b32 v181, s62, v38
    v_lshlrev_b32 v182, 16, v39
    v_and_b32 v183, s62, v39
    v_pk_mul_f32 v[212:213], v[136:137], v[70:71]
    v_pk_mul_f32 v[214:215], v[138:139], v[72:73]
    v_pk_fma_f32 v[212:213], v[140:141], v[66:67], v[212:213]
    v_pk_fma_f32 v[214:215], v[142:143], v[68:69], v[214:215]
    v_pk_fma_f32 v[212:213], v[144:145], v[62:63], v[212:213]
    v_pk_fma_f32 v[214:215], v[146:147], v[64:65], v[214:215]
    v_pk_fma_f32 v[212:213], v[148:149], v[58:59], v[212:213]
    v_pk_fma_f32 v[214:215], v[150:151], v[60:61], v[214:215]
    v_pk_mul_f32 v[212:213], v[212:213], v[180:181]
    v_pk_mul_f32 v[214:215], v[214:215], v[182:183]
    s_waitcnt vmcnt(10)
    v_lshlrev_b32 v152, 16, v24
    v_and_b32 v153, s62, v24
    v_lshlrev_b32 v154, 16, v25
    v_and_b32 v155, s62, v25
    s_waitcnt vmcnt(9)
    v_lshlrev_b32 v184, 16, v40
    v_and_b32 v185, s62, v40
    v_lshlrev_b32 v186, 16, v41
    v_and_b32 v187, s62, v41
    v_pk_mul_f32 v[216:217], v[140:141], v[70:71]
    v_pk_mul_f32 v[218:219], v[142:143], v[72:73]
    v_pk_fma_f32 v[216:217], v[144:145], v[66:67], v[216:217]
    v_pk_fma_f32 v[218:219], v[146:147], v[68:69], v[218:219]
    v_pk_fma_f32 v[216:217], v[148:149], v[62:63], v[216:217]
    v_pk_fma_f32 v[218:219], v[150:151], v[64:65], v[218:219]
    v_pk_fma_f32 v[216:217], v[152:153], v[58:59], v[216:217]
    v_pk_fma_f32 v[218:219], v[154:155], v[60:61], v[218:219]
    v_pk_mul_f32 v[216:217], v[216:217], v[184:185]
    v_pk_mul_f32 v[218:219], v[218:219], v[186:187]
    s_waitcnt vmcnt(8)
    v_lshlrev_b32 v156, 16, v26
    v_and_b32 v157, s62, v26
    v_lshlrev_b32 v158, 16, v27
    v_and_b32 v159, s62, v27
    s_waitcnt vmcnt(7)
    v_lshlrev_b32 v188, 16, v42
    v_and_b32 v189, s62, v42
    v_lshlrev_b32 v190, 16, v43
    v_and_b32 v191, s62, v43
    v_pk_mul_f32 v[220:221], v[144:145], v[70:71]
    v_pk_mul_f32 v[222:223], v[146:147], v[72:73]
    v_pk_fma_f32 v[220:221], v[148:149], v[66:67], v[220:221]
    v_pk_fma_f32 v[222:223], v[150:151], v[68:69], v[222:223]
    v_pk_fma_f32 v[220:221], v[152:153], v[62:63], v[220:221]
    v_pk_fma_f32 v[222:223], v[154:155], v[64:65], v[222:223]
    v_pk_fma_f32 v[220:221], v[156:157], v[58:59], v[220:221]
    v_pk_fma_f32 v[222:223], v[158:159], v[60:61], v[222:223]
    v_pk_mul_f32 v[220:221], v[220:221], v[188:189]
    v_pk_mul_f32 v[222:223], v[222:223], v[190:191]
    s_waitcnt vmcnt(6)
    v_lshlrev_b32 v160, 16, v28
    v_and_b32 v161, s62, v28
    v_lshlrev_b32 v162, 16, v29
    v_and_b32 v163, s62, v29
    s_waitcnt vmcnt(5)
    v_lshlrev_b32 v192, 16, v44
    v_and_b32 v193, s62, v44
    v_lshlrev_b32 v194, 16, v45
    v_and_b32 v195, s62, v45
    v_pk_mul_f32 v[224:225], v[148:149], v[70:71]
    v_pk_mul_f32 v[226:227], v[150:151], v[72:73]
    v_pk_fma_f32 v[224:225], v[152:153], v[66:67], v[224:225]
    v_pk_fma_f32 v[226:227], v[154:155], v[68:69], v[226:227]
    v_pk_fma_f32 v[224:225], v[156:157], v[62:63], v[224:225]
    v_pk_fma_f32 v[226:227], v[158:159], v[64:65], v[226:227]
    v_pk_fma_f32 v[224:225], v[160:161], v[58:59], v[224:225]
    v_pk_fma_f32 v[226:227], v[162:163], v[60:61], v[226:227]
    v_pk_mul_f32 v[224:225], v[224:225], v[192:193]
    v_pk_mul_f32 v[226:227], v[226:227], v[194:195]
    s_waitcnt vmcnt(4)
    v_lshlrev_b32 v164, 16, v30
    v_and_b32 v165, s62, v30
    v_lshlrev_b32 v166, 16, v31
    v_and_b32 v167, s62, v31
    s_waitcnt vmcnt(3)
    v_lshlrev_b32 v196, 16, v46
    v_and_b32 v197, s62, v46
    v_lshlrev_b32 v198, 16, v47
    v_and_b32 v199, s62, v47
    v_pk_mul_f32 v[228:229], v[152:153], v[70:71]
    v_pk_mul_f32 v[230:231], v[154:155], v[72:73]
    v_pk_fma_f32 v[228:229], v[156:157], v[66:67], v[228:229]
    v_pk_fma_f32 v[230:231], v[158:159], v[68:69], v[230:231]
    v_pk_fma_f32 v[228:229], v[160:161], v[62:63], v[228:229]
    v_pk_fma_f32 v[230:231], v[162:163], v[64:65], v[230:231]
    v_pk_fma_f32 v[228:229], v[164:165], v[58:59], v[228:229]
    v_pk_fma_f32 v[230:231], v[166:167], v[60:61], v[230:231]
    v_pk_mul_f32 v[228:229], v[228:229], v[196:197]
    v_pk_mul_f32 v[230:231], v[230:231], v[198:199]
    s_waitcnt vmcnt(2)
    v_lshlrev_b32 v168, 16, v32
    v_and_b32 v169, s62, v32
    v_lshlrev_b32 v170, 16, v33
    v_and_b32 v171, s62, v33
    s_waitcnt vmcnt(1)
    v_lshlrev_b32 v200, 16, v48
    v_and_b32 v201, s62, v48
    v_lshlrev_b32 v202, 16, v49
    v_and_b32 v203, s62, v49
    v_pk_mul_f32 v[232:233], v[156:157], v[70:71]
    v_pk_mul_f32 v[234:235], v[158:159], v[72:73]
    v_pk_fma_f32 v[232:233], v[160:161], v[66:67], v[232:233]
    v_pk_fma_f32 v[234:235], v[162:163], v[68:69], v[234:235]
    v_pk_fma_f32 v[232:233], v[164:165], v[62:63], v[232:233]
    v_pk_fma_f32 v[234:235], v[166:167], v[64:65], v[234:235]
    v_pk_fma_f32 v[232:233], v[168:169], v[58:59], v[232:233]
    v_pk_fma_f32 v[234:235], v[170:171], v[60:61], v[234:235]
    v_pk_mul_f32 v[232:233], v[232:233], v[200:201]
    v_pk_mul_f32 v[234:235], v[234:235], v[202:203]
    s_mov_b32 s67, 2097152
    v_cvt_pk_bf16_f32 v76, v232, v228
    v_cvt_pk_bf16_f32 v77, v224, v220
    v_cvt_pk_bf16_f32 v78, v216, v212
    v_cvt_pk_bf16_f32 v79, v208, v204
    buffer_store_dwordx4 v[76:79], v8, s[12:15], s67 offen sc1
    s_add_u32 s67, s67, 4096
    v_cvt_pk_bf16_f32 v80, v233, v229
    v_cvt_pk_bf16_f32 v81, v225, v221
    v_cvt_pk_bf16_f32 v82, v217, v213
    v_cvt_pk_bf16_f32 v83, v209, v205
    buffer_store_dwordx4 v[80:83], v8, s[12:15], s67 offen sc1
    s_add_u32 s67, s67, 4096
    v_cvt_pk_bf16_f32 v84, v234, v230
    v_cvt_pk_bf16_f32 v85, v226, v222
    v_cvt_pk_bf16_f32 v86, v218, v214
    v_cvt_pk_bf16_f32 v87, v210, v206
    buffer_store_dwordx4 v[84:87], v8, s[12:15], s67 offen sc1
    s_add_u32 s67, s67, 4096
    v_cvt_pk_bf16_f32 v88, v235, v231
    v_cvt_pk_bf16_f32 v89, v227, v223
    v_cvt_pk_bf16_f32 v90, v219, v215
    v_cvt_pk_bf16_f32 v91, v211, v207
    buffer_store_dwordx4 v[88:91], v8, s[12:15], s67 offen sc1
    s_waitcnt lgkmcnt(0)
    s_mul_i32 s8, s8, 0x9E3779B1
    s_add_u32 s8, s8, 0x7F4A7C15
    v_mov_b32 v1, s8
    v_lshrrev_b32 v10, 3, v0
    v_bfe_u32 v11, v0, 1, 2
    v_bfe_u32 v12, v0, 4, 2
    v_xor_b32 v11, v11, v12
    v_and_b32 v12, 1, v0
    v_lshlrev_b32 v12, 4, v12
    v_lshl_add_u32 v11, v11, 5, v12
    s_movk_i32 s64, 3584
    v_mad_u32_u24 v120, v10, s64, v11
    v_add_u32 v121, 27648, v120
    v_add_u32 v122, 55296, v120
    v_add_u32 v123, 82944, v120
    v_lshrrev_b32 v10, 3, v0
    v_bfe_u32 v11, v0, 1, 2
    v_bfe_u32 v12, v0, 4, 2
    v_xor_b32 v11, v11, v12
    v_and_b32 v12, 1, v0
    v_lshlrev_b32 v12, 4, v12
    v_lshl_add_u32 v11, v11, 5, v12
    s_movk_i32 s64, 1024
    v_mad_u32_u24 v124, v10, s64, v11
    v_add_u32 v125, 7168, v124
    v_add_u32 v126, 14336, v124
    v_add_u32 v127, 21504, v124
    s_barrier
    s_mul_i32 s67, s99, 8320
    s_add_u32 s67, s67, 256
    v_and_b32 v3, 15, v0
    v_lshrrev_b32 v4, 4, v0
    v_add_u32 v5, 1, v3
    v_lshrrev_b32 v6, 1, v5
    v_lshlrev_b32 v6, 2, v6
    v_lshl_add_u32 v6, v4, 4, v6
    v_and_b32 v5, 1, v5
    s_movk_i32 s69, 4160
    v_mad_u32_u24 v6, v5, s69, v6
    v_add_u32 v6, s67, v6
    ds_read2_b32 v[128:129], v6 offset0:0 offset1:1
    ds_read2_b32 v[130:131], v6 offset0:2 offset1:3
    ds_read2_b32 v[160:161], v6 offset0:16 offset1:17
    ds_read2_b32 v[162:163], v6 offset0:18 offset1:19
    ds_read2_b32 v[192:193], v6 offset0:32 offset1:33
    ds_read2_b32 v[194:195], v6 offset0:34 offset1:35
    ds_read2_b32 v[224:225], v6 offset0:48 offset1:49
    ds_read2_b32 v[226:227], v6 offset0:50 offset1:51
    ds_read2_b32 v[132:133], v6 offset0:128 offset1:129
    ds_read2_b32 v[134:135], v6 offset0:130 offset1:131
    ds_read2_b32 v[164:165], v6 offset0:144 offset1:145
    ds_read2_b32 v[166:167], v6 offset0:146 offset1:147
    ds_read2_b32 v[196:197], v6 offset0:160 offset1:161
    ds_read2_b32 v[198:199], v6 offset0:162 offset1:163
    ds_read2_b32 v[228:229], v6 offset0:176 offset1:177
    ds_read2_b32 v[230:231], v6 offset0:178 offset1:179
    v_add_u32 v6, 1024, v6
    ds_read2_b32 v[136:137], v6 offset0:0 offset1:1
    ds_read2_b32 v[138:139], v6 offset0:2 offset1:3
    ds_read2_b32 v[168:169], v6 offset0:16 offset1:17
    ds_read2_b32 v[170:171], v6 offset0:18 offset1:19
    ds_read2_b32 v[200:201], v6 offset0:32 offset1:33
    ds_read2_b32 v[202:203], v6 offset0:34 offset1:35
    ds_read2_b32 v[232:233], v6 offset0:48 offset1:49
    ds_read2_b32 v[234:235], v6 offset0:50 offset1:51
    ds_read2_b32 v[140:141], v6 offset0:128 offset1:129
    ds_read2_b32 v[142:143], v6 offset0:130 offset1:131
    ds_read2_b32 v[172:173], v6 offset0:144 offset1:145
    ds_read2_b32 v[174:175], v6 offset0:146 offset1:147
    ds_read2_b32 v[204:205], v6 offset0:160 offset1:161
    ds_read2_b32 v[206:207], v6 offset0:162 offset1:163
    ds_read2_b32 v[236:237], v6 offset0:176 offset1:177
    ds_read2_b32 v[238:239], v6 offset0:178 offset1:179
    v_add_u32 v6, 1024, v6
    ds_read2_b32 v[144:145], v6 offset0:0 offset1:1
    ds_read2_b32 v[146:147], v6 offset0:2 offset1:3
    ds_read2_b32 v[176:177], v6 offset0:16 offset1:17
    ds_read2_b32 v[178:179], v6 offset0:18 offset1:19
    ds_read2_b32 v[208:209], v6 offset0:32 offset1:33
    ds_read2_b32 v[210:211], v6 offset0:34 offset1:35
    ds_read2_b32 v[240:241], v6 offset0:48 offset1:49
    ds_read2_b32 v[242:243], v6 offset0:50 offset1:51
    ds_read2_b32 v[148:149], v6 offset0:128 offset1:129
    ds_read2_b32 v[150:151], v6 offset0:130 offset1:131
    ds_read2_b32 v[180:181], v6 offset0:144 offset1:145
    ds_read2_b32 v[182:183], v6 offset0:146 offset1:147
    ds_read2_b32 v[212:213], v6 offset0:160 offset1:161
    ds_read2_b32 v[214:215], v6 offset0:162 offset1:163
    ds_read2_b32 v[244:245], v6 offset0:176 offset1:177
    ds_read2_b32 v[246:247], v6 offset0:178 offset1:179
    v_add_u32 v6, 1024, v6
    ds_read2_b32 v[152:153], v6 offset0:0 offset1:1
    ds_read2_b32 v[154:155], v6 offset0:2 offset1:3
    ds_read2_b32 v[184:185], v6 offset0:16 offset1:17
    ds_read2_b32 v[186:187], v6 offset0:18 offset1:19
    ds_read2_b32 v[216:217], v6 offset0:32 offset1:33
    ds_read2_b32 v[218:219], v6 offset0:34 offset1:35
    ds_read2_b32 v[248:249], v6 offset0:48 offset1:49
    ds_read2_b32 v[250:251], v6 offset0:50 offset1:51
    ds_read2_b32 v[156:157], v6 offset0:128 offset1:129
    ds_read2_b32 v[158:159], v6 offset0:130 offset1:131
    ds_read2_b32 v[188:189], v6 offset0:144 offset1:145
    ds_read2_b32 v[190:191], v6 offset0:146 offset1:147
    ds_read2_b32 v[220:221], v6 offset0:160 offset1:161
    ds_read2_b32 v[222:223], v6 offset0:162 offset1:163
    ds_read2_b32 v[252:253], v6 offset0:176 offset1:177
    ds_read2_b32 v[254:255], v6 offset0:178 offset1:179
    s_mul_i32 s67, s99, 4608
    s_add_u32 s67, s67, 17376
    v_lshlrev_b32 v5, 5, v3
    v_lshlrev_b32 v8, 4, v4
    v_sub_u32 v8, v8, v5
    v_add_u32 v8, s67, v8
    v_lshlrev_b32 v7, 14, v3
    v_lshl_add_u32 v7, v4, 4, v7
    v_lshlrev_b32 v3, 4, v0
    s_lshl_b32 s64, s3, 12
    v_add_u32 v6, s64, v3
    s_lshl_b32 s64, s4, 8
    s_lshl3_add_u32 s64, s5, s64
    s_lshl2_add_u32 s64, s3, s64
    s_add_u32 s73, s64, 4096
    v_xor_b32 v5, s11, v1
L_pb_2:
    s_waitcnt vmcnt(0)
    buffer_store_dword v5, v2, s[12:15], s73 offen
    s_lshl_b32 s64, s4, 8
    s_add_u32 s64, s64, 4096
    v_lshlrev_b32 v4, 2, v0
    s_lshl_b32 s66, s4, 6
    s_lshl1_add_u32 s66, s5, s66
    s_add_u32 s66, s66, s3
    s_lshl_b32 s66, s66, 12
    s_add_u32 s66, s66, 2097152
    s_mul_i32 s65, s3, 4608
    s_add_u32 m0, s65, 16640
    s_mov_b32 s10, 0
    s_mov_b32 s9, 0
L_f1_1:
    buffer_load_dword v11, v4, s[12:15], s64 offen sc1
    s_waitcnt vmcnt(0)
    v_cmp_ne_u32 vcc, v5, v11
    s_nop 0
    s_cbranch_vccz L_f1f_2
    s_add_u32 s10, s10, 1
    s_cmp_lt_u32 s10, 40
    s_nop 0
    s_cbranch_scc1 L_f1_1
    s_cmp_lg_u32 s10, 40
    s_cbranch_scc1 L_f1w_4
    buffer_store_dword v1, v2, s[12:15], s73 offen offset:2048 sc1
L_f1w_4:
    s_sleep 8
    buffer_load_dword v11, v4, s[12:15], s64 offen offset:2048 sc1
    s_waitcnt vmcnt(0)
    v_cmp_ne_u32 vcc, v1, v11
    s_nop 0
    s_cbranch_vccz L_f1s_3
    s_cmp_lt_u32 s10, 400000
    s_nop 1
    s_cbranch_scc1 L_f1_1
L_f1s_3:
    s_mov_b32 s9, 1
L_f1f_2:
    buffer_load_dwordx4 v3, s[12:15], s66 offen offset:0 sc1 lds
    buffer_load_dwordx4 v3, s[12:15], s66 offen offset:1024 sc1 lds
    buffer_load_dwordx4 v3, s[12:15], s66 offen offset:2048 sc1 lds
    buffer_load_dwordx4 v3, s[12:15], s66 offen offset:3072 sc1 lds
    v_mov_b32 v4, 32000
    v_mov_b32 v5, s9
    ds_write_b32 v4, v5
    s_lshl_b32 s64, s4, 5
    s_add_u32 s64, s64, s5
    s_lshr_b32 s65, s64, 7
    s_and_b32 s66, s64, 1
    s_lshl1_add_u32 s65, s65, s66
    s_lshl_b32 s65, s65, 10
    s_bfe_u32 s66, s64, 0x60001
    s_lshl4_add_u32 s65, s66, s65
    s_lshl_b32 s65, s65, 2
    s_lshl_b32 s66, s3, 19
    s_add_u32 s65, s65, s66
    s_add_u32 s82, s65, 4194304
    s_lshl1_add_u32 s64, s2, s3
    s_lshl_b32 s64, s64, 2
    s_add_u32 s83, s64, 32768
    v_lshlrev_b32 v12, 12, v0
    v_cmp_gt_u32 vcc, 8, v0
    v_mov_b32 v13, 2146435072
    s_nop 0
    v_cndmask_b32 v12, v13, v12, vcc
    s_barrier
    ds_read_b64_tr_b16 a[0:1], v116 offset:0
    ds_read_b64_tr_b16 a[4:5], v116 offset:2048
    ds_read_b64_tr_b16 a[8:9], v116 offset:4096
    ds_read_b64_tr_b16 a[12:13], v116 offset:6144
    ds_read_b64_tr_b16 a[16:17], v116 offset:8192
    ds_read_b64_tr_b16 a[20:21], v116 offset:10240
    ds_read_b64_tr_b16 a[24:25], v116 offset:12288
    ds_read_b64_tr_b16 a[28:29], v116 offset:14336
    ds_read_b64_tr_b16 a[32:33], v116 offset:16384
    ds_read_b64_tr_b16 a[36:37], v116 offset:18432
    ds_read_b64_tr_b16 a[40:41], v116 offset:20480
    ds_read_b64_tr_b16 a[44:45], v116 offset:22528
    ds_read_b64_tr_b16 a[48:49], v116 offset:24576
    ds_read_b64_tr_b16 a[52:53], v116 offset:26624
    ds_read_b64_tr_b16 a[56:57], v116 offset:28672
    ds_read_b64_tr_b16 a[60:61], v116 offset:30720
    ds_read_b64_tr_b16 a[64:65], v117 offset:0
    ds_read_b64_tr_b16 a[68:69], v117 offset:2048
    ds_read_b64_tr_b16 a[72:73], v117 offset:4096
    ds_read_b64_tr_b16 a[76:77], v117 offset:6144
    ds_read_b64_tr_b16 a[80:81], v117 offset:8192
    ds_read_b64_tr_b16 a[84:85], v117 offset:10240
    ds_read_b64_tr_b16 a[88:89], v117 offset:12288
    ds_read_b64_tr_b16 a[92:93], v117 offset:14336
    ds_read_b64_tr_b16 a[96:97], v117 offset:16384
    ds_read_b64_tr_b16 a[100:101], v117 offset:18432
    ds_read_b64_tr_b16 a[104:105], v117 offset:20480
    ds_read_b64_tr_b16 a[108:109], v117 offset:22528
    ds_read_b64_tr_b16 a[112:113], v117 offset:24576
    ds_read_b64_tr_b16 a[116:117], v117 offset:26624
    ds_read_b64_tr_b16 a[120:121], v117 offset:28672
    ds_read_b64_tr_b16 a[124:125], v117 offset:30720
    ds_read_b64_tr_b16 a[128:129], v118 offset:0
    ds_read_b64_tr_b16 a[132:133], v118 offset:2048
    ds_read_b64_tr_b16 a[136:137], v118 offset:4096
    ds_read_b64_tr_b16 a[140:141], v118 offset:6144
    ds_read_b64_tr_b16 a[144:145], v118 offset:8192
    ds_read_b64_tr_b16 a[148:149], v118 offset:10240
    ds_read_b64_tr_b16 a[152:153], v118 offset:12288
    ds_read_b64_tr_b16 a[156:157], v118 offset:14336
    ds_read_b64_tr_b16 a[160:161], v118 offset:16384
    ds_read_b64_tr_b16 a[164:165], v118 offset:18432
    ds_read_b64_tr_b16 a[168:169], v118 offset:20480
    ds_read_b64_tr_b16 a[172:173], v118 offset:22528
    ds_read_b64_tr_b16 a[176:177], v118 offset:24576
    ds_read_b64_tr_b16 a[180:181], v118 offset:26624
    ds_read_b64_tr_b16 a[184:185], v118 offset:28672
    ds_read_b64_tr_b16 a[188:189], v118 offset:30720
    ds_read_b64_tr_b16 a[192:193], v119 offset:0
    ds_read_b64_tr_b16 a[196:197], v119 offset:2048
    ds_read_b64_tr_b16 a[200:201], v119 offset:4096
    ds_read_b64_tr_b16 a[204:205], v119 offset:6144
    ds_read_b64_tr_b16 a[208:209], v119 offset:8192
    ds_read_b64_tr_b16 a[212:213], v119 offset:10240
    ds_read_b64_tr_b16 a[216:217], v119 offset:12288
    ds_read_b64_tr_b16 a[220:221], v119 offset:14336
    ds_read_b64_tr_b16 a[224:225], v119 offset:16384
    ds_read_b64_tr_b16 a[228:229], v119 offset:18432
    ds_read_b64_tr_b16 a[232:233], v119 offset:20480
    ds_read_b64_tr_b16 a[236:237], v119 offset:22528
    ds_read_b64_tr_b16 a[240:241], v119 offset:24576
    ds_read_b64_tr_b16 a[244:245], v119 offset:26624
    ds_read_b64_tr_b16 a[248:249], v119 offset:28672
    ds_read_b64_tr_b16 a[252:253], v119 offset:30720
    s_cmp_lg_u32 s3, 0
    s_cbranch_scc1 L_cv1_5
L_pb_3:
    s_branch L_pbt_3
.p2align 12
L_pbt_3:
    s_waitcnt vmcnt(0)
    s_waitcnt lgkmcnt(0)
    s_barrier
    ds_read_b128 v[60:63], v8 offset:2048
    ds_read_b128 v[56:59], v8 offset:2560
    ds_read_b128 v[52:55], v8 offset:3072
    ds_read_b128 v[48:51], v8 offset:3584
    ds_read_b128 v[76:79], v8 offset:2112
    ds_read_b128 v[72:75], v8 offset:2624
    ds_read_b128 v[68:71], v8 offset:3136
    s_waitcnt lgkmcnt(6)
    v_mfma_f32_16x16x32_bf16 v[28:31], v[128:131], v[60:63], 0
    s_waitcnt lgkmcnt(5)
    v_mfma_f32_16x16x32_bf16 v[24:27], v[128:131], v[56:59], 0
    ds_read_b128 v[64:67], v8 offset:3648
    v_mfma_f32_16x16x32_bf16 v[28:31], v[132:135], v[56:59], v[28:31]
    s_waitcnt lgkmcnt(5)
    v_mfma_f32_16x16x32_bf16 v[20:23], v[128:131], v[52:55], 0
    v_mfma_f32_16x16x32_bf16 v[24:27], v[132:135], v[52:55], v[24:27]
    v_mfma_f32_16x16x32_bf16 v[28:31], v[136:139], v[52:55], v[28:31]
    ds_read_b128 v[60:63], v8 offset:2176
    s_waitcnt lgkmcnt(5)
    v_mfma_f32_16x16x32_bf16 v[16:19], v[128:131], v[48:51], 0
    ds_read_b128 v[56:59], v8 offset:2688
    v_mfma_f32_16x16x32_bf16 v[20:23], v[132:135], v[48:51], v[20:23]
    v_mfma_f32_16x16x32_bf16 v[24:27], v[136:139], v[48:51], v[24:27]
    ds_read_b128 v[52:55], v8 offset:3200
    v_mfma_f32_16x16x32_bf16 v[28:31], v[140:143], v[48:51], v[28:31]
    s_waitcnt lgkmcnt(6)
    v_mfma_f32_16x16x32_bf16 v[28:31], v[160:163], v[76:79], v[28:31]
    s_waitcnt lgkmcnt(5)
    v_mfma_f32_16x16x32_bf16 v[24:27], v[160:163], v[72:75], v[24:27]
    ds_read_b128 v[48:51], v8 offset:3712
    v_mfma_f32_16x16x32_bf16 v[28:31], v[164:167], v[72:75], v[28:31]
    s_waitcnt lgkmcnt(5)
    v_mfma_f32_16x16x32_bf16 v[20:23], v[160:163], v[68:71], v[20:23]
    v_mfma_f32_16x16x32_bf16 v[24:27], v[164:167], v[68:71], v[24:27]
    v_mfma_f32_16x16x32_bf16 v[28:31], v[168:171], v[68:71], v[28:31]
    ds_read_b128 v[76:79], v8 offset:2240
    s_waitcnt lgkmcnt(5)
    v_mfma_f32_16x16x32_bf16 v[16:19], v[160:163], v[64:67], v[16:19]
    ds_read_b128 v[72:75], v8 offset:2752
    v_mfma_f32_16x16x32_bf16 v[20:23], v[164:167], v[64:67], v[20:23]
    v_mfma_f32_16x16x32_bf16 v[24:27], v[168:171], v[64:67], v[24:27]
    ds_read_b128 v[68:71], v8 offset:3264
    v_mfma_f32_16x16x32_bf16 v[28:31], v[172:175], v[64:67], v[28:31]
    s_waitcnt lgkmcnt(6)
    v_mfma_f32_16x16x32_bf16 v[28:31], v[192:195], v[60:63], v[28:31]
    s_waitcnt lgkmcnt(5)
    v_mfma_f32_16x16x32_bf16 v[24:27], v[192:195], v[56:59], v[24:27]
    ds_read_b128 v[64:67], v8 offset:3776
    v_mfma_f32_16x16x32_bf16 v[28:31], v[196:199], v[56:59], v[28:31]
    s_waitcnt lgkmcnt(5)
    v_mfma_f32_16x16x32_bf16 v[20:23], v[192:195], v[52:55], v[20:23]
    v_mfma_f32_16x16x32_bf16 v[24:27], v[196:199], v[52:55], v[24:27]
    v_mfma_f32_16x16x32_bf16 v[28:31], v[200:203], v[52:55], v[28:31]
    s_waitcnt lgkmcnt(4)
    v_mfma_f32_16x16x32_bf16 v[16:19], v[192:195], v[48:51], v[16:19]
    v_mfma_f32_16x16x32_bf16 v[20:23], v[196:199], v[48:51], v[20:23]
    v_mfma_f32_16x16x32_bf16 v[24:27], v[200:203], v[48:51], v[24:27]
    v_mfma_f32_16x16x32_bf16 v[28:31], v[204:207], v[48:51], v[28:31]
    ds_read_b128 v[48:51], v8 offset:3584
    ds_read_b128 v[52:55], v8 offset:3072
    s_waitcnt lgkmcnt(5)
    v_mfma_f32_16x16x32_bf16 v[28:31], v[224:227], v[76:79], v[28:31]
    s_waitcnt lgkmcnt(4)
    v_mfma_f32_16x16x32_bf16 v[24:27], v[224:227], v[72:75], v[24:27]
    v_mfma_f32_16x16x32_bf16 v[28:31], v[228:231], v[72:75], v[28:31]
    s_waitcnt lgkmcnt(3)
    v_mfma_f32_16x16x32_bf16 v[20:23], v[224:227], v[68:71], v[20:23]
    ds_read_b128 v[56:59], v8 offset:2560
    v_mfma_f32_16x16x32_bf16 v[24:27], v[228:231], v[68:71], v[24:27]
    v_mfma_f32_16x16x32_bf16 v[28:31], v[232:235], v[68:71], v[28:31]
    s_waitcnt lgkmcnt(3)
    v_mfma_f32_16x16x32_bf16 v[16:19], v[224:227], v[64:67], v[16:19]
    v_mfma_f32_16x16x32_bf16 v[20:23], v[228:231], v[64:67], v[20:23]
    ds_read_b128 v[60:63], v8 offset:2048
    v_mfma_f32_16x16x32_bf16 v[24:27], v[232:235], v[64:67], v[24:27]
    v_mfma_f32_16x16x32_bf16 v[28:31], v[236:239], v[64:67], v[28:31]
    s_waitcnt lgkmcnt(3)
    v_mfma_f32_16x16x32_bf16 v[32:35], v[144:147], v[48:51], 0
    v_mfma_f32_16x16x32_bf16 v[36:39], v[148:151], v[48:51], 0
    ds_read_b128 v[76:79], v8 offset:0
    v_mfma_f32_16x16x32_bf16 v[40:43], v[152:155], v[48:51], 0
    ds_read_b128 v[72:75], v8 offset:512
    s_nop 0
    ds_write_b128 v6, v[24:27] offset:2048
    v_mfma_f32_16x16x32_bf16 v[44:47], v[156:159], v[48:51], 0
    ds_write_b128 v6, v[28:31] offset:3072
    s_waitcnt lgkmcnt(6)
    v_mfma_f32_16x16x32_bf16 v[32:35], v[140:143], v[52:55], v[32:35]
    ds_read_b128 v[68:71], v8 offset:1024
    v_mfma_f32_16x16x32_bf16 v[36:39], v[144:147], v[52:55], v[36:39]
    v_mfma_f32_16x16x32_bf16 v[40:43], v[148:151], v[52:55], v[40:43]
    s_waitcnt lgkmcnt(0)
    s_barrier
    ds_read_b128 v[80:83], v3 offset:8192
    v_mfma_f32_16x16x32_bf16 v[44:47], v[152:155], v[52:55], v[44:47]
    ds_read_b128 v[64:67], v8 offset:1536
    v_mfma_f32_16x16x32_bf16 v[32:35], v[136:139], v[56:59], v[32:35]
    ds_read_b128 v[84:87], v3 offset:4096
    v_mfma_f32_16x16x32_bf16 v[36:39], v[140:143], v[56:59], v[36:39]
    ds_read_b128 v[88:91], v3 offset:12288
    v_mfma_f32_16x16x32_bf16 v[40:43], v[144:147], v[56:59], v[40:43]
    ds_read_b128 v[92:95], v3 offset:9216
    v_mfma_f32_16x16x32_bf16 v[44:47], v[148:151], v[56:59], v[44:47]
    ds_read_b128 v[96:99], v3 offset:5120
    v_mfma_f32_16x16x32_bf16 v[32:35], v[132:135], v[60:63], v[32:35]
    ds_read_b128 v[100:103], v3 offset:13312
    v_mfma_f32_16x16x32_bf16 v[36:39], v[136:139], v[60:63], v[36:39]
    v_mfma_f32_16x16x32_bf16 v[40:43], v[140:143], v[60:63], v[40:43]
    v_mfma_f32_16x16x32_bf16 v[44:47], v[144:147], v[60:63], v[44:47]
    v_mfma_f32_16x16x32_bf16 v[44:47], v[128:131], v[76:79], v[44:47]
    ds_read_b128 v[76:79], v8 offset:64
    v_mfma_f32_16x16x32_bf16 v[40:43], v[128:131], v[72:75], v[40:43]
    s_waitcnt lgkmcnt(7)
    v_add_f32 v80, v80, v16
    v_mfma_f32_16x16x32_bf16 v[44:47], v[132:135], v[72:75], v[44:47]
    ds_read_b128 v[72:75], v8 offset:576
    v_mfma_f32_16x16x32_bf16 v[36:39], v[128:131], v[68:71], v[36:39]
    s_waitcnt lgkmcnt(5)
    v_add_f32 v84, v84, v88
    v_add_f32 v81, v81, v17
    v_mfma_f32_16x16x32_bf16 v[40:43], v[132:135], v[68:71], v[40:43]
    v_add_f32 v85, v85, v89
    v_add_f32 v82, v82, v18
    v_mfma_f32_16x16x32_bf16 v[44:47], v[136:139], v[68:71], v[44:47]
    v_add_f32 v86, v86, v90
    v_add_f32 v83, v83, v19
    v_add_f32 v87, v87, v91
    v_cvt_pk_bf16_f32 v88, v80, v84
    v_cvt_pk_bf16_f32 v89, v81, v85
    v_cvt_pk_bf16_f32 v90, v82, v86
    v_cvt_pk_bf16_f32 v91, v83, v87
    buffer_store_dwordx4 v[88:91], v7, s[12:15], s82 offen sc1
    s_add_u32 s82, s82, 262144
    s_waitcnt lgkmcnt(4)
    v_add_f32 v92, v92, v20
    s_waitcnt lgkmcnt(2)
    v_add_f32 v96, v96, v100
    v_add_f32 v93, v93, v21
    v_add_f32 v97, v97, v101
    v_add_f32 v94, v94, v22
    v_add_f32 v98, v98, v102
    v_add_f32 v95, v95, v23
    v_add_f32 v99, v99, v103
    v_cvt_pk_bf16_f32 v100, v92, v96
    v_cvt_pk_bf16_f32 v101, v93, v97
    v_cvt_pk_bf16_f32 v102, v94, v98
    v_cvt_pk_bf16_f32 v103, v95, v99
    buffer_store_dwordx4 v[100:103], v7, s[12:15], s82 offen sc1
    s_add_u32 s82, s82, 786432
    s_waitcnt lgkmcnt(0)
    s_barrier
    ds_read_b128 v[68:71], v8 offset:1088
    ds_read_b128 v[60:63], v8 offset:2112
    v_mfma_f32_16x16x32_bf16 v[32:35], v[128:131], v[64:67], v[32:35]
    s_lshl_b32 s64, s3, 7
    s_lshl_b32 s65, s100, 9
    s_sub_u32 s65, 384, s65
    s_cmp_eq_u32 s3, 3
    s_cselect_b32 s64, s65, s64
    s_add_u32 s64, s64, s101
    v_lshrrev_b32 v10, 4, v0
    v_lshlrev_b32 v10, 3, v10
    buffer_load_dwordx2 v[104:105], v10, s[52:55], s64 offen offset:0
    buffer_load_dwordx2 v[106:107], v10, s[52:55], s64 offen offset:32
    buffer_load_dwordx2 v[108:109], v10, s[52:55], s64 offen offset:64
    buffer_load_dwordx2 v[110:111], v10, s[52:55], s64 offen offset:96
    v_mfma_f32_16x16x32_bf16 v[36:39], v[132:135], v[64:67], v[36:39]
    v_mfma_f32_16x16x32_bf16 v[40:43], v[136:139], v[64:67], v[40:43]
    v_mfma_f32_16x16x32_bf16 v[44:47], v[140:143], v[64:67], v[44:47]
    ds_read_b128 v[64:67], v8 offset:1600
    ds_read_b128 v[56:59], v8 offset:2624
    v_mfma_f32_16x16x32_bf16 v[44:47], v[160:163], v[76:79], v[44:47]
    v_mfma_f32_16x16x32_bf16 v[40:43], v[160:163], v[72:75], v[40:43]
    v_mfma_f32_16x16x32_bf16 v[44:47], v[164:167], v[72:75], v[44:47]
    s_waitcnt lgkmcnt(3)
    v_mfma_f32_16x16x32_bf16 v[36:39], v[160:163], v[68:71], v[36:39]
    ds_read_b128 v[52:55], v8 offset:3136
    v_mfma_f32_16x16x32_bf16 v[40:43], v[164:167], v[68:71], v[40:43]
    v_mfma_f32_16x16x32_bf16 v[44:47], v[168:171], v[68:71], v[44:47]
    s_waitcnt lgkmcnt(2)
    v_mfma_f32_16x16x32_bf16 v[32:35], v[160:163], v[64:67], v[32:35]
    v_mfma_f32_16x16x32_bf16 v[36:39], v[164:167], v[64:67], v[36:39]
    ds_read_b128 v[48:51], v8 offset:3648
    v_mfma_f32_16x16x32_bf16 v[40:43], v[168:171], v[64:67], v[40:43]
    v_mfma_f32_16x16x32_bf16 v[44:47], v[172:175], v[64:67], v[44:47]
    v_mfma_f32_16x16x32_bf16 v[32:35], v[164:167], v[60:63], v[32:35]
    v_mfma_f32_16x16x32_bf16 v[36:39], v[168:171], v[60:63], v[36:39]
    ds_read_b128 v[76:79], v8 offset:128
    v_mfma_f32_16x16x32_bf16 v[40:43], v[172:175], v[60:63], v[40:43]
    ds_read_b128 v[72:75], v8 offset:640
    v_mfma_f32_16x16x32_bf16 v[44:47], v[176:179], v[60:63], v[44:47]
    s_waitcnt lgkmcnt(4)
    v_mfma_f32_16x16x32_bf16 v[32:35], v[168:171], v[56:59], v[32:35]
    ds_read_b128 v[68:71], v8 offset:1152
    v_mfma_f32_16x16x32_bf16 v[36:39], v[172:175], v[56:59], v[36:39]
    v_mfma_f32_16x16x32_bf16 v[40:43], v[176:179], v[56:59], v[40:43]
    v_mfma_f32_16x16x32_bf16 v[44:47], v[180:183], v[56:59], v[44:47]
    ds_read_b128 v[64:67], v8 offset:1664
    s_waitcnt lgkmcnt(5)
    v_mfma_f32_16x16x32_bf16 v[32:35], v[172:175], v[52:55], v[32:35]
    v_mfma_f32_16x16x32_bf16 v[36:39], v[176:179], v[52:55], v[36:39]
    v_mfma_f32_16x16x32_bf16 v[40:43], v[180:183], v[52:55], v[40:43]
    v_mfma_f32_16x16x32_bf16 v[44:47], v[184:187], v[52:55], v[44:47]
    ds_read_b128 v[60:63], v8 offset:2176
    s_waitcnt lgkmcnt(5)
    v_mfma_f32_16x16x32_bf16 v[32:35], v[176:179], v[48:51], v[32:35]
    v_mfma_f32_16x16x32_bf16 v[36:39], v[180:183], v[48:51], v[36:39]
    v_mfma_f32_16x16x32_bf16 v[40:43], v[184:187], v[48:51], v[40:43]
    v_mfma_f32_16x16x32_bf16 v[44:47], v[188:191], v[48:51], v[44:47]
    ds_read_b128 v[56:59], v8 offset:2688
    s_waitcnt lgkmcnt(5)
    v_mfma_f32_16x16x32_bf16 v[44:47], v[192:195], v[76:79], v[44:47]
    s_lshl_b32 s92, s3, 7
    s_lshl_b32 s70, s100, 9
    s_sub_u32 s70, 384, s70
    s_cmp_eq_u32 s3, 3
    s_cselect_b32 s92, s70, s92
    s_add_u32 s92, s92, s101
    s_waitcnt lgkmcnt(4)
    v_mfma_f32_16x16x32_bf16 v[40:43], v[192:195], v[72:75], v[40:43]
    s_add_u32 s92, s92, 917504
    s_lshl_b32 s93, s3, 15
    s_add_u32 s93, s93, 32768
    v_mfma_f32_16x16x32_bf16 v[44:47], v[196:199], v[72:75], v[44:47]
    s_lshl_b32 s91, s6, 1
    s_and_b32 s91, s91, 7
    s_waitcnt lgkmcnt(3)
    v_mfma_f32_16x16x32_bf16 v[36:39], v[192:195], v[68:71], v[36:39]
    ds_read_b128 v[52:55], v8 offset:3200
    s_lshl_b32 s70, s91, 12
    v_mfma_f32_16x16x32_bf16 v[40:43], v[196:199], v[68:71], v[40:43]
    s_add_u32 m0, s70, s93
    s_mul_i32 s70, s91, 114688
    s_add_u32 s70, s70, s92
    v_mfma_f32_16x16x32_bf16 v[44:47], v[200:203], v[68:71], v[44:47]
    s_add_u32 s91, s91, 1
    buffer_load_dwordx4 v120, s[28:31], s70 offen offset:0 lds
    s_waitcnt lgkmcnt(3)
    v_mfma_f32_16x16x32_bf16 v[32:35], v[192:195], v[64:67], v[32:35]
    buffer_load_dwordx4 v121, s[28:31], s70 offen offset:1024 lds
    v_mfma_f32_16x16x32_bf16 v[36:39], v[196:199], v[64:67], v[36:39]
    ds_read_b128 v[48:51], v8 offset:3712
    buffer_load_dwordx4 v122, s[28:31], s70 offen offset:2048 lds
    v_mfma_f32_16x16x32_bf16 v[40:43], v[200:203], v[64:67], v[40:43]
    buffer_load_dwordx4 v123, s[28:31], s70 offen offset:3072 lds
    v_mfma_f32_16x16x32_bf16 v[44:47], v[204:207], v[64:67], v[44:47]
    s_and_b32 s91, s91, 7
    s_lshl_b32 s70, s91, 12
    s_waitcnt lgkmcnt(3)
    v_mfma_f32_16x16x32_bf16 v[32:35], v[196:199], v[60:63], v[32:35]
    s_add_u32 m0, s70, s93
    s_mul_i32 s70, s91, 114688
    s_add_u32 s70, s70, s92
    v_mfma_f32_16x16x32_bf16 v[36:39], v[200:203], v[60:63], v[36:39]
    ds_read_b128 v[76:79], v8 offset:192
    s_waitcnt vmcnt(8)
    buffer_store_dword v1, v12, s[12:15], s83 offen sc1
    v_mfma_f32_16x16x32_bf16 v[40:43], v[204:207], v[60:63], v[40:43]
    ds_read_b128 v[72:75], v8 offset:704
    s_add_u32 s91, s91, 1
    v_mfma_f32_16x16x32_bf16 v[44:47], v[208:211], v[60:63], v[44:47]
    buffer_load_dwordx4 v120, s[28:31], s70 offen offset:0 lds
    s_waitcnt lgkmcnt(4)
    v_mfma_f32_16x16x32_bf16 v[32:35], v[200:203], v[56:59], v[32:35]
    ds_read_b128 v[68:71], v8 offset:1216
    buffer_load_dwordx4 v121, s[28:31], s70 offen offset:1024 lds
    v_mfma_f32_16x16x32_bf16 v[36:39], v[204:207], v[56:59], v[36:39]
    buffer_load_dwordx4 v122, s[28:31], s70 offen offset:2048 lds
    v_mfma_f32_16x16x32_bf16 v[40:43], v[208:211], v[56:59], v[40:43]
    buffer_load_dwordx4 v123, s[28:31], s70 offen offset:3072 lds
    v_mfma_f32_16x16x32_bf16 v[44:47], v[212:215], v[56:59], v[44:47]
    ds_read_b128 v[64:67], v8 offset:1728
    s_waitcnt lgkmcnt(5)
    v_mfma_f32_16x16x32_bf16 v[32:35], v[204:207], v[52:55], v[32:35]
    s_and_b32 s91, s91, 7
    s_lshl_b32 s70, s91, 12
    s_add_u32 m0, s70, s93
    v_mfma_f32_16x16x32_bf16 v[36:39], v[208:211], v[52:55], v[36:39]
    s_mul_i32 s70, s91, 114688
    s_add_u32 s70, s70, s92
    s_add_u32 s91, s91, 1
    v_mfma_f32_16x16x32_bf16 v[40:43], v[212:215], v[52:55], v[40:43]
    buffer_load_dwordx4 v120, s[28:31], s70 offen offset:0 lds
    v_mfma_f32_16x16x32_bf16 v[44:47], v[216:219], v[52:55], v[44:47]
    ds_read_b128 v[60:63], v8 offset:2240
    s_waitcnt lgkmcnt(5)
    v_mfma_f32_16x16x32_bf16 v[32:35], v[208:211], v[48:51], v[32:35]
    buffer_load_dwordx4 v121, s[28:31], s70 offen offset:1024 lds
    v_mfma_f32_16x16x32_bf16 v[36:39], v[212:215], v[48:51], v[36:39]
    buffer_load_dwordx4 v122, s[28:31], s70 offen offset:2048 lds
    v_mfma_f32_16x16x32_bf16 v[40:43], v[216:219], v[48:51], v[40:43]
    buffer_load_dwordx4 v123, s[28:31], s70 offen offset:3072 lds
    v_mfma_f32_16x16x32_bf16 v[44:47], v[220:223], v[48:51], v[44:47]
    ds_read_b128 v[56:59], v8 offset:2752
    s_waitcnt lgkmcnt(5)
    v_mfma_f32_16x16x32_bf16 v[44:47], v[224:227], v[76:79], v[44:47]
    s_and_b32 s91, s91, 7
    s_lshl_b32 s70, s91, 12
    s_waitcnt lgkmcnt(4)
    v_mfma_f32_16x16x32_bf16 v[40:43], v[224:227], v[72:75], v[40:43]
    s_add_u32 m0, s70, s93
    s_mul_i32 s70, s91, 114688
    s_add_u32 s70, s70, s92
    v_mfma_f32_16x16x32_bf16 v[44:47], v[228:231], v[72:75], v[44:47]
    s_add_u32 s91, s91, 1
    buffer_load_dwordx4 v120, s[28:31], s70 offen offset:0 lds
    s_waitcnt lgkmcnt(3)
    v_mfma_f32_16x16x32_bf16 v[36:39], v[224:227], v[68:71], v[36:39]
    ds_read_b128 v[52:55], v8 offset:3264
    buffer_load_dwordx4 v121, s[28:31], s70 offen offset:1024 lds
    v_mfma_f32_16x16x32_bf16 v[40:43], v[228:231], v[68:71], v[40:43]
    buffer_load_dwordx4 v122, s[28:31], s70 offen offset:2048 lds
    v_mfma_f32_16x16x32_bf16 v[44:47], v[232:235], v[68:71], v[44:47]
    buffer_load_dwordx4 v123, s[28:31], s70 offen offset:3072 lds
    s_waitcnt lgkmcnt(3)
    v_mfma_f32_16x16x32_bf16 v[32:35], v[224:227], v[64:67], v[32:35]
    s_and_b32 s91, s91, 7
    s_lshl_b32 s70, s91, 12
    s_add_u32 m0, s70, s93
    v_mfma_f32_16x16x32_bf16 v[36:39], v[228:231], v[64:67], v[36:39]
    ds_read_b128 v[48:51], v8 offset:3776
    s_mul_i32 s70, s91, 114688
    v_mfma_f32_16x16x32_bf16 v[40:43], v[232:235], v[64:67], v[40:43]
    s_add_u32 s70, s70, s92
    s_add_u32 s91, s91, 1
    buffer_load_dwordx4 v120, s[28:31], s70 offen offset:0 lds
    v_mfma_f32_16x16x32_bf16 v[44:47], v[236:239], v[64:67], v[44:47]
    buffer_load_dwordx4 v121, s[28:31], s70 offen offset:1024 lds
    s_waitcnt lgkmcnt(3)
    v_mfma_f32_16x16x32_bf16 v[32:35], v[228:231], v[60:63], v[32:35]
    buffer_load_dwordx4 v122, s[28:31], s70 offen offset:2048 lds
    v_mfma_f32_16x16x32_bf16 v[36:39], v[232:235], v[60:63], v[36:39]
    buffer_load_dwordx4 v123, s[28:31], s70 offen offset:3072 lds
    v_mfma_f32_16x16x32_bf16 v[40:43], v[236:239], v[60:63], v[40:43]
    s_and_b32 s91, s91, 7
    s_lshl_b32 s70, s91, 12
    s_add_u32 m0, s70, s93
    v_mfma_f32_16x16x32_bf16 v[44:47], v[240:243], v[60:63], v[44:47]
    s_mul_i32 s70, s91, 114688
    s_add_u32 s70, s70, s92
    s_waitcnt lgkmcnt(2)
    v_mfma_f32_16x16x32_bf16 v[32:35], v[232:235], v[56:59], v[32:35]
    s_add_u32 s91, s91, 1
    buffer_load_dwordx4 v120, s[28:31], s70 offen offset:0 lds
    v_mfma_f32_16x16x32_bf16 v[36:39], v[236:239], v[56:59], v[36:39]
    buffer_load_dwordx4 v121, s[28:31], s70 offen offset:1024 lds
    v_mfma_f32_16x16x32_bf16 v[40:43], v[240:243], v[56:59], v[40:43]
    buffer_load_dwordx4 v122, s[28:31], s70 offen offset:2048 lds
    v_mfma_f32_16x16x32_bf16 v[44:47], v[244:247], v[56:59], v[44:47]
    buffer_load_dwordx4 v123, s[28:31], s70 offen offset:3072 lds
    s_waitcnt lgkmcnt(1)
    v_mfma_f32_16x16x32_bf16 v[32:35], v[236:239], v[52:55], v[32:35]
    s_and_b32 s91, s91, 7
    s_lshl_b32 s70, s91, 12
    s_add_u32 m0, s70, s93
    v_mfma_f32_16x16x32_bf16 v[36:39], v[240:243], v[52:55], v[36:39]
    s_mul_i32 s70, s91, 114688
    s_add_u32 s70, s70, s92
    s_add_u32 s91, s91, 1
    v_mfma_f32_16x16x32_bf16 v[40:43], v[244:247], v[52:55], v[40:43]
    buffer_load_dwordx4 v120, s[28:31], s70 offen offset:0 lds
    v_mfma_f32_16x16x32_bf16 v[44:47], v[248:251], v[52:55], v[44:47]
    buffer_load_dwordx4 v121, s[28:31], s70 offen offset:1024 lds
    s_waitcnt lgkmcnt(0)
    v_mfma_f32_16x16x32_bf16 v[32:35], v[240:243], v[48:51], v[32:35]
    buffer_load_dwordx4 v122, s[28:31], s70 offen offset:2048 lds
    v_mfma_f32_16x16x32_bf16 v[36:39], v[244:247], v[48:51], v[36:39]
    buffer_load_dwordx4 v123, s[28:31], s70 offen offset:3072 lds
    v_mfma_f32_16x16x32_bf16 v[40:43], v[248:251], v[48:51], v[40:43]
    s_and_b32 s91, s91, 7
    s_lshl_b32 s70, s91, 12
    s_add_u32 m0, s70, s93
    v_mfma_f32_16x16x32_bf16 v[44:47], v[252:255], v[48:51], v[44:47]
    s_nop 3
    ds_write_b128 v6, v[40:43] offset:2048
    s_nop 2
    ds_write_b128 v6, v[44:47] offset:3072
    s_waitcnt lgkmcnt(0)
    s_barrier
    ds_read_b128 v[80:83], v3 offset:8192
    ds_read_b128 v[84:87], v3 offset:4096
    ds_read_b128 v[88:91], v3 offset:12288
    ds_read_b128 v[92:95], v3 offset:9216
    ds_read_b128 v[96:99], v3 offset:5120
    ds_read_b128 v[100:103], v3 offset:13312
    s_waitcnt lgkmcnt(5)
    v_add_f32 v80, v80, v32
    s_waitcnt lgkmcnt(3)
    v_add_f32 v84, v84, v88
    v_add_f32 v81, v81, v33
    v_add_f32 v85, v85, v89
    v_add_f32 v82, v82, v34
    v_add_f32 v86, v86, v90
    v_add_f32 v83, v83, v35
    v_add_f32 v87, v87, v91
    v_cvt_pk_bf16_f32 v88, v80, v84
    v_cvt_pk_bf16_f32 v89, v81, v85
    v_cvt_pk_bf16_f32 v90, v82, v86
    v_cvt_pk_bf16_f32 v91, v83, v87
    buffer_store_dwordx4 v[88:91], v7, s[12:15], s82 offen sc1
    s_add_u32 s82, s82, 262144
    s_waitcnt lgkmcnt(2)
    v_add_f32 v92, v92, v36
    s_waitcnt lgkmcnt(0)
    v_add_f32 v96, v96, v100
    v_add_f32 v93, v93, v37
    v_add_f32 v97, v97, v101
    v_add_f32 v94, v94, v38
    v_add_f32 v98, v98, v102
    v_add_f32 v95, v95, v39
    v_add_f32 v99, v99, v103
    v_cvt_pk_bf16_f32 v100, v92, v96
    v_cvt_pk_bf16_f32 v101, v93, v97
    v_cvt_pk_bf16_f32 v102, v94, v98
    v_cvt_pk_bf16_f32 v103, v95, v99
    buffer_store_dwordx4 v[100:103], v7, s[12:15], s82 offen sc1
    s_add_u32 s82, s82, 786432
    s_barrier
    s_mul_i32 s70, s91, 114688
    s_add_u32 s70, s70, s92
    s_add_u32 s91, s91, 1
    buffer_load_dwordx4 v120, s[28:31], s70 offen offset:0 lds
    buffer_load_dwordx4 v121, s[28:31], s70 offen offset:1024 lds
    buffer_load_dwordx4 v122, s[28:31], s70 offen offset:2048 lds
    buffer_load_dwordx4 v123, s[28:31], s70 offen offset:3072 lds
L_pb_4:
    s_waitcnt vmcnt(4)
    buffer_store_dword v1, v12, s[12:15], s83 offen offset:2048 sc1
    s_waitcnt vmcnt(1)
    ds_read_b64_tr_b16 a[2:3], v116 offset:0
    ds_read_b64_tr_b16 a[6:7], v116 offset:2048
    ds_read_b64_tr_b16 a[10:11], v116 offset:4096
    ds_read_b64_tr_b16 a[14:15], v116 offset:6144
    ds_read_b64_tr_b16 a[18:19], v116 offset:8192
    ds_read_b64_tr_b16 a[22:23], v116 offset:10240
    ds_read_b64_tr_b16 a[26:27], v116 offset:12288
    ds_read_b64_tr_b16 a[30:31], v116 offset:14336
    ds_read_b64_tr_b16 a[34:35], v116 offset:16384
    ds_read_b64_tr_b16 a[38:39], v116 offset:18432
    ds_read_b64_tr_b16 a[42:43], v116 offset:20480
    ds_read_b64_tr_b16 a[46:47], v116 offset:22528
    ds_read_b64_tr_b16 a[50:51], v116 offset:24576
    ds_read_b64_tr_b16 a[54:55], v116 offset:26624
    ds_read_b64_tr_b16 a[58:59], v116 offset:28672
    ds_read_b64_tr_b16 a[62:63], v116 offset:30720
    ds_read_b64_tr_b16 a[66:67], v117 offset:0
    ds_read_b64_tr_b16 a[70:71], v117 offset:2048
    ds_read_b64_tr_b16 a[74:75], v117 offset:4096
    ds_read_b64_tr_b16 a[78:79], v117 offset:6144
    ds_read_b64_tr_b16 a[82:83], v117 offset:8192
    ds_read_b64_tr_b16 a[86:87], v117 offset:10240
    ds_read_b64_tr_b16 a[90:91], v117 offset:12288
    ds_read_b64_tr_b16 a[94:95], v117 offset:14336
    ds_read_b64_tr_b16 a[98:99], v117 offset:16384
    ds_read_b64_tr_b16 a[102:103], v117 offset:18432
    ds_read_b64_tr_b16 a[106:107], v117 offset:20480
    ds_read_b64_tr_b16 a[110:111], v117 offset:22528
    ds_read_b64_tr_b16 a[114:115], v117 offset:24576
    ds_read_b64_tr_b16 a[118:119], v117 offset:26624
    ds_read_b64_tr_b16 a[122:123], v117 offset:28672
    ds_read_b64_tr_b16 a[126:127], v117 offset:30720
    ds_read_b64_tr_b16 a[130:131], v118 offset:0
    ds_read_b64_tr_b16 a[134:135], v118 offset:2048
    ds_read_b64_tr_b16 a[138:139], v118 offset:4096
    ds_read_b64_tr_b16 a[142:143], v118 offset:6144
    ds_read_b64_tr_b16 a[146:147], v118 offset:8192
    ds_read_b64_tr_b16 a[150:151], v118 offset:10240
    ds_read_b64_tr_b16 a[154:155], v118 offset:12288
    ds_read_b64_tr_b16 a[158:159], v118 offset:14336
    ds_read_b64_tr_b16 a[162:163], v118 offset:16384
    ds_read_b64_tr_b16 a[166:167], v118 offset:18432
    ds_read_b64_tr_b16 a[170:171], v118 offset:20480
    ds_read_b64_tr_b16 a[174:175], v118 offset:22528
    ds_read_b64_tr_b16 a[178:179], v118 offset:24576
    ds_read_b64_tr_b16 a[182:183], v118 offset:26624
    ds_read_b64_tr_b16 a[186:187], v118 offset:28672
    ds_read_b64_tr_b16 a[190:191], v118 offset:30720
    ds_read_b64_tr_b16 a[194:195], v119 offset:0
    ds_read_b64_tr_b16 a[198:199], v119 offset:2048
    ds_read_b64_tr_b16 a[202:203], v119 offset:4096
    ds_read_b64_tr_b16 a[206:207], v119 offset:6144
    ds_read_b64_tr_b16 a[210:211], v119 offset:8192
    ds_read_b64_tr_b16 a[214:215], v119 offset:10240
    ds_read_b64_tr_b16 a[218:219], v119 offset:12288
    ds_read_b64_tr_b16 a[222:223], v119 offset:14336
    ds_read_b64_tr_b16 a[226:227], v119 offset:16384
    ds_read_b64_tr_b16 a[230:231], v119 offset:18432
    ds_read_b64_tr_b16 a[234:235], v119 offset:20480
    ds_read_b64_tr_b16 a[238:239], v119 offset:22528
    ds_read_b64_tr_b16 a[242:243], v119 offset:24576
    ds_read_b64_tr_b16 a[246:247], v119 offset:26624
    ds_read_b64_tr_b16 a[250:251], v119 offset:28672
    ds_read_b64_tr_b16 a[254:255], v119 offset:30720
    s_branch L_cvd_6
L_cv1_5:
L_pb_5:
    s_branch L_pbt_5
.p2align 12
L_pbt_5:
    s_waitcnt vmcnt(0)
    s_waitcnt lgkmcnt(0)
    s_barrier
    ds_read_b128 v[60:63], v8 offset:2048
    ds_read_b128 v[56:59], v8 offset:2560
    ds_read_b128 v[52:55], v8 offset:3072
    ds_read_b128 v[48:51], v8 offset:3584
    ds_read_b128 v[76:79], v8 offset:2112
    ds_read_b128 v[72:75], v8 offset:2624
    ds_read_b128 v[68:71], v8 offset:3136
    s_waitcnt lgkmcnt(6)
    v_mfma_f32_16x16x32_bf16 v[28:31], v[128:131], v[60:63], 0
    s_waitcnt lgkmcnt(5)
    v_mfma_f32_16x16x32_bf16 v[24:27], v[128:131], v[56:59], 0
    ds_read_b128 v[64:67], v8 offset:3648
    v_mfma_f32_16x16x32_bf16 v[28:31], v[132:135], v[56:59], v[28:31]
    s_waitcnt lgkmcnt(5)
    v_mfma_f32_16x16x32_bf16 v[20:23], v[128:131], v[52:55], 0
    v_mfma_f32_16x16x32_bf16 v[24:27], v[132:135], v[52:55], v[24:27]
    v_mfma_f32_16x16x32_bf16 v[28:31], v[136:139], v[52:55], v[28:31]
    ds_read_b128 v[60:63], v8 offset:2176
    s_waitcnt lgkmcnt(5)
    v_mfma_f32_16x16x32_bf16 v[16:19], v[128:131], v[48:51], 0
    ds_read_b128 v[56:59], v8 offset:2688
    v_mfma_f32_16x16x32_bf16 v[20:23], v[132:135], v[48:51], v[20:23]
    v_mfma_f32_16x16x32_bf16 v[24:27], v[136:139], v[48:51], v[24:27]
    ds_read_b128 v[52:55], v8 offset:3200
    v_mfma_f32_16x16x32_bf16 v[28:31], v[140:143], v[48:51], v[28:31]
    s_waitcnt lgkmcnt(6)
    v_mfma_f32_16x16x32_bf16 v[28:31], v[160:163], v[76:79], v[28:31]
    s_waitcnt lgkmcnt(5)
    v_mfma_f32_16x16x32_bf16 v[24:27], v[160:163], v[72:75], v[24:27]
    ds_read_b128 v[48:51], v8 offset:3712
    v_mfma_f32_16x16x32_bf16 v[28:31], v[164:167], v[72:75], v[28:31]
    s_waitcnt lgkmcnt(5)
    v_mfma_f32_16x16x32_bf16 v[20:23], v[160:163], v[68:71], v[20:23]
    v_mfma_f32_16x16x32_bf16 v[24:27], v[164:167], v[68:71], v[24:27]
    v_mfma_f32_16x16x32_bf16 v[28:31], v[168:171], v[68:71], v[28:31]
    ds_read_b128 v[76:79], v8 offset:2240
    s_waitcnt lgkmcnt(5)
    v_mfma_f32_16x16x32_bf16 v[16:19], v[160:163], v[64:67], v[16:19]
    ds_read_b128 v[72:75], v8 offset:2752
    v_mfma_f32_16x16x32_bf16 v[20:23], v[164:167], v[64:67], v[20:23]
    v_mfma_f32_16x16x32_bf16 v[24:27], v[168:171], v[64:67], v[24:27]
    ds_read_b128 v[68:71], v8 offset:3264
    v_mfma_f32_16x16x32_bf16 v[28:31], v[172:175], v[64:67], v[28:31]
    s_waitcnt lgkmcnt(6)
    v_mfma_f32_16x16x32_bf16 v[28:31], v[192:195], v[60:63], v[28:31]
    s_waitcnt lgkmcnt(5)
    v_mfma_f32_16x16x32_bf16 v[24:27], v[192:195], v[56:59], v[24:27]
    ds_read_b128 v[64:67], v8 offset:3776
    v_mfma_f32_16x16x32_bf16 v[28:31], v[196:199], v[56:59], v[28:31]
    s_waitcnt lgkmcnt(5)
    v_mfma_f32_16x16x32_bf16 v[20:23], v[192:195], v[52:55], v[20:23]
    v_mfma_f32_16x16x32_bf16 v[24:27], v[196:199], v[52:55], v[24:27]
    v_mfma_f32_16x16x32_bf16 v[28:31], v[200:203], v[52:55], v[28:31]
    s_waitcnt lgkmcnt(4)
    v_mfma_f32_16x16x32_bf16 v[16:19], v[192:195], v[48:51], v[16:19]
    v_mfma_f32_16x16x32_bf16 v[20:23], v[196:199], v[48:51], v[20:23]
    v_mfma_f32_16x16x32_bf16 v[24:27], v[200:203], v[48:51], v[24:27]
    v_mfma_f32_16x16x32_bf16 v[28:31], v[204:207], v[48:51], v[28:31]
    ds_read_b128 v[48:51], v8 offset:3584
    ds_read_b128 v[52:55], v8 offset:3072
    s_waitcnt lgkmcnt(5)
    v_mfma_f32_16x16x32_bf16 v[28:31], v[224:227], v[76:79], v[28:31]
    s_waitcnt lgkmcnt(4)
    v_mfma_f32_16x16x32_bf16 v[24:27], v[224:227], v[72:75], v[24:27]
    v_mfma_f32_16x16x32_bf16 v[28:31], v[228:231], v[72:75], v[28:31]
    s_waitcnt lgkmcnt(3)
    v_mfma_f32_16x16x32_bf16 v[20:23], v[224:227], v[68:71], v[20:23]
    ds_read_b128 v[56:59], v8 offset:2560
    v_mfma_f32_16x16x32_bf16 v[24:27], v[228:231], v[68:71], v[24:27]
    v_mfma_f32_16x16x32_bf16 v[28:31], v[232:235], v[68:71], v[28:31]
    s_waitcnt lgkmcnt(3)
    v_mfma_f32_16x16x32_bf16 v[16:19], v[224:227], v[64:67], v[16:19]
    v_mfma_f32_16x16x32_bf16 v[20:23], v[228:231], v[64:67], v[20:23]
    ds_read_b128 v[60:63], v8 offset:2048
    v_mfma_f32_16x16x32_bf16 v[24:27], v[232:235], v[64:67], v[24:27]
    v_mfma_f32_16x16x32_bf16 v[28:31], v[236:239], v[64:67], v[28:31]
    s_waitcnt lgkmcnt(3)
    v_mfma_f32_16x16x32_bf16 v[32:35], v[144:147], v[48:51], 0
    v_mfma_f32_16x16x32_bf16 v[36:39], v[148:151], v[48:51], 0
    ds_read_b128 v[76:79], v8 offset:0
    v_mfma_f32_16x16x32_bf16 v[40:43], v[152:155], v[48:51], 0
    ds_read_b128 v[72:75], v8 offset:512
    ds_write_b128 v6, v[16:19] offset:0
    v_mfma_f32_16x16x32_bf16 v[44:47], v[156:159], v[48:51], 0
    ds_write_b128 v6, v[20:23] offset:1024
    s_waitcnt lgkmcnt(6)
    v_mfma_f32_16x16x32_bf16 v[32:35], v[140:143], v[52:55], v[32:35]
    ds_read_b128 v[68:71], v8 offset:1024
    v_mfma_f32_16x16x32_bf16 v[36:39], v[144:147], v[52:55], v[36:39]
    v_mfma_f32_16x16x32_bf16 v[40:43], v[148:151], v[52:55], v[40:43]
    s_waitcnt lgkmcnt(0)
    s_barrier
    ds_read_b128 v[80:83], v3 offset:14336
    v_mfma_f32_16x16x32_bf16 v[44:47], v[152:155], v[52:55], v[44:47]
    ds_read_b128 v[64:67], v8 offset:1536
    v_mfma_f32_16x16x32_bf16 v[32:35], v[136:139], v[56:59], v[32:35]
    ds_read_b128 v[84:87], v3 offset:2048
    v_mfma_f32_16x16x32_bf16 v[36:39], v[140:143], v[56:59], v[36:39]
    ds_read_b128 v[88:91], v3 offset:10240
    v_mfma_f32_16x16x32_bf16 v[40:43], v[144:147], v[56:59], v[40:43]
    ds_read_b128 v[92:95], v3 offset:15360
    v_mfma_f32_16x16x32_bf16 v[44:47], v[148:151], v[56:59], v[44:47]
    ds_read_b128 v[96:99], v3 offset:3072
    v_mfma_f32_16x16x32_bf16 v[32:35], v[132:135], v[60:63], v[32:35]
    ds_read_b128 v[100:103], v3 offset:11264
    v_mfma_f32_16x16x32_bf16 v[36:39], v[136:139], v[60:63], v[36:39]
    v_mfma_f32_16x16x32_bf16 v[40:43], v[140:143], v[60:63], v[40:43]
    v_mfma_f32_16x16x32_bf16 v[44:47], v[144:147], v[60:63], v[44:47]
    v_mfma_f32_16x16x32_bf16 v[44:47], v[128:131], v[76:79], v[44:47]
    ds_read_b128 v[76:79], v8 offset:64
    v_mfma_f32_16x16x32_bf16 v[40:43], v[128:131], v[72:75], v[40:43]
    s_waitcnt lgkmcnt(7)
    v_add_f32 v80, v80, v24
    v_mfma_f32_16x16x32_bf16 v[44:47], v[132:135], v[72:75], v[44:47]
    ds_read_b128 v[72:75], v8 offset:576
    v_mfma_f32_16x16x32_bf16 v[36:39], v[128:131], v[68:71], v[36:39]
    s_waitcnt lgkmcnt(5)
    v_add_f32 v84, v84, v88
    v_add_f32 v81, v81, v25
    v_mfma_f32_16x16x32_bf16 v[40:43], v[132:135], v[68:71], v[40:43]
    v_add_f32 v85, v85, v89
    v_add_f32 v82, v82, v26
    v_mfma_f32_16x16x32_bf16 v[44:47], v[136:139], v[68:71], v[44:47]
    v_add_f32 v86, v86, v90
    v_add_f32 v83, v83, v27
    v_add_f32 v87, v87, v91
    v_cvt_pk_bf16_f32 v88, v84, v80
    v_cvt_pk_bf16_f32 v89, v85, v81
    v_cvt_pk_bf16_f32 v90, v86, v82
    v_cvt_pk_bf16_f32 v91, v87, v83
    buffer_store_dwordx4 v[88:91], v7, s[12:15], s82 offen sc1
    s_add_u32 s82, s82, 262144
    s_waitcnt lgkmcnt(4)
    v_add_f32 v92, v92, v28
    s_waitcnt lgkmcnt(2)
    v_add_f32 v96, v96, v100
    v_add_f32 v93, v93, v29
    v_add_f32 v97, v97, v101
    v_add_f32 v94, v94, v30
    v_add_f32 v98, v98, v102
    v_add_f32 v95, v95, v31
    v_add_f32 v99, v99, v103
    v_cvt_pk_bf16_f32 v100, v96, v92
    v_cvt_pk_bf16_f32 v101, v97, v93
    v_cvt_pk_bf16_f32 v102, v98, v94
    v_cvt_pk_bf16_f32 v103, v99, v95
    buffer_store_dwordx4 v[100:103], v7, s[12:15], s82 offen sc1
    s_add_u32 s82, s82, 786432
    s_waitcnt lgkmcnt(0)
    s_barrier
    ds_read_b128 v[68:71], v8 offset:1088
    ds_read_b128 v[60:63], v8 offset:2112
    v_mfma_f32_16x16x32_bf16 v[32:35], v[128:131], v[64:67], v[32:35]
    s_lshl_b32 s64, s3, 7
    s_lshl_b32 s65, s100, 9
    s_sub_u32 s65, 384, s65
    s_cmp_eq_u32 s3, 3
    s_cselect_b32 s64, s65, s64
    s_add_u32 s64, s64, s101
    v_lshrrev_b32 v10, 4, v0
    v_lshlrev_b32 v10, 3, v10
    buffer_load_dwordx2 v[104:105], v10, s[52:55], s64 offen offset:0
    buffer_load_dwordx2 v[106:107], v10, s[52:55], s64 offen offset:32
    buffer_load_dwordx2 v[108:109], v10, s[52:55], s64 offen offset:64
    buffer_load_dwordx2 v[110:111], v10, s[52:55], s64 offen offset:96
    v_mfma_f32_16x16x32_bf16 v[36:39], v[132:135], v[64:67], v[36:39]
    v_mfma_f32_16x16x32_bf16 v[40:43], v[136:139], v[64:67], v[40:43]
    v_mfma_f32_16x16x32_bf16 v[44:47], v[140:143], v[64:67], v[44:47]
    ds_read_b128 v[64:67], v8 offset:1600
    ds_read_b128 v[56:59], v8 offset:2624
    v_mfma_f32_16x16x32_bf16 v[44:47], v[160:163], v[76:79], v[44:47]
    v_mfma_f32_16x16x32_bf16 v[40:43], v[160:163], v[72:75], v[40:43]
    v_mfma_f32_16x16x32_bf16 v[44:47], v[164:167], v[72:75], v[44:47]
    s_waitcnt lgkmcnt(3)
    v_mfma_f32_16x16x32_bf16 v[36:39], v[160:163], v[68:71], v[36:39]
    ds_read_b128 v[52:55], v8 offset:3136
    v_mfma_f32_16x16x32_bf16 v[40:43], v[164:167], v[68:71], v[40:43]
    v_mfma_f32_16x16x32_bf16 v[44:47], v[168:171], v[68:71], v[44:47]
    s_waitcnt lgkmcnt(2)
    v_mfma_f32_16x16x32_bf16 v[32:35], v[160:163], v[64:67], v[32:35]
    v_mfma_f32_16x16x32_bf16 v[36:39], v[164:167], v[64:67], v[36:39]
    ds_read_b128 v[48:51], v8 offset:3648
    v_mfma_f32_16x16x32_bf16 v[40:43], v[168:171], v[64:67], v[40:43]
    v_mfma_f32_16x16x32_bf16 v[44:47], v[172:175], v[64:67], v[44:47]
    v_mfma_f32_16x16x32_bf16 v[32:35], v[164:167], v[60:63], v[32:35]
    v_mfma_f32_16x16x32_bf16 v[36:39], v[168:171], v[60:63], v[36:39]
    ds_read_b128 v[76:79], v8 offset:128
    v_mfma_f32_16x16x32_bf16 v[40:43], v[172:175], v[60:63], v[40:43]
    ds_read_b128 v[72:75], v8 offset:640
    v_mfma_f32_16x16x32_bf16 v[44:47], v[176:179], v[60:63], v[44:47]
    s_waitcnt lgkmcnt(4)
    v_mfma_f32_16x16x32_bf16 v[32:35], v[168:171], v[56:59], v[32:35]
    ds_read_b128 v[68:71], v8 offset:1152
    v_mfma_f32_16x16x32_bf16 v[36:39], v[172:175], v[56:59], v[36:39]
    v_mfma_f32_16x16x32_bf16 v[40:43], v[176:179], v[56:59], v[40:43]
    v_mfma_f32_16x16x32_bf16 v[44:47], v[180:183], v[56:59], v[44:47]
    ds_read_b128 v[64:67], v8 offset:1664
    s_waitcnt lgkmcnt(5)
    v_mfma_f32_16x16x32_bf16 v[32:35], v[172:175], v[52:55], v[32:35]
    v_mfma_f32_16x16x32_bf16 v[36:39], v[176:179], v[52:55], v[36:39]
    v_mfma_f32_16x16x32_bf16 v[40:43], v[180:183], v[52:55], v[40:43]
    v_mfma_f32_16x16x32_bf16 v[44:47], v[184:187], v[52:55], v[44:47]
    ds_read_b128 v[60:63], v8 offset:2176
    s_waitcnt lgkmcnt(5)
    v_mfma_f32_16x16x32_bf16 v[32:35], v[176:179], v[48:51], v[32:35]
    v_mfma_f32_16x16x32_bf16 v[36:39], v[180:183], v[48:51], v[36:39]
    v_mfma_f32_16x16x32_bf16 v[40:43], v[184:187], v[48:51], v[40:43]
    v_mfma_f32_16x16x32_bf16 v[44:47], v[188:191], v[48:51], v[44:47]
    ds_read_b128 v[56:59], v8 offset:2688
    s_waitcnt lgkmcnt(5)
    v_mfma_f32_16x16x32_bf16 v[44:47], v[192:195], v[76:79], v[44:47]
    s_lshl_b32 s92, s3, 7
    s_lshl_b32 s70, s100, 9
    s_sub_u32 s70, 384, s70
    s_cmp_eq_u32 s3, 3
    s_cselect_b32 s92, s70, s92
    s_add_u32 s92, s92, s101
    s_waitcnt lgkmcnt(4)
    v_mfma_f32_16x16x32_bf16 v[40:43], v[192:195], v[72:75], v[40:43]
    s_add_u32 s92, s92, 917504
    s_lshl_b32 s93, s3, 15
    s_add_u32 s93, s93, 32768
    v_mfma_f32_16x16x32_bf16 v[44:47], v[196:199], v[72:75], v[44:47]
    s_lshl_b32 s91, s6, 1
    s_and_b32 s91, s91, 7
    s_waitcnt lgkmcnt(3)
    v_mfma_f32_16x16x32_bf16 v[36:39], v[192:195], v[68:71], v[36:39]
    ds_read_b128 v[52:55], v8 offset:3200
    s_lshl_b32 s70, s91, 12
    v_mfma_f32_16x16x32_bf16 v[40:43], v[196:199], v[68:71], v[40:43]
    s_add_u32 m0, s70, s93
    s_mul_i32 s70, s91, 114688
    s_add_u32 s70, s70, s92
    v_mfma_f32_16x16x32_bf16 v[44:47], v[200:203], v[68:71], v[44:47]
    s_add_u32 s91, s91, 1
    buffer_load_dwordx4 v120, s[28:31], s70 offen offset:0 lds
    s_waitcnt lgkmcnt(3)
    v_mfma_f32_16x16x32_bf16 v[32:35], v[192:195], v[64:67], v[32:35]
    buffer_load_dwordx4 v121, s[28:31], s70 offen offset:1024 lds
    v_mfma_f32_16x16x32_bf16 v[36:39], v[196:199], v[64:67], v[36:39]
    ds_read_b128 v[48:51], v8 offset:3712
    buffer_load_dwordx4 v122, s[28:31], s70 offen offset:2048 lds
    v_mfma_f32_16x16x32_bf16 v[40:43], v[200:203], v[64:67], v[40:43]
    buffer_load_dwordx4 v123, s[28:31], s70 offen offset:3072 lds
    v_mfma_f32_16x16x32_bf16 v[44:47], v[204:207], v[64:67], v[44:47]
    s_and_b32 s91, s91, 7
    s_lshl_b32 s70, s91, 12
    s_waitcnt lgkmcnt(3)
    v_mfma_f32_16x16x32_bf16 v[32:35], v[196:199], v[60:63], v[32:35]
    s_add_u32 m0, s70, s93
    s_mul_i32 s70, s91, 114688
    s_add_u32 s70, s70, s92
    v_mfma_f32_16x16x32_bf16 v[36:39], v[200:203], v[60:63], v[36:39]
    ds_read_b128 v[76:79], v8 offset:192
    s_waitcnt vmcnt(8)
    buffer_store_dword v1, v12, s[12:15], s83 offen sc1
    v_mfma_f32_16x16x32_bf16 v[40:43], v[204:207], v[60:63], v[40:43]
    ds_read_b128 v[72:75], v8 offset:704
    s_add_u32 s91, s91, 1
    v_mfma_f32_16x16x32_bf16 v[44:47], v[208:211], v[60:63], v[44:47]
    buffer_load_dwordx4 v120, s[28:31], s70 offen offset:0 lds
    s_waitcnt lgkmcnt(4)
    v_mfma_f32_16x16x32_bf16 v[32:35], v[200:203], v[56:59], v[32:35]
    ds_read_b128 v[68:71], v8 offset:1216
    buffer_load_dwordx4 v121, s[28:31], s70 offen offset:1024 lds
    v_mfma_f32_16x16x32_bf16 v[36:39], v[204:207], v[56:59], v[36:39]
    buffer_load_dwordx4 v122, s[28:31], s70 offen offset:2048 lds
    v_mfma_f32_16x16x32_bf16 v[40:43], v[208:211], v[56:59], v[40:43]
    buffer_load_dwordx4 v123, s[28:31], s70 offen offset:3072 lds
    v_mfma_f32_16x16x32_bf16 v[44:47], v[212:215], v[56:59], v[44:47]
    ds_read_b128 v[64:67], v8 offset:1728
    s_waitcnt lgkmcnt(5)
    v_mfma_f32_16x16x32_bf16 v[32:35], v[204:207], v[52:55], v[32:35]
    s_and_b32 s91, s91, 7
    s_lshl_b32 s70, s91, 12
    s_add_u32 m0, s70, s93
    v_mfma_f32_16x16x32_bf16 v[36:39], v[208:211], v[52:55], v[36:39]
    s_mul_i32 s70, s91, 114688
    s_add_u32 s70, s70, s92
    s_add_u32 s91, s91, 1
    v_mfma_f32_16x16x32_bf16 v[40:43], v[212:215], v[52:55], v[40:43]
    buffer_load_dwordx4 v120, s[28:31], s70 offen offset:0 lds
    v_mfma_f32_16x16x32_bf16 v[44:47], v[216:219], v[52:55], v[44:47]
    ds_read_b128 v[60:63], v8 offset:2240
    s_waitcnt lgkmcnt(5)
    v_mfma_f32_16x16x32_bf16 v[32:35], v[208:211], v[48:51], v[32:35]
    buffer_load_dwordx4 v121, s[28:31], s70 offen offset:1024 lds
    v_mfma_f32_16x16x32_bf16 v[36:39], v[212:215], v[48:51], v[36:39]
    buffer_load_dwordx4 v122, s[28:31], s70 offen offset:2048 lds
    v_mfma_f32_16x16x32_bf16 v[40:43], v[216:219], v[48:51], v[40:43]
    buffer_load_dwordx4 v123, s[28:31], s70 offen offset:3072 lds
    v_mfma_f32_16x16x32_bf16 v[44:47], v[220:223], v[48:51], v[44:47]
    ds_read_b128 v[56:59], v8 offset:2752
    s_waitcnt lgkmcnt(5)
    v_mfma_f32_16x16x32_bf16 v[44:47], v[224:227], v[76:79], v[44:47]
    s_and_b32 s91, s91, 7
    s_lshl_b32 s70, s91, 12
    s_waitcnt lgkmcnt(4)
    v_mfma_f32_16x16x32_bf16 v[40:43], v[224:227], v[72:75], v[40:43]
    s_add_u32 m0, s70, s93
    s_mul_i32 s70, s91, 114688
    s_add_u32 s70, s70, s92
    v_mfma_f32_16x16x32_bf16 v[44:47], v[228:231], v[72:75], v[44:47]
    s_add_u32 s91, s91, 1
    buffer_load_dwordx4 v120, s[28:31], s70 offen offset:0 lds
    s_waitcnt lgkmcnt(3)
    v_mfma_f32_16x16x32_bf16 v[36:39], v[224:227], v[68:71], v[36:39]
    ds_read_b128 v[52:55], v8 offset:3264
    buffer_load_dwordx4 v121, s[28:31], s70 offen offset:1024 lds
    v_mfma_f32_16x16x32_bf16 v[40:43], v[228:231], v[68:71], v[40:43]
    buffer_load_dwordx4 v122, s[28:31], s70 offen offset:2048 lds
    v_mfma_f32_16x16x32_bf16 v[44:47], v[232:235], v[68:71], v[44:47]
    buffer_load_dwordx4 v123, s[28:31], s70 offen offset:3072 lds
    s_waitcnt lgkmcnt(3)
    v_mfma_f32_16x16x32_bf16 v[32:35], v[224:227], v[64:67], v[32:35]
    s_and_b32 s91, s91, 7
    s_lshl_b32 s70, s91, 12
    s_add_u32 m0, s70, s93
    v_mfma_f32_16x16x32_bf16 v[36:39], v[228:231], v[64:67], v[36:39]
    ds_read_b128 v[48:51], v8 offset:3776
    s_mul_i32 s70, s91, 114688
    v_mfma_f32_16x16x32_bf16 v[40:43], v[232:235], v[64:67], v[40:43]
    s_add_u32 s70, s70, s92
    s_add_u32 s91, s91, 1
    buffer_load_dwordx4 v120, s[28:31], s70 offen offset:0 lds
    v_mfma_f32_16x16x32_bf16 v[44:47], v[236:239], v[64:67], v[44:47]
    buffer_load_dwordx4 v121, s[28:31], s70 offen offset:1024 lds
    s_waitcnt lgkmcnt(3)
    v_mfma_f32_16x16x32_bf16 v[32:35], v[228:231], v[60:63], v[32:35]
    buffer_load_dwordx4 v122, s[28:31], s70 offen offset:2048 lds
    v_mfma_f32_16x16x32_bf16 v[36:39], v[232:235], v[60:63], v[36:39]
    buffer_load_dwordx4 v123, s[28:31], s70 offen offset:3072 lds
    v_mfma_f32_16x16x32_bf16 v[40:43], v[236:239], v[60:63], v[40:43]
    s_and_b32 s91, s91, 7
    s_lshl_b32 s70, s91, 12
    s_add_u32 m0, s70, s93
    v_mfma_f32_16x16x32_bf16 v[44:47], v[240:243], v[60:63], v[44:47]
    s_mul_i32 s70, s91, 114688
    s_add_u32 s70, s70, s92
    s_waitcnt lgkmcnt(2)
    v_mfma_f32_16x16x32_bf16 v[32:35], v[232:235], v[56:59], v[32:35]
    s_add_u32 s91, s91, 1
    buffer_load_dwordx4 v120, s[28:31], s70 offen offset:0 lds
    v_mfma_f32_16x16x32_bf16 v[36:39], v[236:239], v[56:59], v[36:39]
    buffer_load_dwordx4 v121, s[28:31], s70 offen offset:1024 lds
    v_mfma_f32_16x16x32_bf16 v[40:43], v[240:243], v[56:59], v[40:43]
    buffer_load_dwordx4 v122, s[28:31], s70 offen offset:2048 lds
    v_mfma_f32_16x16x32_bf16 v[44:47], v[244:247], v[56:59], v[44:47]
    buffer_load_dwordx4 v123, s[28:31], s70 offen offset:3072 lds
    s_waitcnt lgkmcnt(1)
    v_mfma_f32_16x16x32_bf16 v[32:35], v[236:239], v[52:55], v[32:35]
    s_and_b32 s91, s91, 7
    s_lshl_b32 s70, s91, 12
    s_add_u32 m0, s70, s93
    v_mfma_f32_16x16x32_bf16 v[36:39], v[240:243], v[52:55], v[36:39]
    s_mul_i32 s70, s91, 114688
    s_add_u32 s70, s70, s92
    s_add_u32 s91, s91, 1
    v_mfma_f32_16x16x32_bf16 v[40:43], v[244:247], v[52:55], v[40:43]
    buffer_load_dwordx4 v120, s[28:31], s70 offen offset:0 lds
    v_mfma_f32_16x16x32_bf16 v[44:47], v[248:251], v[52:55], v[44:47]
    buffer_load_dwordx4 v121, s[28:31], s70 offen offset:1024 lds
    s_waitcnt lgkmcnt(0)
    v_mfma_f32_16x16x32_bf16 v[32:35], v[240:243], v[48:51], v[32:35]
    buffer_load_dwordx4 v122, s[28:31], s70 offen offset:2048 lds
    v_mfma_f32_16x16x32_bf16 v[36:39], v[244:247], v[48:51], v[36:39]
    buffer_load_dwordx4 v123, s[28:31], s70 offen offset:3072 lds
    v_mfma_f32_16x16x32_bf16 v[40:43], v[248:251], v[48:51], v[40:43]
    s_and_b32 s91, s91, 7
    s_lshl_b32 s70, s91, 12
    s_add_u32 m0, s70, s93
    v_mfma_f32_16x16x32_bf16 v[44:47], v[252:255], v[48:51], v[44:47]
    ds_write_b128 v6, v[32:35] offset:0
    s_nop 0
    ds_write_b128 v6, v[36:39] offset:1024
    s_waitcnt lgkmcnt(0)
    s_barrier
    ds_read_b128 v[80:83], v3 offset:14336
    ds_read_b128 v[84:87], v3 offset:2048
    ds_read_b128 v[88:91], v3 offset:10240
    ds_read_b128 v[92:95], v3 offset:15360
    ds_read_b128 v[96:99], v3 offset:3072
    ds_read_b128 v[100:103], v3 offset:11264
    s_waitcnt lgkmcnt(5)
    v_add_f32 v80, v80, v40
    s_waitcnt lgkmcnt(3)
    v_add_f32 v84, v84, v88
    v_add_f32 v81, v81, v41
    v_add_f32 v85, v85, v89
    v_add_f32 v82, v82, v42
    v_add_f32 v86, v86, v90
    v_add_f32 v83, v83, v43
    v_add_f32 v87, v87, v91
    v_cvt_pk_bf16_f32 v88, v84, v80
    v_cvt_pk_bf16_f32 v89, v85, v81
    v_cvt_pk_bf16_f32 v90, v86, v82
    v_cvt_pk_bf16_f32 v91, v87, v83
    buffer_store_dwordx4 v[88:91], v7, s[12:15], s82 offen sc1
    s_add_u32 s82, s82, 262144
    s_waitcnt lgkmcnt(2)
    v_add_f32 v92, v92, v44
    s_waitcnt lgkmcnt(0)
    v_add_f32 v96, v96, v100
    v_add_f32 v93, v93, v45
    v_add_f32 v97, v97, v101
    v_add_f32 v94, v94, v46
    v_add_f32 v98, v98, v102
    v_add_f32 v95, v95, v47
    v_add_f32 v99, v99, v103
    v_cvt_pk_bf16_f32 v100, v96, v92
    v_cvt_pk_bf16_f32 v101, v97, v93
    v_cvt_pk_bf16_f32 v102, v98, v94
    v_cvt_pk_bf16_f32 v103, v99, v95
    buffer_store_dwordx4 v[100:103], v7, s[12:15], s82 offen sc1
    s_add_u32 s82, s82, 786432
    s_barrier
    s_mul_i32 s70, s91, 114688
    s_add_u32 s70, s70, s92
    s_add_u32 s91, s91, 1
    buffer_load_dwordx4 v120, s[28:31], s70 offen offset:0 lds
    buffer_load_dwordx4 v121, s[28:31], s70 offen offset:1024 lds
    buffer_load_dwordx4 v122, s[28:31], s70 offen offset:2048 lds
    buffer_load_dwordx4 v123, s[28:31], s70 offen offset:3072 lds
L_pb_6:
    s_waitcnt vmcnt(4)
    buffer_store_dword v1, v12, s[12:15], s83 offen offset:2048 sc1
    s_waitcnt vmcnt(1)
    ds_read_b64_tr_b16 a[2:3], v116 offset:0
    ds_read_b64_tr_b16 a[6:7], v116 offset:2048
    ds_read_b64_tr_b16 a[10:11], v116 offset:4096
    ds_read_b64_tr_b16 a[14:15], v116 offset:6144
    ds_read_b64_tr_b16 a[18:19], v116 offset:8192
    ds_read_b64_tr_b16 a[22:23], v116 offset:10240
    ds_read_b64_tr_b16 a[26:27], v116 offset:12288
    ds_read_b64_tr_b16 a[30:31], v116 offset:14336
    ds_read_b64_tr_b16 a[34:35], v116 offset:16384
    ds_read_b64_tr_b16 a[38:39], v116 offset:18432
    ds_read_b64_tr_b16 a[42:43], v116 offset:20480
    ds_read_b64_tr_b16 a[46:47], v116 offset:22528
    ds_read_b64_tr_b16 a[50:51], v116 offset:24576
    ds_read_b64_tr_b16 a[54:55], v116 offset:26624
    ds_read_b64_tr_b16 a[58:59], v116 offset:28672
    ds_read_b64_tr_b16 a[62:63], v116 offset:30720
    ds_read_b64_tr_b16 a[66:67], v117 offset:0
    ds_read_b64_tr_b16 a[70:71], v117 offset:2048
    ds_read_b64_tr_b16 a[74:75], v117 offset:4096
    ds_read_b64_tr_b16 a[78:79], v117 offset:6144
    ds_read_b64_tr_b16 a[82:83], v117 offset:8192
    ds_read_b64_tr_b16 a[86:87], v117 offset:10240
    ds_read_b64_tr_b16 a[90:91], v117 offset:12288
    ds_read_b64_tr_b16 a[94:95], v117 offset:14336
    ds_read_b64_tr_b16 a[98:99], v117 offset:16384
    ds_read_b64_tr_b16 a[102:103], v117 offset:18432
    ds_read_b64_tr_b16 a[106:107], v117 offset:20480
    ds_read_b64_tr_b16 a[110:111], v117 offset:22528
    ds_read_b64_tr_b16 a[114:115], v117 offset:24576
    ds_read_b64_tr_b16 a[118:119], v117 offset:26624
    ds_read_b64_tr_b16 a[122:123], v117 offset:28672
    ds_read_b64_tr_b16 a[126:127], v117 offset:30720
    ds_read_b64_tr_b16 a[130:131], v118 offset:0
    ds_read_b64_tr_b16 a[134:135], v118 offset:2048
    ds_read_b64_tr_b16 a[138:139], v118 offset:4096
    ds_read_b64_tr_b16 a[142:143], v118 offset:6144
    ds_read_b64_tr_b16 a[146:147], v118 offset:8192
    ds_read_b64_tr_b16 a[150:151], v118 offset:10240
    ds_read_b64_tr_b16 a[154:155], v118 offset:12288
    ds_read_b64_tr_b16 a[158:159], v118 offset:14336
    ds_read_b64_tr_b16 a[162:163], v118 offset:16384
    ds_read_b64_tr_b16 a[166:167], v118 offset:18432
    ds_read_b64_tr_b16 a[170:171], v118 offset:20480
    ds_read_b64_tr_b16 a[174:175], v118 offset:22528
    ds_read_b64_tr_b16 a[178:179], v118 offset:24576
    ds_read_b64_tr_b16 a[182:183], v118 offset:26624
    ds_read_b64_tr_b16 a[186:187], v118 offset:28672
    ds_read_b64_tr_b16 a[190:191], v118 offset:30720
    ds_read_b64_tr_b16 a[194:195], v119 offset:0
    ds_read_b64_tr_b16 a[198:199], v119 offset:2048
    ds_read_b64_tr_b16 a[202:203], v119 offset:4096
    ds_read_b64_tr_b16 a[206:207], v119 offset:6144
    ds_read_b64_tr_b16 a[210:211], v119 offset:8192
    ds_read_b64_tr_b16 a[214:215], v119 offset:10240
    ds_read_b64_tr_b16 a[218:219], v119 offset:12288
    ds_read_b64_tr_b16 a[222:223], v119 offset:14336
    ds_read_b64_tr_b16 a[226:227], v119 offset:16384
    ds_read_b64_tr_b16 a[230:231], v119 offset:18432
    ds_read_b64_tr_b16 a[234:235], v119 offset:20480
    ds_read_b64_tr_b16 a[238:239], v119 offset:22528
    ds_read_b64_tr_b16 a[242:243], v119 offset:24576
    ds_read_b64_tr_b16 a[246:247], v119 offset:26624
    ds_read_b64_tr_b16 a[250:251], v119 offset:28672
    ds_read_b64_tr_b16 a[254:255], v119 offset:30720
L_cvd_6:
    s_waitcnt lgkmcnt(0)
    s_mul_i32 s92, s7, 229376
    s_lshl_b32 s70, s3, 8
    s_add_u32 s92, s92, s70
    s_lshl_b32 s70, s100, 15
    s_add_u32 s92, s92, s70
    s_lshl_b32 s93, s3, 15
    s_add_u32 s93, s93, 32768
    s_lshl_b32 s71, s3, 1
    s_mov_b32 s91, s6
    s_and_b32 s91, s91, 3
    s_lshl_b32 s70, s91, 12
    s_add_u32 m0, s70, s93
    s_xor_b32 s70, s91, s71
    s_lshl_b32 s70, s70, 15
    s_add_u32 s70, s70, s92
    s_add_u32 s91, s91, 1
    buffer_load_dwordx4 v124, s[32:35], s70 offen offset:0 lds
    buffer_load_dwordx4 v125, s[32:35], s70 offen offset:1024 lds
    buffer_load_dwordx4 v126, s[32:35], s70 offen offset:2048 lds
    buffer_load_dwordx4 v127, s[32:35], s70 offen offset:3072 lds
    s_add_u32 m0, m0, 16384
    s_add_u32 s70, s70, 128
    buffer_load_dwordx4 v124, s[32:35], s70 offen offset:0 lds
    buffer_load_dwordx4 v125, s[32:35], s70 offen offset:1024 lds
    buffer_load_dwordx4 v126, s[32:35], s70 offen offset:2048 lds
    buffer_load_dwordx4 v127, s[32:35], s70 offen offset:3072 lds
    s_and_b32 s91, s91, 3
    s_lshl_b32 s70, s91, 12
    s_add_u32 m0, s70, s93
    s_xor_b32 s70, s91, s71
    s_lshl_b32 s70, s70, 15
    s_add_u32 s70, s70, s92
    s_add_u32 s91, s91, 1
    buffer_load_dwordx4 v124, s[32:35], s70 offen offset:0 lds
    buffer_load_dwordx4 v125, s[32:35], s70 offen offset:1024 lds
    buffer_load_dwordx4 v126, s[32:35], s70 offen offset:2048 lds
    buffer_load_dwordx4 v127, s[32:35], s70 offen offset:3072 lds
    s_add_u32 m0, m0, 16384
    s_add_u32 s70, s70, 128
    buffer_load_dwordx4 v124, s[32:35], s70 offen offset:0 lds
    buffer_load_dwordx4 v125, s[32:35], s70 offen offset:1024 lds
    buffer_load_dwordx4 v126, s[32:35], s70 offen offset:2048 lds
    buffer_load_dwordx4 v127, s[32:35], s70 offen offset:3072 lds
    s_and_b32 s91, s91, 3
    s_lshl_b32 s70, s91, 12
    s_add_u32 m0, s70, s93
    s_xor_b32 s70, s91, s71
    s_lshl_b32 s70, s70, 15
    s_add_u32 s70, s70, s92
    s_add_u32 s91, s91, 1
    buffer_load_dwordx4 v124, s[32:35], s70 offen offset:0 lds
    buffer_load_dwordx4 v125, s[32:35], s70 offen offset:1024 lds
    buffer_load_dwordx4 v126, s[32:35], s70 offen offset:2048 lds
    buffer_load_dwordx4 v127, s[32:35], s70 offen offset:3072 lds
    s_add_u32 m0, m0, 16384
    s_add_u32 s70, s70, 128
    buffer_load_dwordx4 v124, s[32:35], s70 offen offset:0 lds
    buffer_load_dwordx4 v125, s[32:35], s70 offen offset:1024 lds
    buffer_load_dwordx4 v126, s[32:35], s70 offen offset:2048 lds
    buffer_load_dwordx4 v127, s[32:35], s70 offen offset:3072 lds
    s_and_b32 s91, s91, 3
    s_lshl_b32 s70, s91, 12
    s_add_u32 m0, s70, s93
    s_xor_b32 s70, s91, s71
    s_lshl_b32 s70, s70, 15
    s_add_u32 s70, s70, s92
    s_add_u32 s91, s91, 1
    buffer_load_dwordx4 v124, s[32:35], s70 offen offset:0 lds
    buffer_load_dwordx4 v125, s[32:35], s70 offen offset:1024 lds
    buffer_load_dwordx4 v126, s[32:35], s70 offen offset:2048 lds
    buffer_load_dwordx4 v127, s[32:35], s70 offen offset:3072 lds
    s_add_u32 m0, m0, 16384
    s_add_u32 s70, s70, 128
    buffer_load_dwordx4 v124, s[32:35], s70 offen offset:0 lds
    buffer_load_dwordx4 v125, s[32:35], s70 offen offset:1024 lds
    buffer_load_dwordx4 v126, s[32:35], s70 offen offset:2048 lds
    buffer_load_dwordx4 v127, s[32:35], s70 offen offset:3072 lds
    v_lshrrev_b32 v10, 4, v0
    v_and_b32 v11, 15, v0
    s_lshl_b32 s64, s3, 11
    s_add_u32 s64, s64, 57344
    v_add_u32 v4, s64, v3
    v_lshrrev_b32 v5, 1, v11
    v_lshlrev_b32 v5, 14, v5
    v_lshl_add_u32 v5, v10, 4, v5
    v_and_b32 v16, 1, v0
    v_lshl_add_u32 v5, v16, 6, v5
    s_lshl_b32 s66, s7, 11
    s_lshl_b32 s67, s3, 9
    s_add_u32 s66, s66, s67
    v_add_u32 v5, s66, v5
    s_lshl_b32 s66, s3, 15
    s_add_u32 s66, s66, 32768
    v_add_u32 v12, s66, v3
    v_lshlrev_b32 v20, 16, v104
    v_and_b32 v21, s62, v104
    v_lshlrev_b32 v22, 16, v105
    v_and_b32 v23, s62, v105
    v_lshlrev_b32 v24, 16, v106
    v_and_b32 v25, s62, v106
    v_lshlrev_b32 v26, 16, v107
    v_and_b32 v27, s62, v107
    v_lshlrev_b32 v28, 16, v108
    v_and_b32 v29, s62, v108
    v_lshlrev_b32 v30, 16, v109
    v_and_b32 v31, s62, v109
    v_lshlrev_b32 v32, 16, v110
    v_and_b32 v33, s62, v110
    v_lshlrev_b32 v34, 16, v111
    v_and_b32 v35, s62, v111
    v_min_u32 v6, 15, v0
    v_lshlrev_b32 v6, 2, v6
    v_and_b32 v16, 7, v0
    v_xor_b32 v16, v16, v10
    v_lshlrev_b32 v16, 4, v16
    v_lshl_add_u32 v8, v11, 7, v16
    v_xor_b32 v13, 64, v8
    s_lshl1_add_u32 s64, s7, s3
    s_lshl_b32 s64, s64, 13
    v_lshl_add_u32 v7, v0, 7, s64
    v_xor_b32 v14, 0x800, v4
L_pb_7:
    s_branch L_pbt_7
.p2align 12
L_pbt_7:
    s_waitcnt vmcnt(0)
    s_lshl_b32 s64, s3, 15
    s_add_u32 s64, s64, 32768
    v_add_u32 v116, s64, v112
    v_add_u32 v117, s64, v113
    v_add_u32 v118, s64, v114
    v_add_u32 v119, s64, v115
    ds_read_b64_tr_b16 v[128:129], v116 offset:0
    ds_read_b64_tr_b16 v[130:131], v116 offset:2048
    ds_read_b64_tr_b16 v[132:133], v117 offset:0
    ds_read_b64_tr_b16 v[134:135], v117 offset:2048
    ds_read_b64_tr_b16 v[136:137], v118 offset:0
    ds_read_b64_tr_b16 v[138:139], v118 offset:2048
    ds_read_b64_tr_b16 v[140:141], v119 offset:0
    ds_read_b64_tr_b16 v[142:143], v119 offset:2048
    ds_read_b64_tr_b16 v[144:145], v116 offset:16384
    ds_read_b64_tr_b16 v[146:147], v116 offset:18432
    ds_read_b64_tr_b16 v[148:149], v117 offset:16384
    ds_read_b64_tr_b16 v[150:151], v117 offset:18432
    ds_read_b64_tr_b16 v[152:153], v118 offset:16384
    ds_read_b64_tr_b16 v[154:155], v118 offset:18432
    ds_read_b64_tr_b16 v[156:157], v119 offset:16384
    ds_read_b64_tr_b16 v[158:159], v119 offset:18432
    ds_read_b64_tr_b16 v[160:161], v116 offset:4096
    ds_read_b64_tr_b16 v[162:163], v116 offset:6144
    ds_read_b64_tr_b16 v[164:165], v117 offset:4096
    ds_read_b64_tr_b16 v[166:167], v117 offset:6144
    ds_read_b64_tr_b16 v[168:169], v118 offset:4096
    ds_read_b64_tr_b16 v[170:171], v118 offset:6144
    ds_read_b64_tr_b16 v[172:173], v119 offset:4096
    ds_read_b64_tr_b16 v[174:175], v119 offset:6144
    ds_read_b64_tr_b16 v[176:177], v116 offset:20480
    ds_read_b64_tr_b16 v[178:179], v116 offset:22528
    ds_read_b64_tr_b16 v[180:181], v117 offset:20480
    ds_read_b64_tr_b16 v[182:183], v117 offset:22528
    ds_read_b64_tr_b16 v[184:185], v118 offset:20480
    ds_read_b64_tr_b16 v[186:187], v118 offset:22528
    ds_read_b64_tr_b16 v[188:189], v119 offset:20480
    ds_read_b64_tr_b16 v[190:191], v119 offset:22528
    ds_read_b64_tr_b16 v[192:193], v116 offset:8192
    ds_read_b64_tr_b16 v[194:195], v116 offset:10240
    ds_read_b64_tr_b16 v[196:197], v117 offset:8192
    ds_read_b64_tr_b16 v[198:199], v117 offset:10240
    ds_read_b64_tr_b16 v[200:201], v118 offset:8192
    ds_read_b64_tr_b16 v[202:203], v118 offset:10240
    ds_read_b64_tr_b16 v[204:205], v119 offset:8192
    ds_read_b64_tr_b16 v[206:207], v119 offset:10240
    ds_read_b64_tr_b16 v[208:209], v116 offset:24576
    ds_read_b64_tr_b16 v[210:211], v116 offset:26624
    ds_read_b64_tr_b16 v[212:213], v117 offset:24576
    ds_read_b64_tr_b16 v[214:215], v117 offset:26624
    ds_read_b64_tr_b16 v[216:217], v118 offset:24576
    ds_read_b64_tr_b16 v[218:219], v118 offset:26624
    ds_read_b64_tr_b16 v[220:221], v119 offset:24576
    ds_read_b64_tr_b16 v[222:223], v119 offset:26624
    ds_read_b64_tr_b16 v[224:225], v116 offset:12288
    ds_read_b64_tr_b16 v[226:227], v116 offset:14336
    ds_read_b64_tr_b16 v[228:229], v117 offset:12288
    ds_read_b64_tr_b16 v[230:231], v117 offset:14336
    ds_read_b64_tr_b16 v[232:233], v118 offset:12288
    ds_read_b64_tr_b16 v[234:235], v118 offset:14336
    ds_read_b64_tr_b16 v[236:237], v119 offset:12288
    ds_read_b64_tr_b16 v[238:239], v119 offset:14336
    ds_read_b64_tr_b16 v[240:241], v116 offset:28672
    ds_read_b64_tr_b16 v[242:243], v116 offset:30720
    ds_read_b64_tr_b16 v[244:245], v117 offset:28672
    ds_read_b64_tr_b16 v[246:247], v117 offset:30720
    ds_read_b64_tr_b16 v[248:249], v118 offset:28672
    ds_read_b64_tr_b16 v[250:251], v118 offset:30720
    ds_read_b64_tr_b16 v[252:253], v119 offset:28672
    ds_read_b64_tr_b16 v[254:255], v119 offset:30720
    s_waitcnt lgkmcnt(0)
    s_cmp_lg_u32 s9, 0
    s_cbranch_scc1 L_slow_7
    s_mul_i32 s92, s7, 229376
    s_lshl_b32 s70, s3, 8
    s_add_u32 s92, s92, s70
    s_cmp_eq_u32 s3, 3
    s_cselect_b32 s77, 6, 4
    s_cselect_b32 s71, -1, 1
    s_add_u32 s77, s77, s100
    s_lshl_b32 s93, s3, 15
    s_add_u32 s93, s93, 32768
    s_and_b32 s91, s6, 3
    s_cmp_ge_u32 s91, 3
    s_cselect_b32 s91, 0, s91
    s_lshl_b32 s70, s91, 12
    s_add_u32 m0, s70, s93
    s_mul_i32 s70, s91, s71
    s_add_u32 s70, s70, s77
    s_cmp_eq_u32 s70, 7
    s_cselect_b32 s70, 0, s70
    s_lshl_b32 s70, s70, 15
    s_add_u32 s70, s70, s92
    s_add_u32 s91, s91, 1
    buffer_load_dwordx4 v124, s[32:35], s70 offen offset:0 lds
    buffer_load_dwordx4 v125, s[32:35], s70 offen offset:1024 lds
    buffer_load_dwordx4 v126, s[32:35], s70 offen offset:2048 lds
    buffer_load_dwordx4 v127, s[32:35], s70 offen offset:3072 lds
    s_add_u32 m0, m0, 12288
    s_add_u32 s70, s70, 128
    buffer_load_dwordx4 v124, s[32:35], s70 offen offset:0 lds
    buffer_load_dwordx4 v125, s[32:35], s70 offen offset:1024 lds
    buffer_load_dwordx4 v126, s[32:35], s70 offen offset:2048 lds
    buffer_load_dwordx4 v127, s[32:35], s70 offen offset:3072 lds
    s_cmp_ge_u32 s91, 3
    s_cselect_b32 s91, 0, s91
    s_lshl_b32 s70, s91, 12
    s_add_u32 m0, s70, s93
    s_mul_i32 s70, s91, s71
    s_add_u32 s70, s70, s77
    s_cmp_eq_u32 s70, 7
    s_cselect_b32 s70, 0, s70
    s_lshl_b32 s70, s70, 15
    s_add_u32 s70, s70, s92
    s_add_u32 s91, s91, 1
    buffer_load_dwordx4 v124, s[32:35], s70 offen offset:0 lds
    buffer_load_dwordx4 v125, s[32:35], s70 offen offset:1024 lds
    buffer_load_dwordx4 v126, s[32:35], s70 offen offset:2048 lds
    buffer_load_dwordx4 v127, s[32:35], s70 offen offset:3072 lds
    s_add_u32 m0, m0, 12288
    s_add_u32 s70, s70, 128
    buffer_load_dwordx4 v124, s[32:35], s70 offen offset:0 lds
    buffer_load_dwordx4 v125, s[32:35], s70 offen offset:1024 lds
    buffer_load_dwordx4 v126, s[32:35], s70 offen offset:2048 lds
    buffer_load_dwordx4 v127, s[32:35], s70 offen offset:3072 lds
    s_cmp_ge_u32 s91, 3
    s_cselect_b32 s91, 0, s91
    s_lshl_b32 s70, s91, 12
    s_add_u32 m0, s70, s93
    s_mul_i32 s70, s91, s71
    s_add_u32 s70, s70, s77
    s_cmp_eq_u32 s70, 7
    s_cselect_b32 s70, 0, s70
    s_lshl_b32 s70, s70, 15
    s_add_u32 s70, s70, s92
    s_add_u32 s91, s91, 1
    buffer_load_dwordx4 v124, s[32:35], s70 offen offset:0 lds
    buffer_load_dwordx4 v125, s[32:35], s70 offen offset:1024 lds
    buffer_load_dwordx4 v126, s[32:35], s70 offen offset:2048 lds
    buffer_load_dwordx4 v127, s[32:35], s70 offen offset:3072 lds
    s_add_u32 m0, m0, 12288
    s_add_u32 s70, s70, 128
    buffer_load_dwordx4 v124, s[32:35], s70 offen offset:0 lds
    buffer_load_dwordx4 v125, s[32:35], s70 offen offset:1024 lds
    buffer_load_dwordx4 v126, s[32:35], s70 offen offset:2048 lds
    buffer_load_dwordx4 v127, s[32:35], s70 offen offset:3072 lds
L_pb_8:
    s_waitcnt vmcnt(0)
    ds_read_b64_tr_b16 v[36:37], v116 offset:0
    ds_read_b64_tr_b16 v[38:39], v116 offset:2048
    ds_read_b64_tr_b16 v[40:41], v117 offset:0
    ds_read_b64_tr_b16 v[42:43], v117 offset:2048
    ds_read_b64_tr_b16 v[44:45], v118 offset:0
    ds_read_b64_tr_b16 v[46:47], v118 offset:2048
    ds_read_b64_tr_b16 v[48:49], v119 offset:0
    ds_read_b64_tr_b16 v[50:51], v119 offset:2048
    ds_read_b64_tr_b16 v[52:53], v116 offset:4096
    ds_read_b64_tr_b16 v[54:55], v116 offset:6144
    ds_read_b64_tr_b16 v[56:57], v117 offset:4096
    ds_read_b64_tr_b16 v[58:59], v117 offset:6144
    ds_read_b64_tr_b16 v[60:61], v118 offset:4096
    ds_read_b64_tr_b16 v[62:63], v118 offset:6144
    ds_read_b64_tr_b16 v[64:65], v119 offset:4096
    ds_read_b64_tr_b16 v[66:67], v119 offset:6144
    ds_read_b64_tr_b16 v[68:69], v116 offset:8192
    ds_read_b64_tr_b16 v[70:71], v116 offset:10240
    ds_read_b64_tr_b16 v[72:73], v117 offset:8192
    ds_read_b64_tr_b16 v[74:75], v117 offset:10240
    ds_read_b64_tr_b16 v[76:77], v118 offset:8192
    ds_read_b64_tr_b16 v[78:79], v118 offset:10240
    ds_read_b64_tr_b16 v[80:81], v119 offset:8192
    ds_read_b64_tr_b16 v[82:83], v119 offset:10240
    s_waitcnt lgkmcnt(15)
    v_mov_b32 v11, v51
    ds_write_b128 v12, v[36:39] offset:0
    ds_write_b128 v12, v[40:43] offset:1024
    ds_write_b128 v12, v[44:47] offset:2048
    ds_write_b128 v12, v[48:51] offset:3072
    ds_read_b64_tr_b16 v[36:37], v116 offset:12288
    ds_read_b64_tr_b16 v[38:39], v116 offset:14336
    ds_read_b64_tr_b16 v[40:41], v117 offset:12288
    ds_read_b64_tr_b16 v[42:43], v117 offset:14336
    ds_read_b64_tr_b16 v[44:45], v118 offset:12288
    ds_read_b64_tr_b16 v[46:47], v118 offset:14336
    ds_read_b64_tr_b16 v[48:49], v119 offset:12288
    ds_read_b64_tr_b16 v[50:51], v119 offset:14336
    s_waitcnt lgkmcnt(15)
    v_mov_b32 v11, v67
    ds_write_b128 v12, v[52:55] offset:4096
    ds_write_b128 v12, v[56:59] offset:5120
    ds_write_b128 v12, v[60:63] offset:6144
    ds_write_b128 v12, v[64:67] offset:7168
    ds_read_b64_tr_b16 v[52:53], v116 offset:16384
    ds_read_b64_tr_b16 v[54:55], v116 offset:18432
    ds_read_b64_tr_b16 v[56:57], v117 offset:16384
    ds_read_b64_tr_b16 v[58:59], v117 offset:18432
    ds_read_b64_tr_b16 v[60:61], v118 offset:16384
    ds_read_b64_tr_b16 v[62:63], v118 offset:18432
    ds_read_b64_tr_b16 v[64:65], v119 offset:16384
    ds_read_b64_tr_b16 v[66:67], v119 offset:18432
    s_waitcnt lgkmcnt(15)
    v_mov_b32 v11, v83
    ds_write_b128 v12, v[68:71] offset:8192
    ds_write_b128 v12, v[72:75] offset:9216
    ds_write_b128 v12, v[76:79] offset:10240
    ds_write_b128 v12, v[80:83] offset:11264
    ds_read_b64_tr_b16 v[68:69], v116 offset:20480
    ds_read_b64_tr_b16 v[70:71], v116 offset:22528
    ds_read_b64_tr_b16 v[72:73], v117 offset:20480
    ds_read_b64_tr_b16 v[74:75], v117 offset:22528
    ds_read_b64_tr_b16 v[76:77], v118 offset:20480
    ds_read_b64_tr_b16 v[78:79], v118 offset:22528
    ds_read_b64_tr_b16 v[80:81], v119 offset:20480
    ds_read_b64_tr_b16 v[82:83], v119 offset:22528
    s_waitcnt lgkmcnt(15)
    v_mov_b32 v11, v51
    ds_write_b128 v12, v[36:39] offset:12288
    ds_write_b128 v12, v[40:43] offset:13312
    ds_write_b128 v12, v[44:47] offset:14336
    ds_write_b128 v12, v[48:51] offset:15360
    s_waitcnt lgkmcnt(15)
    v_mov_b32 v11, v67
    ds_write_b128 v12, v[52:55] offset:16384
    ds_write_b128 v12, v[56:59] offset:17408
    ds_write_b128 v12, v[60:63] offset:18432
    ds_write_b128 v12, v[64:67] offset:19456
    s_waitcnt lgkmcnt(8)
    v_mov_b32 v11, v83
    ds_write_b128 v12, v[68:71] offset:20480
    ds_write_b128 v12, v[72:75] offset:21504
    ds_write_b128 v12, v[76:79] offset:22528
    ds_write_b128 v12, v[80:83] offset:23552
    s_lshl_b32 s64, s3, 13
    s_add_u32 m0, s64, 0
    s_mov_b32 s65, 50176
    s_mov_b32 s10, 400000
L_poll_8:
    buffer_load_dword v11, v6, s[20:23], s65 offen offset:0 sc1
    s_waitcnt vmcnt(0)
    v_cmp_ne_u32 vcc, s8, v11
    s_nop 0
    s_cbranch_vccz L_polld_9
    s_sub_u32 s10, s10, 1
    s_cmp_lg_u32 s10, 0
    s_nop 0
    s_cbranch_scc1 L_poll_8
L_polld_9:
    buffer_load_dwordx4 v3, s[20:23], s64 offen offset:0 sc1 lds
    buffer_load_dwordx4 v3, s[20:23], s64 offen offset:1024 sc1 lds
    buffer_load_dwordx4 v3, s[20:23], s64 offen offset:2048 sc1 lds
    buffer_load_dwordx4 v3, s[20:23], s64 offen offset:3072 sc1 lds
    s_add_u32 s64, s64, 4096
    s_add_u32 m0, m0, 4096
    s_nop 0
    buffer_load_dwordx4 v3, s[20:23], s64 offen offset:0 sc1 lds
    buffer_load_dwordx4 v3, s[20:23], s64 offen offset:1024 sc1 lds
    buffer_load_dwordx4 v3, s[20:23], s64 offen offset:2048 sc1 lds
    buffer_load_dwordx4 v3, s[20:23], s64 offen offset:3072 sc1 lds
L_pb_9:
    s_waitcnt vmcnt(0)
    s_mov_b32 s80, 0
    s_mov_b32 s94, 0
    s_mov_b32 s82, 2146435072
    s_mov_b32 s83, 2146435072
    s_lshl2_add_u32 s90, s7, s3
    s_lshl_b32 s90, s90, 2
    s_add_u32 s90, s90, 49152
    s_lshl_b32 s88, s3, 13
    s_mov_b32 s87, s88
    s_mov_b32 s71, s88
    s_mov_b32 s85, 50176
    s_mov_b32 s89, 0x20000
L_pb_10:
    s_waitcnt vmcnt(0) lgkmcnt(0)
    s_barrier
    ds_read_b128 v[84:87], v8 offset:0
    ds_read_b128 v[88:91], v13 offset:0
    s_waitcnt lgkmcnt(0)
L_pass_10:
    ds_read_b128 v[92:95], v8 offset:2048
    s_add_u32 s85, s85, 128
    v_mfma_f32_16x16x32_bf16 v[36:39], a[0:3], v[84:87], v[20:23]
    ds_read_b128 v[96:99], v13 offset:2048
    v_mfma_f32_16x16x32_bf16 v[40:43], a[64:67], v[84:87], v[24:27]
    ds_read_b128 v[100:103], v8 offset:4096
    v_mfma_f32_16x16x32_bf16 v[44:47], a[128:131], v[84:87], v[28:31]
    v_cvt_pk_bf16_f32 v64, v64, v65
    s_add_u32 s87, s87, 16384
    s_cmp_ge_u32 s87, 49152
    s_cselect_b32 s87, s71, s87
    v_mfma_f32_16x16x32_bf16 v[48:51], a[192:195], v[84:87], v[32:35]
    v_cvt_pk_bf16_f32 v65, v66, v67
    s_add_u32 s86, s87, 4096
    s_waitcnt lgkmcnt(3)
    v_mfma_f32_16x16x32_bf16 v[36:39], a[4:7], v[88:91], v[36:39]
    v_cvt_pk_bf16_f32 v66, v80, v81
    s_xor_b32 s88, s88, 0x4000
    s_mov_b32 m0, s88
    v_mfma_f32_16x16x32_bf16 v[40:43], a[68:71], v[88:91], v[40:43]
    ds_read_b128 v[84:87], v13 offset:4096
    v_cvt_pk_bf16_f32 v67, v82, v83
    v_mfma_f32_16x16x32_bf16 v[44:47], a[132:135], v[88:91], v[44:47]
    s_bitcmp1_b32 6, s80
    s_cbranch_scc1 L_pss_11
    buffer_store_dwordx4 v[64:67], v5, s[44:47], s82 offen offset:384
L_psb_12:
    v_mfma_f32_16x16x32_bf16 v[48:51], a[196:199], v[88:91], v[48:51]
    s_waitcnt lgkmcnt(2)
    v_mfma_f32_16x16x32_bf16 v[36:39], a[8:11], v[92:95], v[36:39]
    v_mfma_f32_16x16x32_bf16 v[40:43], a[72:75], v[92:95], v[40:43]
    ds_read_b128 v[88:91], v8 offset:6144
    v_mfma_f32_16x16x32_bf16 v[44:47], a[136:139], v[92:95], v[44:47]
    v_mfma_f32_16x16x32_bf16 v[48:51], a[200:203], v[92:95], v[48:51]
    ds_read_b128 v[92:95], v13 offset:6144
    v_mfma_f32_16x16x32_bf16 v[36:39], a[12:15], v[96:99], v[36:39]
    v_mfma_f32_16x16x32_bf16 v[40:43], a[76:79], v[96:99], v[40:43]
    ds_read_b128 v[104:107], v8 offset:8192
    v_mfma_f32_16x16x32_bf16 v[44:47], a[140:143], v[96:99], v[44:47]
    v_mfma_f32_16x16x32_bf16 v[48:51], a[204:207], v[96:99], v[48:51]
    ds_read_b128 v[96:99], v13 offset:8192
    s_waitcnt lgkmcnt(4)
    v_mfma_f32_16x16x32_bf16 v[36:39], a[16:19], v[100:103], v[36:39]
    v_mfma_f32_16x16x32_bf16 v[40:43], a[80:83], v[100:103], v[40:43]
    ds_read_b128 v[108:111], v8 offset:10240
    v_mfma_f32_16x16x32_bf16 v[44:47], a[144:147], v[100:103], v[44:47]
    v_mfma_f32_16x16x32_bf16 v[48:51], a[208:211], v[100:103], v[48:51]
    ds_read_b128 v[100:103], v13 offset:10240
    v_mfma_f32_16x16x32_bf16 v[36:39], a[20:23], v[84:87], v[36:39]
    v_mfma_f32_16x16x32_bf16 v[40:43], a[84:87], v[84:87], v[40:43]
    ds_read_b128 v[112:115], v8 offset:12288
    v_mfma_f32_16x16x32_bf16 v[44:47], a[148:151], v[84:87], v[44:47]
    v_mfma_f32_16x16x32_bf16 v[48:51], a[212:215], v[84:87], v[48:51]
    ds_read_b128 v[84:87], v13 offset:12288
    s_waitcnt lgkmcnt(6)
    v_mfma_f32_16x16x32_bf16 v[36:39], a[24:27], v[88:91], v[36:39]
    v_mfma_f32_16x16x32_bf16 v[40:43], a[88:91], v[88:91], v[40:43]
    ds_read_b128 v[116:119], v8 offset:14336
    v_mfma_f32_16x16x32_bf16 v[36:39], a[28:31], v[92:95], v[36:39]
    v_mfma_f32_16x16x32_bf16 v[40:43], a[92:95], v[92:95], v[40:43]
    ds_read_b128 v[120:123], v13 offset:14336
    s_waitcnt lgkmcnt(6)
    v_mfma_f32_16x16x32_bf16 v[36:39], a[32:35], v[104:107], v[36:39]
    v_mfma_f32_16x16x32_bf16 v[40:43], a[96:99], v[104:107], v[40:43]
    v_mfma_f32_16x16x32_bf16 v[36:39], a[36:39], v[96:99], v[36:39]
    v_mfma_f32_16x16x32_bf16 v[40:43], a[100:103], v[96:99], v[40:43]
    s_waitcnt vmcnt(0)
    buffer_store_dword v1, v2, s[20:23], s83 offen
    s_waitcnt lgkmcnt(4)
    v_mfma_f32_16x16x32_bf16 v[36:39], a[40:43], v[108:111], v[36:39]
    s_and_b32 s64, s80, 1
    v_mfma_f32_16x16x32_bf16 v[40:43], a[104:107], v[108:111], v[40:43]
    buffer_load_dword v11, v6, s[20:23], s85 offen offset:0 sc1
    s_lshl_b32 s82, s64, 17
    v_mfma_f32_16x16x32_bf16 v[36:39], a[44:47], v[100:103], v[36:39]
    s_lshl_b32 s64, s80, 7
    v_mfma_f32_16x16x32_bf16 v[40:43], a[108:111], v[100:103], v[40:43]
    s_waitcnt lgkmcnt(2)
    s_add_u32 s83, s64, s90
    v_mfma_f32_16x16x32_bf16 v[36:39], a[48:51], v[112:115], v[36:39]
    v_mfma_f32_16x16x32_bf16 v[40:43], a[112:115], v[112:115], v[40:43]
    v_mfma_f32_16x16x32_bf16 v[36:39], a[52:55], v[84:87], v[36:39]
    v_mfma_f32_16x16x32_bf16 v[40:43], a[116:119], v[84:87], v[40:43]
    s_waitcnt lgkmcnt(0)
    v_mfma_f32_16x16x32_bf16 v[36:39], a[56:59], v[116:119], v[36:39]
    v_mfma_f32_16x16x32_bf16 v[40:43], a[120:123], v[116:119], v[40:43]
    v_mfma_f32_16x16x32_bf16 v[36:39], a[60:63], v[120:123], v[36:39]
    v_mfma_f32_16x16x32_bf16 v[40:43], a[124:127], v[120:123], v[40:43]
    s_nop 2
    v_mfma_f32_16x16x32_bf16 v[44:47], a[152:155], v[88:91], v[44:47]
    s_nop 1
    v_mfma_f32_16x16x32_bf16 v[44:47], a[156:159], v[92:95], v[44:47]
    v_mul_f32_e64 v36, v36, |v36|
    v_mul_f32_e64 v37, v37, |v37|
    v_mfma_f32_16x16x32_bf16 v[44:47], a[160:163], v[104:107], v[44:47]
    v_mul_f32_e64 v38, v38, |v38|
    v_mul_f32_e64 v39, v39, |v39|
    v_mfma_f32_16x16x32_bf16 v[44:47], a[164:167], v[96:99], v[44:47]
    v_cvt_pk_bf16_f32 v36, v36, v37
    v_cvt_pk_bf16_f32 v37, v38, v39
    v_mfma_f32_16x16x32_bf16 v[44:47], a[168:171], v[108:111], v[44:47]
    v_pk_max_i16 v36, v36, 0
    v_pk_max_i16 v37, v37, 0
    v_mfma_f32_16x16x32_bf16 v[44:47], a[172:175], v[100:103], v[44:47]
    v_mul_f32_e64 v40, v40, |v40|
    v_mul_f32_e64 v41, v41, |v41|
    v_mfma_f32_16x16x32_bf16 v[44:47], a[176:179], v[112:115], v[44:47]
    v_mul_f32_e64 v42, v42, |v42|
    v_mul_f32_e64 v43, v43, |v43|
    v_mfma_f32_16x16x32_bf16 v[44:47], a[180:183], v[84:87], v[44:47]
    v_cvt_pk_bf16_f32 v38, v40, v41
    v_cvt_pk_bf16_f32 v39, v42, v43
    v_mfma_f32_16x16x32_bf16 v[44:47], a[184:187], v[116:119], v[44:47]
    v_pk_max_i16 v38, v38, 0
    v_pk_max_i16 v39, v39, 0
    v_mfma_f32_16x16x32_bf16 v[44:47], a[188:191], v[120:123], v[44:47]
    ds_write_b128 v4, v[36:39]
    v_mfma_f32_16x16x32_bf16 v[48:51], a[216:219], v[88:91], v[48:51]
    s_nop 2
    v_mfma_f32_16x16x32_bf16 v[48:51], a[220:223], v[92:95], v[48:51]
    s_nop 1
    v_mul_f32_e64 v44, v44, |v44|
    v_mfma_f32_16x16x32_bf16 v[48:51], a[224:227], v[104:107], v[48:51]
    v_mul_f32_e64 v45, v45, |v45|
    v_mul_f32_e64 v46, v46, |v46|
    v_mfma_f32_16x16x32_bf16 v[48:51], a[228:231], v[96:99], v[48:51]
    s_waitcnt vmcnt(0)
    v_cmp_ne_u32 vcc, s8, v11
    s_nop 0
    s_cbranch_vccnz L_ops_13
L_opb_14:
    v_mfma_f32_16x16x32_bf16 v[48:51], a[232:235], v[108:111], v[48:51]
    buffer_load_dwordx4 v3, s[20:23], s87 offen offset:0 sc1 lds
    v_mul_f32_e64 v47, v47, |v47|
    v_cvt_pk_bf16_f32 v44, v44, v45
    v_mfma_f32_16x16x32_bf16 v[48:51], a[236:239], v[100:103], v[48:51]
    v_cvt_pk_bf16_f32 v45, v46, v47
    v_pk_max_i16 v44, v44, 0
    v_mfma_f32_16x16x32_bf16 v[48:51], a[240:243], v[112:115], v[48:51]
    v_pk_max_i16 v45, v45, 0
    v_mfma_f32_16x16x32_bf16 v[48:51], a[244:247], v[84:87], v[48:51]
    buffer_load_dwordx4 v3, s[20:23], s87 offen offset:1024 sc1 lds
    v_mfma_f32_16x16x32_bf16 v[48:51], a[248:251], v[116:119], v[48:51]
    v_mfma_f32_16x16x32_bf16 v[48:51], a[252:255], v[120:123], v[48:51]
    s_nop 2
    v_mfma_f32_16x16x32_bf16 v[52:55], v[128:131], v[36:39], 0
    buffer_load_dwordx4 v3, s[20:23], s87 offen offset:2048 sc1 lds
    s_nop 1
    v_mfma_f32_16x16x32_bf16 v[56:59], v[132:135], v[36:39], 0
    v_mul_f32_e64 v48, v48, |v48|
    v_mul_f32_e64 v49, v49, |v49|
    v_mfma_f32_16x16x32_bf16 v[60:63], v[136:139], v[36:39], 0
    v_mul_f32_e64 v50, v50, |v50|
    v_mul_f32_e64 v51, v51, |v51|
    v_mfma_f32_16x16x32_bf16 v[64:67], v[140:143], v[36:39], 0
    buffer_load_dwordx4 v3, s[20:23], s87 offen offset:3072 sc1 lds
    s_add_u32 m0, m0, 4096
    v_cvt_pk_bf16_f32 v46, v48, v49
    v_mfma_f32_16x16x32_bf16 v[68:71], v[144:147], v[36:39], 0
    v_cvt_pk_bf16_f32 v47, v50, v51
    v_pk_max_i16 v46, v46, 0
    v_mfma_f32_16x16x32_bf16 v[72:75], v[148:151], v[36:39], 0
    v_pk_max_i16 v47, v47, 0
    v_mfma_f32_16x16x32_bf16 v[76:79], v[152:155], v[36:39], 0
    buffer_load_dwordx4 v3, s[20:23], s86 offen offset:0 sc1 lds
    v_mfma_f32_16x16x32_bf16 v[80:83], v[156:159], v[36:39], 0
    ds_write_b128 v4, v[44:47] offset:1024
    ds_read_b128 v[116:119], v12 offset:0
    v_mfma_f32_16x16x32_bf16 v[52:55], v[160:163], v[44:47], v[52:55]
    ds_read_b128 v[84:87], v12 offset:12288
    v_mfma_f32_16x16x32_bf16 v[56:59], v[164:167], v[44:47], v[56:59]
    s_waitcnt lgkmcnt(2)
    s_barrier
    buffer_load_dwordx4 v3, s[20:23], s86 offen offset:1024 sc1 lds
    ds_read_b128 v[120:123], v14 offset:0
    v_mfma_f32_16x16x32_bf16 v[60:63], v[168:171], v[44:47], v[60:63]
    ds_read_b128 v[112:115], v3 offset:61440
    v_mfma_f32_16x16x32_bf16 v[64:67], v[172:175], v[44:47], v[64:67]
    ds_read_b128 v[100:103], v14 offset:1024
    v_mfma_f32_16x16x32_bf16 v[68:71], v[176:179], v[44:47], v[68:71]
    buffer_load_dwordx4 v3, s[20:23], s86 offen offset:2048 sc1 lds
    ds_read_b128 v[108:111], v12 offset:4096
    v_mfma_f32_16x16x32_bf16 v[72:75], v[180:183], v[44:47], v[72:75]
    ds_read_b128 v[96:99], v3 offset:62464
    v_mfma_f32_16x16x32_bf16 v[76:79], v[184:187], v[44:47], v[76:79]
    ds_read_b128 v[104:107], v12 offset:16384
    v_mfma_f32_16x16x32_bf16 v[80:83], v[188:191], v[44:47], v[80:83]
    buffer_load_dwordx4 v3, s[20:23], s86 offen offset:3072 sc1 lds
    ds_read_b128 v[92:95], v12 offset:8192
    s_waitcnt lgkmcnt(6)
    v_mfma_f32_16x16x32_bf16 v[52:55], v[192:195], v[120:123], v[52:55]
    ds_read_b128 v[124:127], v3 offset:63488
    v_xor_b32 v8, 0x4000, v8
    v_mfma_f32_16x16x32_bf16 v[68:71], v[208:211], v[120:123], v[68:71]
    ds_read_b128 v[88:91], v12 offset:20480
    s_waitcnt lgkmcnt(7)
    v_mfma_f32_16x16x32_bf16 v[52:55], v[116:119], v[112:115], v[52:55]
    ds_read_b128 v[116:119], v12 offset:1024
    v_mfma_f32_16x16x32_bf16 v[68:71], v[84:87], v[112:115], v[68:71]
    ds_read_b128 v[84:87], v12 offset:13312
    s_waitcnt lgkmcnt(8)
    v_mfma_f32_16x16x32_bf16 v[52:55], v[224:227], v[100:103], v[52:55]
    v_xor_b32 v13, 0x4000, v13
    v_mfma_f32_16x16x32_bf16 v[68:71], v[240:243], v[100:103], v[68:71]
    s_waitcnt lgkmcnt(5)
    v_mfma_f32_16x16x32_bf16 v[52:55], v[108:111], v[96:99], v[52:55]
    ds_read_b128 v[108:111], v12 offset:5120
    v_mfma_f32_16x16x32_bf16 v[68:71], v[104:107], v[96:99], v[68:71]
    ds_read_b128 v[104:107], v12 offset:17408
    s_waitcnt lgkmcnt(4)
    v_mfma_f32_16x16x32_bf16 v[52:55], v[92:95], v[124:127], v[52:55]
    ds_read_b128 v[92:95], v12 offset:9216
    v_mfma_f32_16x16x32_bf16 v[68:71], v[88:91], v[124:127], v[68:71]
    ds_read_b128 v[88:91], v12 offset:21504
    v_mfma_f32_16x16x32_bf16 v[56:59], v[196:199], v[120:123], v[56:59]
    v_mfma_f32_16x16x32_bf16 v[72:75], v[212:215], v[120:123], v[72:75]
    s_waitcnt lgkmcnt(4)
    v_mfma_f32_16x16x32_bf16 v[56:59], v[116:119], v[112:115], v[56:59]
    ds_read_b128 v[116:119], v12 offset:2048
    v_cvt_pk_bf16_f32 v52, v52, v53
    v_mfma_f32_16x16x32_bf16 v[72:75], v[84:87], v[112:115], v[72:75]
    ds_read_b128 v[84:87], v12 offset:14336
    v_cvt_pk_bf16_f32 v53, v54, v55
    v_mfma_f32_16x16x32_bf16 v[56:59], v[228:231], v[100:103], v[56:59]
    v_cvt_pk_bf16_f32 v54, v68, v69
    v_mfma_f32_16x16x32_bf16 v[72:75], v[244:247], v[100:103], v[72:75]
    s_waitcnt lgkmcnt(4)
    v_cvt_pk_bf16_f32 v55, v70, v71
    v_mfma_f32_16x16x32_bf16 v[56:59], v[108:111], v[96:99], v[56:59]
    s_bitcmp1_b32 3, s80
    s_cbranch_scc1 L_pss_15
    buffer_store_dwordx4 v[52:55], v5, s[44:47], s82 offen offset:0
L_psb_16:
    ds_read_b128 v[108:111], v12 offset:6144
    v_mfma_f32_16x16x32_bf16 v[72:75], v[104:107], v[96:99], v[72:75]
    ds_read_b128 v[104:107], v12 offset:18432
    s_waitcnt lgkmcnt(4)
    v_mfma_f32_16x16x32_bf16 v[56:59], v[92:95], v[124:127], v[56:59]
    ds_read_b128 v[92:95], v12 offset:10240
    v_mfma_f32_16x16x32_bf16 v[72:75], v[88:91], v[124:127], v[72:75]
    ds_read_b128 v[88:91], v12 offset:22528
    v_mfma_f32_16x16x32_bf16 v[60:63], v[200:203], v[120:123], v[60:63]
    v_mfma_f32_16x16x32_bf16 v[76:79], v[216:219], v[120:123], v[76:79]
    s_waitcnt lgkmcnt(4)
    v_mfma_f32_16x16x32_bf16 v[60:63], v[116:119], v[112:115], v[60:63]
    ds_read_b128 v[116:119], v12 offset:3072
    v_cvt_pk_bf16_f32 v56, v56, v57
    v_mfma_f32_16x16x32_bf16 v[76:79], v[84:87], v[112:115], v[76:79]
    s_waitcnt vmcnt(1)
    s_barrier
    v_cvt_pk_bf16_f32 v57, v58, v59
    v_mfma_f32_16x16x32_bf16 v[60:63], v[232:235], v[100:103], v[60:63]
    v_cvt_pk_bf16_f32 v58, v72, v73
    v_mfma_f32_16x16x32_bf16 v[76:79], v[248:251], v[100:103], v[76:79]
    s_waitcnt lgkmcnt(3)
    v_cvt_pk_bf16_f32 v59, v74, v75
    v_mfma_f32_16x16x32_bf16 v[60:63], v[108:111], v[96:99], v[60:63]
    s_bitcmp1_b32 3, s80
    s_cbranch_scc1 L_pss_17
    buffer_store_dwordx4 v[56:59], v5, s[44:47], s82 offen offset:128
L_psb_18:
    ds_read_b128 v[108:111], v12 offset:15360
    v_mfma_f32_16x16x32_bf16 v[76:79], v[104:107], v[96:99], v[76:79]
    ds_read_b128 v[104:107], v12 offset:7168
    s_waitcnt lgkmcnt(3)
    v_mfma_f32_16x16x32_bf16 v[60:63], v[92:95], v[124:127], v[60:63]
    ds_read_b128 v[92:95], v12 offset:19456
    v_mfma_f32_16x16x32_bf16 v[76:79], v[88:91], v[124:127], v[76:79]
    v_mfma_f32_16x16x32_bf16 v[64:67], v[204:207], v[120:123], v[64:67]
    v_mfma_f32_16x16x32_bf16 v[80:83], v[220:223], v[120:123], v[80:83]
    ds_read_b128 v[120:123], v12 offset:11264
    ds_read_b128 v[84:87], v8 offset:0
    s_waitcnt lgkmcnt(4)
    v_mfma_f32_16x16x32_bf16 v[64:67], v[116:119], v[112:115], v[64:67]
    ds_read_b128 v[116:119], v12 offset:23552
    v_cvt_pk_bf16_f32 v60, v60, v61
    v_mfma_f32_16x16x32_bf16 v[80:83], v[108:111], v[112:115], v[80:83]
    ds_read_b128 v[88:91], v13 offset:0
    v_cvt_pk_bf16_f32 v61, v62, v63
    v_mfma_f32_16x16x32_bf16 v[64:67], v[236:239], v[100:103], v[64:67]
    v_cvt_pk_bf16_f32 v62, v76, v77
    v_mfma_f32_16x16x32_bf16 v[80:83], v[252:255], v[100:103], v[80:83]
    s_waitcnt lgkmcnt(4)
    v_cvt_pk_bf16_f32 v63, v78, v79
    v_mfma_f32_16x16x32_bf16 v[64:67], v[104:107], v[96:99], v[64:67]
    s_bitcmp1_b32 3, s80
    s_cbranch_scc1 L_pss_19
    buffer_store_dwordx4 v[60:63], v5, s[44:47], s82 offen offset:256
L_psb_20:
    v_mfma_f32_16x16x32_bf16 v[80:83], v[92:95], v[96:99], v[80:83]
    s_waitcnt lgkmcnt(1)
    v_mfma_f32_16x16x32_bf16 v[64:67], v[120:123], v[124:127], v[64:67]
    v_mfma_f32_16x16x32_bf16 v[80:83], v[116:119], v[124:127], v[80:83]
    s_add_u32 s80, s80, 1
    s_cmp_lt_u32 s80, 8
    s_cbranch_scc1 L_pass_10
    s_nop 3
    v_cvt_pk_bf16_f32 v64, v64, v65
    v_cvt_pk_bf16_f32 v65, v66, v67
    v_cvt_pk_bf16_f32 v66, v80, v81
    v_cvt_pk_bf16_f32 v67, v82, v83
    buffer_store_dwordx4 v[64:67], v5, s[44:47], s82 offen offset:384
    s_waitcnt vmcnt(0)
    buffer_store_dword v1, v2, s[20:23], s83 offen
    s_waitcnt vmcnt(0)
    s_endpgm
L_pe_11:
L_pss_11:
    buffer_store_dwordx4 v[64:67], v5, s[44:47], s82 offen offset:384 sc1
    s_branch L_psb_12
L_ops_13:
    s_add_u32 s94, s94, 1
    s_mov_b32 s10, 400000
L_ops_13_l:
    buffer_load_dword v11, v6, s[20:23], s85 offen offset:0 sc1
    s_waitcnt vmcnt(0)
    v_cmp_ne_u32 vcc, s8, v11
    s_nop 1
    s_cbranch_vccz L_opb_14
    s_sub_u32 s10, s10, 1
    s_cmp_lg_u32 s10, 0
    s_cbranch_scc1 L_ops_13_l
    s_branch L_opb_14
L_pss_15:
    buffer_store_dwordx4 v[52:55], v5, s[44:47], s82 offen offset:0 sc1
    s_branch L_psb_16
L_pss_17:
    buffer_store_dwordx4 v[56:59], v5, s[44:47], s82 offen offset:128 sc1
    s_branch L_psb_18
L_pss_19:
    buffer_store_dwordx4 v[60:63], v5, s[44:47], s82 offen offset:256 sc1
    s_branch L_psb_20
.p2align 12
L_roleB:
    s_lshl_b32 s67, s4, 6
    s_lshl1_add_u32 s67, s5, s67
    s_add_u32 s67, s67, s99
    s_lshl_b32 s65, s67, 12
    v_lshlrev_b32 v4, 4, v0
    v_lshrrev_b32 v10, 3, v0
    v_bfe_u32 v11, v0, 1, 2
    v_bfe_u32 v12, v0, 4, 2
    v_xor_b32 v11, v11, v12
    v_and_b32 v12, 1, v0
    v_lshlrev_b32 v12, 4, v12
    v_lshl_add_u32 v11, v11, 5, v12
    s_movk_i32 s64, 3584
    v_mad_u32_u24 v120, v10, s64, v11
    v_add_u32 v121, 27648, v120
    v_add_u32 v122, 55296, v120
    v_add_u32 v123, 82944, v120
    s_waitcnt lgkmcnt(0)
    buffer_load_dwordx4 v[16:19], v4, s[24:27], s65 offen offset:0
    buffer_load_dword v32, v4, s[24:27], s65 offen offset:16
    buffer_load_dwordx4 v[20:23], v4, s[24:27], s65 offen offset:1024
    buffer_load_dword v33, v4, s[24:27], s65 offen offset:1040
    buffer_load_dwordx4 v[24:27], v4, s[24:27], s65 offen offset:2048
    buffer_load_dword v34, v4, s[24:27], s65 offen offset:2064
    buffer_load_dwordx4 v[28:31], v4, s[24:27], s65 offen offset:3072
    buffer_load_dword v35, v4, s[24:27], s65 offen offset:3088
    s_load_dword s8, s[12:13], 0
    s_load_dwordx2 s[52:53], s[0:1], 64
    s_load_dwordx2 s[36:37], s[0:1], 0
    s_load_dwordx2 s[56:57], s[0:1], 80
    s_load_dwordx2 s[40:41], s[0:1], 88
    s_load_dwordx2 s[60:61], s[0:1], 40
    s_mul_i32 s76, s6, 262144
    s_add_u32 s76, s76, 6291456
    s_add_u32 s44, s12, s76
    s_addc_u32 s45, s13, 0
    s_lshl_b32 s76, s6, 16
    s_add_u32 s76, s76, 2097152
    s_add_u32 s20, s12, s76
    s_addc_u32 s21, s13, 0
    s_mov_b32 s22, 65536
    s_lshl_b32 s71, s3, 7
    s_lshl_b32 s68, s100, 9
    s_sub_u32 s68, 384, s68
    s_cmp_eq_u32 s3, 3
    s_cselect_b32 s71, s68, s71
    s_add_u32 s71, s71, s101
    s_lshl_b32 s68, s99, 7
    s_add_u32 s68, s68, s101
    s_sub_u32 s71, s71, s68
    s_lshl_b32 s69, s99, 15
    s_add_u32 s69, s69, 32768
    s_lshl1_add_u32 s91, s6, 0
    s_mov_b32 s81, 2
L_dmai_26:
    s_and_b32 s91, s91, 7
    s_lshl_b32 s70, s91, 12
    s_add_u32 m0, s70, s69
    s_mul_i32 s70, s91, 114688
    s_add_u32 s70, s70, s68
    buffer_load_dwordx4 v120, s[28:31], s70 offen offset:0 lds
    buffer_load_dwordx4 v121, s[28:31], s70 offen offset:1024 lds
    buffer_load_dwordx4 v122, s[28:31], s70 offen offset:2048 lds
    buffer_load_dwordx4 v123, s[28:31], s70 offen offset:3072 lds
    s_add_u32 m0, m0, 65536
    s_add_u32 s70, s70, s71
    buffer_load_dwordx4 v120, s[28:31], s70 offen offset:0 lds
    buffer_load_dwordx4 v121, s[28:31], s70 offen offset:1024 lds
    buffer_load_dwordx4 v122, s[28:31], s70 offen offset:2048 lds
    buffer_load_dwordx4 v123, s[28:31], s70 offen offset:3072 lds
    s_add_u32 s91, s91, 1
    s_sub_u32 s81, s81, 1
    s_cmp_lg_u32 s81, 0
    s_cbranch_scc1 L_dmai_26
    s_getpc_b64 s[74:75]
L_pc:
    s_lshl1_add_u32 s64, s5, s99
    s_mul_i32 s64, s64, 8
    s_sub_u32 s74, s74, L_pc-interleave_layers__ssm_conv_h3__dense_activation_squared_relu__prompt_kernel
    s_subb_u32 s75, s75, 0
    v_min_u32 v94, 7, v0
    v_add_lshl_u32 v94, v94, s64, 7
    v_min_u32 v94, L_hotend-interleave_layers__ssm_conv_h3__dense_activation_squared_relu__prompt_kernel, v94
    global_load_dword v95, v94, s[74:75]
    s_cmp_lg_u32 s99, 0
    s_cbranch_scc1 L_mw_27
    v_min_u32 v94, 27, v0
    v_lshlrev_b32 v94, 7, v94
    s_mul_i32 s64, s2, 3584
    s_add_u32 s64, s64, 917504
    buffer_load_dword v95, v94, s[28:31], s64 offen
    s_branch L_md_28
L_mw_27:
    v_min_u32 v94, 55, v0
    v_lshlrev_b32 v94, 7, v94
    s_mul_i32 s64, s2, 7168
    buffer_load_dword v95, v94, s[32:35], s64 offen
L_md_28:
    v_lshlrev_b32 v94, 7, v0
    s_lshl1_add_u32 s64, s5, s99
    s_mul_i32 s84, s64, 14336
    s_add_u32 s84, s84, 917504
    s_lshr_b32 s65, s64, 4
    s_mul_i32 s65, s65, 458752
    s_and_b32 s66, s64, 7
    s_lshl_b32 s85, s66, 14
    s_add_u32 s85, s85, s65
    s_bfe_u32 s66, s64, 0x10003
    s_lshl_b32 s66, s66, 18
    s_add_u32 s85, s85, s66
    s_and_b32 s66, s64, 15
    s_lshl_b32 s87, s66, 14
    s_cmp_ge_u32 s66, 8
    s_cselect_b32 s67, 2, 1
    s_lshl_b32 s67, s67, 17
    s_add_u32 s87, s87, s67
    s_add_u32 s87, s87, s65
    s_cmp_ge_u32 s66, 12
    s_cselect_b32 s87, 2146435072, s87
    v_lshlrev_b32 v5, 3, v0
    s_lshl1_add_u32 s95, s7, s99
    v_lshrrev_b32 v10, 3, v0
    v_bfe_u32 v11, v0, 1, 2
    v_bfe_u32 v12, v0, 4, 2
    v_xor_b32 v11, v11, v12
    v_and_b32 v12, 1, v0
    v_lshlrev_b32 v12, 4, v12
    v_lshl_add_u32 v11, v11, 5, v12
    s_movk_i32 s64, 1024
    v_mad_u32_u24 v124, v10, s64, v11
    v_add_u32 v125, 7168, v124
    v_add_u32 v126, 14336, v124
    v_add_u32 v127, 21504, v124
    v_lshrrev_b32 v10, 2, v0
    v_bfe_u32 v11, v0, 3, 2
    v_and_b32 v112, 3, v0
    v_lshlrev_b32 v112, 3, v112
    v_lshl_add_u32 v10, v10, 7, v112
    v_xor_b32 v112, 0, v11
    v_lshl_add_u32 v112, v112, 5, v10
    v_xor_b32 v113, 1, v11
    v_lshl_add_u32 v113, v113, 5, v10
    v_xor_b32 v114, 2, v11
    v_lshl_add_u32 v114, v114, 5, v10
    v_xor_b32 v115, 3, v11
    v_lshl_add_u32 v115, v115, 5, v10
    s_lshl_b32 s77, s100, 1
    s_cmp_eq_u32 s3, 3
    s_cselect_b32 s77, s77, 0
    s_cselect_b32 s79, 3, 2
    s_cselect_b32 s65, 2, s3
    s_add_u32 s78, s77, 1
    s_lshl_b32 s64, s3, 15
    s_add_u32 s64, s64, 32768
    s_lshl_b32 s65, s65, 15
    s_add_u32 s65, s65, 32768
    v_xor_b32 v116, s77, v11
    v_lshl_add_u32 v116, v116, 5, v10
    v_add_u32 v116, s64, v116
    v_xor_b32 v117, s78, v11
    v_lshl_add_u32 v117, v117, 5, v10
    v_add_u32 v117, s64, v117
    v_xor_b32 v118, s79, v11
    v_lshl_add_u32 v118, v118, 5, v10
    v_add_u32 v118, s65, v118
    v_xor_b32 v119, 3, v11
    v_lshl_add_u32 v119, v119, 5, v10
    v_add_u32 v119, s64, v119
    s_mul_i32 s72, s99, 8320
    s_mul_i32 s73, s99, 4608
    v_mov_b32 v6, 0
    v_mov_b32 v7, 0
    v_add_u32 v8, s73, v5
    ds_write_b64 v8, v[6:7] offset:20736
    v_and_b32 v8, 24, v5
    v_add_u32 v8, s72, v8
    ds_write_b64 v8, v[6:7] offset:0
    ds_write_b64 v8, v[6:7] offset:4160
    v_add_u32 v8, s72, v4
L_pb_16:
    s_waitcnt vmcnt(25)
    ds_write_b128 v8, v[16:19] offset:32
    v_alignbit_b32 v36, v17, v16, 16
    v_alignbit_b32 v37, v18, v17, 16
    v_alignbit_b32 v38, v19, v18, 16
    s_waitcnt vmcnt(24)
    v_alignbit_b32 v39, v32, v19, 16
    ds_write_b128 v8, v[36:39] offset:4192
    v_lshlrev_b32 v52, 16, v16
    s_mov_b64 exec, 1
    ds_write_b32 v8, v52 offset:4188
    s_mov_b64 exec, -1
    s_waitcnt vmcnt(23)
    ds_write_b128 v8, v[20:23] offset:1056
    v_alignbit_b32 v40, v21, v20, 16
    v_alignbit_b32 v41, v22, v21, 16
    v_alignbit_b32 v42, v23, v22, 16
    s_waitcnt vmcnt(22)
    v_alignbit_b32 v43, v33, v23, 16
    ds_write_b128 v8, v[40:43] offset:5216
    s_waitcnt vmcnt(21)
    ds_write_b128 v8, v[24:27] offset:2080
    v_alignbit_b32 v44, v25, v24, 16
    v_alignbit_b32 v45, v26, v25, 16
    v_alignbit_b32 v46, v27, v26, 16
    s_waitcnt vmcnt(20)
    v_alignbit_b32 v47, v34, v27, 16
    ds_write_b128 v8, v[44:47] offset:6240
    s_waitcnt vmcnt(19)
    ds_write_b128 v8, v[28:31] offset:3104
    v_alignbit_b32 v48, v29, v28, 16
    v_alignbit_b32 v49, v30, v29, 16
    v_alignbit_b32 v50, v31, v30, 16
    s_waitcnt vmcnt(18)
    v_alignbit_b32 v51, v35, v31, 16
    ds_write_b128 v8, v[48:51] offset:7264
    s_waitcnt lgkmcnt(0)
    s_mul_i32 s8, s8, 0x9E3779B1
    s_add_u32 s8, s8, 0x7F4A7C15
    v_mov_b32 v1, s8
    s_barrier
    s_lshl_b32 s71, s3, 7
    s_lshl_b32 s68, s100, 9
    s_sub_u32 s68, 384, s68
    s_cmp_eq_u32 s3, 3
    s_cselect_b32 s71, s68, s71
    s_add_u32 s71, s71, s101
    s_lshl_b32 s68, s99, 7
    s_add_u32 s68, s68, s101
    s_sub_u32 s71, s71, s68
    s_lshl_b32 s69, s99, 15
    s_add_u32 s69, s69, 32768
    s_lshl1_add_u32 s91, s6, 2
    s_mov_b32 s81, 6
L_dmai_29:
    s_and_b32 s91, s91, 7
    s_lshl_b32 s70, s91, 12
    s_add_u32 m0, s70, s69
    s_mul_i32 s70, s91, 114688
    s_add_u32 s70, s70, s68
    buffer_load_dwordx4 v120, s[28:31], s70 offen offset:0 lds
    buffer_load_dwordx4 v121, s[28:31], s70 offen offset:1024 lds
    buffer_load_dwordx4 v122, s[28:31], s70 offen offset:2048 lds
    buffer_load_dwordx4 v123, s[28:31], s70 offen offset:3072 lds
    s_add_u32 m0, m0, 65536
    s_add_u32 s70, s70, s71
    buffer_load_dwordx4 v120, s[28:31], s70 offen offset:0 lds
    buffer_load_dwordx4 v121, s[28:31], s70 offen offset:1024 lds
    buffer_load_dwordx4 v122, s[28:31], s70 offen offset:2048 lds
    buffer_load_dwordx4 v123, s[28:31], s70 offen offset:3072 lds
    s_add_u32 s91, s91, 1
    s_sub_u32 s81, s81, 1
    s_cmp_lg_u32 s81, 0
    s_cbranch_scc1 L_dmai_29
    buffer_load_dword v95, v94, s[28:31], s84 offen
    s_add_u32 s84, s84, 8192
    buffer_load_dword v95, v94, s[28:31], s84 offen
    s_add_u32 s84, s84, 8192
    s_lshl_b32 s66, s4, 7
    s_lshl2_add_u32 s66, s5, s66
    s_load_dword s63, s[60:61], s66
    s_mul_i32 s67, s99, 8320
    s_add_u32 s67, s67, 0
    v_and_b32 v3, 15, v0
    v_lshrrev_b32 v4, 4, v0
    v_add_u32 v5, 1, v3
    v_lshrrev_b32 v6, 1, v5
    v_lshlrev_b32 v6, 2, v6
    v_lshl_add_u32 v6, v4, 4, v6
    v_and_b32 v5, 1, v5
    s_movk_i32 s69, 4160
    v_mad_u32_u24 v6, v5, s69, v6
    v_add_u32 v6, s67, v6
    s_waitcnt lgkmcnt(0)
    ds_read2_b32 v[128:129], v6 offset0:0 offset1:1
    ds_read2_b32 v[130:131], v6 offset0:2 offset1:3
    ds_read2_b32 v[160:161], v6 offset0:16 offset1:17
    ds_read2_b32 v[162:163], v6 offset0:18 offset1:19
    ds_read2_b32 v[192:193], v6 offset0:32 offset1:33
    ds_read2_b32 v[194:195], v6 offset0:34 offset1:35
    ds_read2_b32 v[224:225], v6 offset0:48 offset1:49
    ds_read2_b32 v[226:227], v6 offset0:50 offset1:51
    ds_read2_b32 v[132:133], v6 offset0:128 offset1:129
    ds_read2_b32 v[134:135], v6 offset0:130 offset1:131
    ds_read2_b32 v[164:165], v6 offset0:144 offset1:145
    ds_read2_b32 v[166:167], v6 offset0:146 offset1:147
    ds_read2_b32 v[196:197], v6 offset0:160 offset1:161
    ds_read2_b32 v[198:199], v6 offset0:162 offset1:163
    ds_read2_b32 v[228:229], v6 offset0:176 offset1:177
    ds_read2_b32 v[230:231], v6 offset0:178 offset1:179
    v_add_u32 v6, 1024, v6
    ds_read2_b32 v[136:137], v6 offset0:0 offset1:1
    ds_read2_b32 v[138:139], v6 offset0:2 offset1:3
    ds_read2_b32 v[168:169], v6 offset0:16 offset1:17
    ds_read2_b32 v[170:171], v6 offset0:18 offset1:19
    ds_read2_b32 v[200:201], v6 offset0:32 offset1:33
    ds_read2_b32 v[202:203], v6 offset0:34 offset1:35
    ds_read2_b32 v[232:233], v6 offset0:48 offset1:49
    ds_read2_b32 v[234:235], v6 offset0:50 offset1:51
    ds_read2_b32 v[140:141], v6 offset0:128 offset1:129
    ds_read2_b32 v[142:143], v6 offset0:130 offset1:131
    ds_read2_b32 v[172:173], v6 offset0:144 offset1:145
    ds_read2_b32 v[174:175], v6 offset0:146 offset1:147
    ds_read2_b32 v[204:205], v6 offset0:160 offset1:161
    ds_read2_b32 v[206:207], v6 offset0:162 offset1:163
    ds_read2_b32 v[236:237], v6 offset0:176 offset1:177
    ds_read2_b32 v[238:239], v6 offset0:178 offset1:179
    v_add_u32 v6, 1024, v6
    ds_read2_b32 v[144:145], v6 offset0:0 offset1:1
    ds_read2_b32 v[146:147], v6 offset0:2 offset1:3
    ds_read2_b32 v[176:177], v6 offset0:16 offset1:17
    ds_read2_b32 v[178:179], v6 offset0:18 offset1:19
    ds_read2_b32 v[208:209], v6 offset0:32 offset1:33
    ds_read2_b32 v[210:211], v6 offset0:34 offset1:35
    ds_read2_b32 v[240:241], v6 offset0:48 offset1:49
    ds_read2_b32 v[242:243], v6 offset0:50 offset1:51
    ds_read2_b32 v[148:149], v6 offset0:128 offset1:129
    ds_read2_b32 v[150:151], v6 offset0:130 offset1:131
    ds_read2_b32 v[180:181], v6 offset0:144 offset1:145
    ds_read2_b32 v[182:183], v6 offset0:146 offset1:147
    ds_read2_b32 v[212:213], v6 offset0:160 offset1:161
    ds_read2_b32 v[214:215], v6 offset0:162 offset1:163
    ds_read2_b32 v[244:245], v6 offset0:176 offset1:177
    ds_read2_b32 v[246:247], v6 offset0:178 offset1:179
    v_add_u32 v6, 1024, v6
    ds_read2_b32 v[152:153], v6 offset0:0 offset1:1
    ds_read2_b32 v[154:155], v6 offset0:2 offset1:3
    ds_read2_b32 v[184:185], v6 offset0:16 offset1:17
    ds_read2_b32 v[186:187], v6 offset0:18 offset1:19
    ds_read2_b32 v[216:217], v6 offset0:32 offset1:33
    ds_read2_b32 v[218:219], v6 offset0:34 offset1:35
    ds_read2_b32 v[248:249], v6 offset0:48 offset1:49
    ds_read2_b32 v[250:251], v6 offset0:50 offset1:51
    ds_read2_b32 v[156:157], v6 offset0:128 offset1:129
    ds_read2_b32 v[158:159], v6 offset0:130 offset1:131
    ds_read2_b32 v[188:189], v6 offset0:144 offset1:145
    ds_read2_b32 v[190:191], v6 offset0:146 offset1:147
    ds_read2_b32 v[220:221], v6 offset0:160 offset1:161
    ds_read2_b32 v[222:223], v6 offset0:162 offset1:163
    ds_read2_b32 v[252:253], v6 offset0:176 offset1:177
    ds_read2_b32 v[254:255], v6 offset0:178 offset1:179
    s_lshl_b32 s66, s99, 4
    s_lshr_b32 s63, s63, s66
    s_and_b32 s63, s63, 0xffff
    v_lshl_add_u32 v5, v4, 3, v3
    v_sub_u32 v5, 15, v5
    v_and_b32 v7, 1, v5
    v_lshlrev_b32 v7, 4, v7
    v_mov_b32 v8, s63
    v_lshlrev_b32 v7, v7, v8
    v_ashrrev_i32 v5, 1, v5
    v_cmp_eq_u32 vcc, 0, v5
    s_nop 1
    v_cndmask_b32 v12, 0, v7, vcc
    v_cmp_eq_u32 vcc, 1, v5
    s_nop 1
    v_cndmask_b32 v13, 0, v7, vcc
    v_cmp_eq_u32 vcc, 2, v5
    s_nop 1
    v_cndmask_b32 v14, 0, v7, vcc
    v_cmp_eq_u32 vcc, 3, v5
    s_nop 1
    v_cndmask_b32 v15, 0, v7, vcc
    s_mul_i32 s67, s99, 4608
    s_add_u32 s67, s67, 17120
    v_lshlrev_b32 v5, 5, v3
    v_lshlrev_b32 v8, 4, v4
    v_sub_u32 v8, v8, v5
    v_add_u32 v8, s67, v8
    v_lshlrev_b32 v3, 4, v0
    s_lshl_b32 s64, s3, 12
    v_add_u32 v6, s64, v3
L_pb_17:
    s_waitcnt vmcnt(2)
    ds_read_b64_tr_b16 a[0:1], v116 offset:0
    ds_read_b64_tr_b16 a[4:5], v116 offset:2048
    ds_read_b64_tr_b16 a[8:9], v116 offset:4096
    ds_read_b64_tr_b16 a[12:13], v116 offset:6144
    ds_read_b64_tr_b16 a[16:17], v116 offset:8192
    ds_read_b64_tr_b16 a[20:21], v116 offset:10240
    ds_read_b64_tr_b16 a[24:25], v116 offset:12288
    ds_read_b64_tr_b16 a[28:29], v116 offset:14336
    ds_read_b64_tr_b16 a[32:33], v116 offset:16384
    ds_read_b64_tr_b16 a[36:37], v116 offset:18432
    ds_read_b64_tr_b16 a[40:41], v116 offset:20480
    ds_read_b64_tr_b16 a[44:45], v116 offset:22528
    ds_read_b64_tr_b16 a[48:49], v116 offset:24576
    ds_read_b64_tr_b16 a[52:53], v116 offset:26624
    ds_read_b64_tr_b16 a[56:57], v116 offset:28672
    ds_read_b64_tr_b16 a[60:61], v116 offset:30720
    ds_read_b64_tr_b16 a[64:65], v117 offset:0
    ds_read_b64_tr_b16 a[68:69], v117 offset:2048
    ds_read_b64_tr_b16 a[72:73], v117 offset:4096
    ds_read_b64_tr_b16 a[76:77], v117 offset:6144
    ds_read_b64_tr_b16 a[80:81], v117 offset:8192
    ds_read_b64_tr_b16 a[84:85], v117 offset:10240
    ds_read_b64_tr_b16 a[88:89], v117 offset:12288
    ds_read_b64_tr_b16 a[92:93], v117 offset:14336
    ds_read_b64_tr_b16 a[96:97], v117 offset:16384
    ds_read_b64_tr_b16 a[100:101], v117 offset:18432
    ds_read_b64_tr_b16 a[104:105], v117 offset:20480
    ds_read_b64_tr_b16 a[108:109], v117 offset:22528
    ds_read_b64_tr_b16 a[112:113], v117 offset:24576
    ds_read_b64_tr_b16 a[116:117], v117 offset:26624
    ds_read_b64_tr_b16 a[120:121], v117 offset:28672
    ds_read_b64_tr_b16 a[124:125], v117 offset:30720
    s_barrier
    ds_read_b64_tr_b16 a[128:129], v118 offset:0
    ds_read_b64_tr_b16 a[132:133], v118 offset:2048
    ds_read_b64_tr_b16 a[136:137], v118 offset:4096
    ds_read_b64_tr_b16 a[140:141], v118 offset:6144
    ds_read_b64_tr_b16 a[144:145], v118 offset:8192
    ds_read_b64_tr_b16 a[148:149], v118 offset:10240
    ds_read_b64_tr_b16 a[152:153], v118 offset:12288
    ds_read_b64_tr_b16 a[156:157], v118 offset:14336
    ds_read_b64_tr_b16 a[160:161], v118 offset:16384
    ds_read_b64_tr_b16 a[164:165], v118 offset:18432
    ds_read_b64_tr_b16 a[168:169], v118 offset:20480
    ds_read_b64_tr_b16 a[172:173], v118 offset:22528
    ds_read_b64_tr_b16 a[176:177], v118 offset:24576
    ds_read_b64_tr_b16 a[180:181], v118 offset:26624
    ds_read_b64_tr_b16 a[184:185], v118 offset:28672
    ds_read_b64_tr_b16 a[188:189], v118 offset:30720
L_pb_18:
    s_branch L_pbt_18
.p2align 12
L_pbt_18:
    s_waitcnt lgkmcnt(0)
    s_barrier
    ds_read_b128 v[60:63], v8 offset:2048
    ds_read_b128 v[56:59], v8 offset:2560
    ds_read_b128 v[52:55], v8 offset:3072
    ds_read_b128 v[48:51], v8 offset:3584
    ds_read_b128 v[76:79], v8 offset:2112
    s_waitcnt lgkmcnt(4)
    v_mfma_f32_16x16x32_bf16 v[28:31], v[12:15], v[60:63], 0
    ds_read_b128 v[72:75], v8 offset:2624
    v_mfma_f32_16x16x32_bf16 v[28:31], v[128:131], v[60:63], v[28:31]
    buffer_load_dword v95, v94, s[32:35], s85 offen
    s_add_u32 s85, s85, 8192
    buffer_load_dword v95, v94, s[32:35], s85 offen
    s_add_u32 s85, s85, 8192
    s_waitcnt lgkmcnt(4)
    v_mfma_f32_16x16x32_bf16 v[24:27], v[12:15], v[56:59], 0
    ds_read_b128 v[68:71], v8 offset:3136
    v_mfma_f32_16x16x32_bf16 v[24:27], v[128:131], v[56:59], v[24:27]
    v_mfma_f32_16x16x32_bf16 v[28:31], v[132:135], v[56:59], v[28:31]
    s_waitcnt lgkmcnt(4)
    v_mfma_f32_16x16x32_bf16 v[20:23], v[12:15], v[52:55], 0
    ds_read_b128 v[64:67], v8 offset:3648
    v_mfma_f32_16x16x32_bf16 v[20:23], v[128:131], v[52:55], v[20:23]
    v_mfma_f32_16x16x32_bf16 v[24:27], v[132:135], v[52:55], v[24:27]
    v_mfma_f32_16x16x32_bf16 v[28:31], v[136:139], v[52:55], v[28:31]
    s_waitcnt lgkmcnt(4)
    v_mfma_f32_16x16x32_bf16 v[16:19], v[12:15], v[48:51], 0
    ds_read_b128 v[60:63], v8 offset:2176
    v_mfma_f32_16x16x32_bf16 v[16:19], v[128:131], v[48:51], v[16:19]
    ds_read_b128 v[56:59], v8 offset:2688
    v_mfma_f32_16x16x32_bf16 v[20:23], v[132:135], v[48:51], v[20:23]
    v_mfma_f32_16x16x32_bf16 v[24:27], v[136:139], v[48:51], v[24:27]
    ds_read_b128 v[52:55], v8 offset:3200
    v_mfma_f32_16x16x32_bf16 v[28:31], v[140:143], v[48:51], v[28:31]
    s_waitcnt lgkmcnt(6)
    v_mfma_f32_16x16x32_bf16 v[28:31], v[160:163], v[76:79], v[28:31]
    s_waitcnt lgkmcnt(5)
    v_mfma_f32_16x16x32_bf16 v[24:27], v[160:163], v[72:75], v[24:27]
    ds_read_b128 v[48:51], v8 offset:3712
    v_mfma_f32_16x16x32_bf16 v[28:31], v[164:167], v[72:75], v[28:31]
    s_waitcnt lgkmcnt(5)
    v_mfma_f32_16x16x32_bf16 v[20:23], v[160:163], v[68:71], v[20:23]
    v_mfma_f32_16x16x32_bf16 v[24:27], v[164:167], v[68:71], v[24:27]
    v_mfma_f32_16x16x32_bf16 v[28:31], v[168:171], v[68:71], v[28:31]
    ds_read_b128 v[76:79], v8 offset:2240
    s_waitcnt lgkmcnt(5)
    v_mfma_f32_16x16x32_bf16 v[16:19], v[160:163], v[64:67], v[16:19]
    ds_read_b128 v[72:75], v8 offset:2752
    v_mfma_f32_16x16x32_bf16 v[20:23], v[164:167], v[64:67], v[20:23]
    v_mfma_f32_16x16x32_bf16 v[24:27], v[168:171], v[64:67], v[24:27]
    ds_read_b128 v[68:71], v8 offset:3264
    v_mfma_f32_16x16x32_bf16 v[28:31], v[172:175], v[64:67], v[28:31]
    s_waitcnt lgkmcnt(6)
    v_mfma_f32_16x16x32_bf16 v[28:31], v[192:195], v[60:63], v[28:31]
    s_waitcnt lgkmcnt(5)
    v_mfma_f32_16x16x32_bf16 v[24:27], v[192:195], v[56:59], v[24:27]
    ds_read_b128 v[64:67], v8 offset:3776
    v_mfma_f32_16x16x32_bf16 v[28:31], v[196:199], v[56:59], v[28:31]
    s_waitcnt lgkmcnt(5)
    v_mfma_f32_16x16x32_bf16 v[20:23], v[192:195], v[52:55], v[20:23]
    v_mfma_f32_16x16x32_bf16 v[24:27], v[196:199], v[52:55], v[24:27]
    v_mfma_f32_16x16x32_bf16 v[28:31], v[200:203], v[52:55], v[28:31]
    s_waitcnt lgkmcnt(4)
    v_mfma_f32_16x16x32_bf16 v[16:19], v[192:195], v[48:51], v[16:19]
    v_mfma_f32_16x16x32_bf16 v[20:23], v[196:199], v[48:51], v[20:23]
    v_mfma_f32_16x16x32_bf16 v[24:27], v[200:203], v[48:51], v[24:27]
    v_mfma_f32_16x16x32_bf16 v[28:31], v[204:207], v[48:51], v[28:31]
    ds_read_b128 v[48:51], v8 offset:3584
    ds_read_b128 v[52:55], v8 offset:3072
    s_waitcnt lgkmcnt(5)
    v_mfma_f32_16x16x32_bf16 v[28:31], v[224:227], v[76:79], v[28:31]
    s_waitcnt lgkmcnt(4)
    v_mfma_f32_16x16x32_bf16 v[24:27], v[224:227], v[72:75], v[24:27]
    v_mfma_f32_16x16x32_bf16 v[28:31], v[228:231], v[72:75], v[28:31]
    s_waitcnt lgkmcnt(3)
    v_mfma_f32_16x16x32_bf16 v[20:23], v[224:227], v[68:71], v[20:23]
    ds_read_b128 v[56:59], v8 offset:2560
    v_mfma_f32_16x16x32_bf16 v[24:27], v[228:231], v[68:71], v[24:27]
    v_mfma_f32_16x16x32_bf16 v[28:31], v[232:235], v[68:71], v[28:31]
    s_waitcnt lgkmcnt(3)
    v_mfma_f32_16x16x32_bf16 v[16:19], v[224:227], v[64:67], v[16:19]
    v_mfma_f32_16x16x32_bf16 v[20:23], v[228:231], v[64:67], v[20:23]
    ds_read_b128 v[60:63], v8 offset:2048
    v_mfma_f32_16x16x32_bf16 v[24:27], v[232:235], v[64:67], v[24:27]
    v_mfma_f32_16x16x32_bf16 v[28:31], v[236:239], v[64:67], v[28:31]
    s_waitcnt lgkmcnt(3)
    v_mfma_f32_16x16x32_bf16 v[32:35], v[144:147], v[48:51], 0
    v_mfma_f32_16x16x32_bf16 v[36:39], v[148:151], v[48:51], 0
    ds_read_b128 v[76:79], v8 offset:0
    v_mfma_f32_16x16x32_bf16 v[40:43], v[152:155], v[48:51], 0
    ds_write_b128 v6, v[16:19] offset:0
    v_mfma_f32_16x16x32_bf16 v[44:47], v[156:159], v[48:51], 0
    ds_read_b128 v[72:75], v8 offset:512
    ds_write_b128 v6, v[20:23] offset:1024
    s_waitcnt lgkmcnt(6)
    v_mfma_f32_16x16x32_bf16 v[32:35], v[140:143], v[52:55], v[32:35]
    ds_write_b128 v6, v[24:27] offset:2048
    v_mfma_f32_16x16x32_bf16 v[36:39], v[144:147], v[52:55], v[36:39]
    ds_write_b128 v6, v[28:31] offset:3072
    v_mfma_f32_16x16x32_bf16 v[40:43], v[148:151], v[52:55], v[40:43]
    ds_read_b128 v[68:71], v8 offset:1024
    s_waitcnt lgkmcnt(0)
    s_barrier
    v_mov_b32 v4, 32000
    ds_read_b32 v5, v4
    v_mfma_f32_16x16x32_bf16 v[44:47], v[152:155], v[52:55], v[44:47]
    v_mfma_f32_16x16x32_bf16 v[32:35], v[136:139], v[56:59], v[32:35]
    v_mfma_f32_16x16x32_bf16 v[36:39], v[140:143], v[56:59], v[36:39]
    v_mfma_f32_16x16x32_bf16 v[40:43], v[144:147], v[56:59], v[40:43]
    ds_read_b128 v[64:67], v8 offset:1536
    v_mfma_f32_16x16x32_bf16 v[44:47], v[148:151], v[56:59], v[44:47]
    v_mfma_f32_16x16x32_bf16 v[32:35], v[132:135], v[60:63], v[32:35]
    s_waitcnt lgkmcnt(1)
    v_readfirstlane_b32 s9, v5
    v_mfma_f32_16x16x32_bf16 v[36:39], v[136:139], v[60:63], v[36:39]
    v_mfma_f32_16x16x32_bf16 v[40:43], v[140:143], v[60:63], v[40:43]
    v_mfma_f32_16x16x32_bf16 v[44:47], v[144:147], v[60:63], v[44:47]
    v_mfma_f32_16x16x32_bf16 v[44:47], v[12:15], v[76:79], v[44:47]
    v_mfma_f32_16x16x32_bf16 v[44:47], v[128:131], v[76:79], v[44:47]
    ds_read_b128 v[76:79], v8 offset:64
    v_mfma_f32_16x16x32_bf16 v[40:43], v[12:15], v[72:75], v[40:43]
    v_mfma_f32_16x16x32_bf16 v[40:43], v[128:131], v[72:75], v[40:43]
    v_mfma_f32_16x16x32_bf16 v[44:47], v[132:135], v[72:75], v[44:47]
    ds_read_b128 v[72:75], v8 offset:576
    v_mfma_f32_16x16x32_bf16 v[36:39], v[12:15], v[68:71], v[36:39]
    s_waitcnt lgkmcnt(0)
    s_barrier
    s_lshl_b32 s92, s3, 7
    s_lshl_b32 s70, s100, 9
    s_sub_u32 s70, 384, s70
    s_cmp_eq_u32 s3, 3
    s_cselect_b32 s92, s70, s92
    s_add_u32 s92, s92, s101
    v_mfma_f32_16x16x32_bf16 v[36:39], v[128:131], v[68:71], v[36:39]
    s_add_u32 s92, s92, 917504
    s_lshl_b32 s93, s3, 15
    s_add_u32 s93, s93, 32768
    v_mfma_f32_16x16x32_bf16 v[40:43], v[132:135], v[68:71], v[40:43]
    s_lshl_b32 s91, s6, 1
    s_and_b32 s91, s91, 7
    s_lshl_b32 s70, s91, 12
    v_mfma_f32_16x16x32_bf16 v[44:47], v[136:139], v[68:71], v[44:47]
    ds_read_b128 v[68:71], v8 offset:1088
    s_add_u32 m0, s70, s93
    v_mfma_f32_16x16x32_bf16 v[32:35], v[12:15], v[64:67], v[32:35]
    ds_read_b128 v[60:63], v8 offset:2112
    s_mul_i32 s70, s91, 114688
    v_mfma_f32_16x16x32_bf16 v[32:35], v[128:131], v[64:67], v[32:35]
    s_add_u32 s70, s70, s92
    s_add_u32 s91, s91, 1
    buffer_load_dwordx4 v120, s[28:31], s70 offen offset:0 lds
    v_mfma_f32_16x16x32_bf16 v[36:39], v[132:135], v[64:67], v[36:39]
    buffer_load_dwordx4 v121, s[28:31], s70 offen offset:1024 lds
    v_mfma_f32_16x16x32_bf16 v[40:43], v[136:139], v[64:67], v[40:43]
    buffer_load_dwordx4 v122, s[28:31], s70 offen offset:2048 lds
    v_mfma_f32_16x16x32_bf16 v[44:47], v[140:143], v[64:67], v[44:47]
    ds_read_b128 v[64:67], v8 offset:1600
    ds_read_b128 v[56:59], v8 offset:2624
    v_mfma_f32_16x16x32_bf16 v[44:47], v[160:163], v[76:79], v[44:47]
    buffer_load_dwordx4 v123, s[28:31], s70 offen offset:3072 lds
    v_mfma_f32_16x16x32_bf16 v[40:43], v[160:163], v[72:75], v[40:43]
    s_and_b32 s91, s91, 7
    s_lshl_b32 s70, s91, 12
    s_add_u32 m0, s70, s93
    v_mfma_f32_16x16x32_bf16 v[44:47], v[164:167], v[72:75], v[44:47]
    s_mul_i32 s70, s91, 114688
    s_add_u32 s70, s70, s92
    s_waitcnt lgkmcnt(3)
    v_mfma_f32_16x16x32_bf16 v[36:39], v[160:163], v[68:71], v[36:39]
    ds_read_b128 v[52:55], v8 offset:3136
    s_add_u32 s91, s91, 1
    v_mfma_f32_16x16x32_bf16 v[40:43], v[164:167], v[68:71], v[40:43]
    buffer_load_dwordx4 v120, s[28:31], s70 offen offset:0 lds
    v_mfma_f32_16x16x32_bf16 v[44:47], v[168:171], v[68:71], v[44:47]
    buffer_load_dwordx4 v121, s[28:31], s70 offen offset:1024 lds
    s_waitcnt lgkmcnt(2)
    v_mfma_f32_16x16x32_bf16 v[32:35], v[160:163], v[64:67], v[32:35]
    buffer_load_dwordx4 v122, s[28:31], s70 offen offset:2048 lds
    v_mfma_f32_16x16x32_bf16 v[36:39], v[164:167], v[64:67], v[36:39]
    ds_read_b128 v[48:51], v8 offset:3648
    buffer_load_dwordx4 v123, s[28:31], s70 offen offset:3072 lds
    v_mfma_f32_16x16x32_bf16 v[40:43], v[168:171], v[64:67], v[40:43]
    s_and_b32 s91, s91, 7
    s_lshl_b32 s70, s91, 12
    s_add_u32 m0, s70, s93
    v_mfma_f32_16x16x32_bf16 v[44:47], v[172:175], v[64:67], v[44:47]
    s_mul_i32 s70, s91, 114688
    s_add_u32 s70, s70, s92
    s_add_u32 s91, s91, 1
    v_mfma_f32_16x16x32_bf16 v[32:35], v[164:167], v[60:63], v[32:35]
    buffer_load_dwordx4 v120, s[28:31], s70 offen offset:0 lds
    v_mfma_f32_16x16x32_bf16 v[36:39], v[168:171], v[60:63], v[36:39]
    ds_read_b128 v[76:79], v8 offset:128
    buffer_load_dwordx4 v121, s[28:31], s70 offen offset:1024 lds
    v_mfma_f32_16x16x32_bf16 v[40:43], v[172:175], v[60:63], v[40:43]
    ds_read_b128 v[72:75], v8 offset:640
    buffer_load_dwordx4 v122, s[28:31], s70 offen offset:2048 lds
    v_mfma_f32_16x16x32_bf16 v[44:47], v[176:179], v[60:63], v[44:47]
    buffer_load_dwordx4 v123, s[28:31], s70 offen offset:3072 lds
    s_waitcnt lgkmcnt(4)
    v_mfma_f32_16x16x32_bf16 v[32:35], v[168:171], v[56:59], v[32:35]
    ds_read_b128 v[68:71], v8 offset:1152
    s_and_b32 s91, s91, 7
    v_mfma_f32_16x16x32_bf16 v[36:39], v[172:175], v[56:59], v[36:39]
    s_lshl_b32 s70, s91, 12
    s_add_u32 m0, s70, s93
    s_mul_i32 s70, s91, 114688
    v_mfma_f32_16x16x32_bf16 v[40:43], v[176:179], v[56:59], v[40:43]
    s_add_u32 s70, s70, s92
    s_add_u32 s91, s91, 1
    buffer_load_dwordx4 v120, s[28:31], s70 offen offset:0 lds
    v_mfma_f32_16x16x32_bf16 v[44:47], v[180:183], v[56:59], v[44:47]
    ds_read_b128 v[64:67], v8 offset:1664
    s_waitcnt lgkmcnt(5)
    v_mfma_f32_16x16x32_bf16 v[32:35], v[172:175], v[52:55], v[32:35]
    buffer_load_dwordx4 v121, s[28:31], s70 offen offset:1024 lds
    v_mfma_f32_16x16x32_bf16 v[36:39], v[176:179], v[52:55], v[36:39]
    buffer_load_dwordx4 v122, s[28:31], s70 offen offset:2048 lds
    v_mfma_f32_16x16x32_bf16 v[40:43], v[180:183], v[52:55], v[40:43]
    buffer_load_dwordx4 v123, s[28:31], s70 offen offset:3072 lds
    v_mfma_f32_16x16x32_bf16 v[44:47], v[184:187], v[52:55], v[44:47]
    ds_read_b128 v[60:63], v8 offset:2176
    s_waitcnt lgkmcnt(5)
    v_mfma_f32_16x16x32_bf16 v[32:35], v[176:179], v[48:51], v[32:35]
    s_and_b32 s91, s91, 7
    s_lshl_b32 s70, s91, 12
    s_add_u32 m0, s70, s93
    v_mfma_f32_16x16x32_bf16 v[36:39], v[180:183], v[48:51], v[36:39]
    s_mul_i32 s70, s91, 114688
    s_add_u32 s70, s70, s92
    s_add_u32 s91, s91, 1
    v_mfma_f32_16x16x32_bf16 v[40:43], v[184:187], v[48:51], v[40:43]
    buffer_load_dwordx4 v120, s[28:31], s70 offen offset:0 lds
    v_mfma_f32_16x16x32_bf16 v[44:47], v[188:191], v[48:51], v[44:47]
    ds_read_b128 v[56:59], v8 offset:2688
    s_waitcnt lgkmcnt(5)
    v_mfma_f32_16x16x32_bf16 v[44:47], v[192:195], v[76:79], v[44:47]
    buffer_load_dwordx4 v121, s[28:31], s70 offen offset:1024 lds
    s_waitcnt lgkmcnt(4)
    v_mfma_f32_16x16x32_bf16 v[40:43], v[192:195], v[72:75], v[40:43]
    buffer_load_dwordx4 v122, s[28:31], s70 offen offset:2048 lds
    v_mfma_f32_16x16x32_bf16 v[44:47], v[196:199], v[72:75], v[44:47]
    buffer_load_dwordx4 v123, s[28:31], s70 offen offset:3072 lds
    s_waitcnt lgkmcnt(3)
    v_mfma_f32_16x16x32_bf16 v[36:39], v[192:195], v[68:71], v[36:39]
    ds_read_b128 v[52:55], v8 offset:3200
    s_and_b32 s91, s91, 7
    v_mfma_f32_16x16x32_bf16 v[40:43], v[196:199], v[68:71], v[40:43]
    s_lshl_b32 s70, s91, 12
    s_add_u32 m0, s70, s93
    s_mul_i32 s70, s91, 114688
    v_mfma_f32_16x16x32_bf16 v[44:47], v[200:203], v[68:71], v[44:47]
    s_add_u32 s70, s70, s92
    s_add_u32 s91, s91, 1
    s_waitcnt lgkmcnt(3)
    v_mfma_f32_16x16x32_bf16 v[32:35], v[192:195], v[64:67], v[32:35]
    buffer_load_dwordx4 v120, s[28:31], s70 offen offset:0 lds
    v_mfma_f32_16x16x32_bf16 v[36:39], v[196:199], v[64:67], v[36:39]
    ds_read_b128 v[48:51], v8 offset:3712
    buffer_load_dwordx4 v121, s[28:31], s70 offen offset:1024 lds
    v_mfma_f32_16x16x32_bf16 v[40:43], v[200:203], v[64:67], v[40:43]
    buffer_load_dwordx4 v122, s[28:31], s70 offen offset:2048 lds
    v_mfma_f32_16x16x32_bf16 v[44:47], v[204:207], v[64:67], v[44:47]
    buffer_load_dwordx4 v123, s[28:31], s70 offen offset:3072 lds
    s_waitcnt lgkmcnt(3)
    v_mfma_f32_16x16x32_bf16 v[32:35], v[196:199], v[60:63], v[32:35]
    s_and_b32 s91, s91, 7
    s_lshl_b32 s70, s91, 12
    s_add_u32 m0, s70, s93
    v_mfma_f32_16x16x32_bf16 v[36:39], v[200:203], v[60:63], v[36:39]
    ds_read_b128 v[76:79], v8 offset:192
    s_mul_i32 s70, s91, 114688
    v_mfma_f32_16x16x32_bf16 v[40:43], v[204:207], v[60:63], v[40:43]
    ds_read_b128 v[72:75], v8 offset:704
    s_add_u32 s70, s70, s92
    v_mfma_f32_16x16x32_bf16 v[44:47], v[208:211], v[60:63], v[44:47]
    s_add_u32 s91, s91, 1
    buffer_load_dwordx4 v120, s[28:31], s70 offen offset:0 lds
    s_waitcnt lgkmcnt(4)
    v_mfma_f32_16x16x32_bf16 v[32:35], v[200:203], v[56:59], v[32:35]
    ds_read_b128 v[68:71], v8 offset:1216
    buffer_load_dwordx4 v121, s[28:31], s70 offen offset:1024 lds
    v_mfma_f32_16x16x32_bf16 v[36:39], v[204:207], v[56:59], v[36:39]
    buffer_load_dwordx4 v122, s[28:31], s70 offen offset:2048 lds
    v_mfma_f32_16x16x32_bf16 v[40:43], v[208:211], v[56:59], v[40:43]
    buffer_load_dwordx4 v123, s[28:31], s70 offen offset:3072 lds
    v_mfma_f32_16x16x32_bf16 v[44:47], v[212:215], v[56:59], v[44:47]
    ds_read_b128 v[64:67], v8 offset:1728
    s_waitcnt lgkmcnt(5)
    v_mfma_f32_16x16x32_bf16 v[32:35], v[204:207], v[52:55], v[32:35]
    s_and_b32 s91, s91, 7
    s_lshl_b32 s70, s91, 12
    s_add_u32 m0, s70, s93
    v_mfma_f32_16x16x32_bf16 v[36:39], v[208:211], v[52:55], v[36:39]
    s_mul_i32 s70, s91, 114688
    s_add_u32 s70, s70, s92
    s_add_u32 s91, s91, 1
    v_mfma_f32_16x16x32_bf16 v[40:43], v[212:215], v[52:55], v[40:43]
    buffer_load_dwordx4 v120, s[28:31], s70 offen offset:0 lds
    v_mfma_f32_16x16x32_bf16 v[44:47], v[216:219], v[52:55], v[44:47]
    ds_read_b128 v[60:63], v8 offset:2240
    s_waitcnt lgkmcnt(5)
    v_mfma_f32_16x16x32_bf16 v[32:35], v[208:211], v[48:51], v[32:35]
    buffer_load_dwordx4 v121, s[28:31], s70 offen offset:1024 lds
    v_mfma_f32_16x16x32_bf16 v[36:39], v[212:215], v[48:51], v[36:39]
    buffer_load_dwordx4 v122, s[28:31], s70 offen offset:2048 lds
    v_mfma_f32_16x16x32_bf16 v[40:43], v[216:219], v[48:51], v[40:43]
    buffer_load_dwordx4 v123, s[28:31], s70 offen offset:3072 lds
    v_mfma_f32_16x16x32_bf16 v[44:47], v[220:223], v[48:51], v[44:47]
    ds_read_b128 v[56:59], v8 offset:2752
    s_waitcnt lgkmcnt(5)
    v_mfma_f32_16x16x32_bf16 v[44:47], v[224:227], v[76:79], v[44:47]
    v_lshlrev_b32 v5, 3, v0
    s_lshl4_add_u32 s66, s6, s95
    s_lshl_b32 s66, s66, 11
    buffer_load_dwordx2 v[96:97], v5, s[36:39], s66 offen
    buffer_load_dwordx2 v[98:99], v5, s[36:39], s66 offen offset:512
    s_add_u32 s66, s66, 1024
    buffer_load_dwordx2 v[100:101], v5, s[36:39], s66 offen
    buffer_load_dwordx2 v[102:103], v5, s[36:39], s66 offen offset:512
    s_add_u32 s66, s66, 1047552
    buffer_load_dwordx2 v[104:105], v5, s[36:39], s66 offen
    buffer_load_dwordx2 v[106:107], v5, s[36:39], s66 offen offset:512
    s_add_u32 s66, s66, 1024
    buffer_load_dwordx2 v[108:109], v5, s[36:39], s66 offen
    buffer_load_dwordx2 v[110:111], v5, s[36:39], s66 offen offset:512
    s_add_u32 s66, s66, 1047552
    buffer_load_dwordx2 v[90:91], v5, s[56:59], 0 offen
    buffer_load_dwordx2 v[92:93], v5, s[56:59], 0 offen offset:512
    s_lshl_b32 s64, s3, 7
    s_lshl_b32 s65, s100, 9
    s_sub_u32 s65, 384, s65
    s_cmp_eq_u32 s3, 3
    s_cselect_b32 s64, s65, s64
    s_add_u32 s64, s64, s101
    v_lshrrev_b32 v10, 4, v0
    v_lshlrev_b32 v10, 3, v10
    s_and_b32 s65, s100, s99
    s_lshl_b32 s65, s65, 6
    s_add_u32 s64, s64, s65
    buffer_load_dwordx2 v[80:81], v10, s[52:55], s64 offen offset:0
    buffer_load_dwordx2 v[82:83], v10, s[52:55], s64 offen offset:32
    s_lshl_b32 s65, s99, 5
    s_add_u32 s65, s65, s101
    buffer_load_dwordx2 v[84:85], v10, s[52:55], s65 offen offset:320
    s_waitcnt lgkmcnt(4)
    v_mfma_f32_16x16x32_bf16 v[40:43], v[224:227], v[72:75], v[40:43]
    buffer_load_dword v95, v94, s[32:35], s87 offen
    s_add_u32 s87, s87, 8192
    buffer_load_dword v95, v94, s[32:35], s87 offen
    s_add_u32 s87, s87, 8192
    v_mfma_f32_16x16x32_bf16 v[44:47], v[228:231], v[72:75], v[44:47]
    s_waitcnt lgkmcnt(3)
    v_mfma_f32_16x16x32_bf16 v[36:39], v[224:227], v[68:71], v[36:39]
    ds_read_b128 v[52:55], v8 offset:3264
    v_mfma_f32_16x16x32_bf16 v[40:43], v[228:231], v[68:71], v[40:43]
    v_mfma_f32_16x16x32_bf16 v[44:47], v[232:235], v[68:71], v[44:47]
    s_waitcnt lgkmcnt(3)
    v_mfma_f32_16x16x32_bf16 v[32:35], v[224:227], v[64:67], v[32:35]
    v_mfma_f32_16x16x32_bf16 v[36:39], v[228:231], v[64:67], v[36:39]
    ds_read_b128 v[48:51], v8 offset:3776
    v_mfma_f32_16x16x32_bf16 v[40:43], v[232:235], v[64:67], v[40:43]
    v_mfma_f32_16x16x32_bf16 v[44:47], v[236:239], v[64:67], v[44:47]
    s_waitcnt lgkmcnt(3)
    v_mfma_f32_16x16x32_bf16 v[32:35], v[228:231], v[60:63], v[32:35]
    v_mfma_f32_16x16x32_bf16 v[36:39], v[232:235], v[60:63], v[36:39]
    v_mfma_f32_16x16x32_bf16 v[40:43], v[236:239], v[60:63], v[40:43]
    v_mfma_f32_16x16x32_bf16 v[44:47], v[240:243], v[60:63], v[44:47]
    s_waitcnt lgkmcnt(2)
    v_mfma_f32_16x16x32_bf16 v[32:35], v[232:235], v[56:59], v[32:35]
    v_mfma_f32_16x16x32_bf16 v[36:39], v[236:239], v[56:59], v[36:39]
    v_mfma_f32_16x16x32_bf16 v[40:43], v[240:243], v[56:59], v[40:43]
    v_mfma_f32_16x16x32_bf16 v[44:47], v[244:247], v[56:59], v[44:47]
    s_waitcnt lgkmcnt(1)
    v_mfma_f32_16x16x32_bf16 v[32:35], v[236:239], v[52:55], v[32:35]
    v_mfma_f32_16x16x32_bf16 v[36:39], v[240:243], v[52:55], v[36:39]
    v_mfma_f32_16x16x32_bf16 v[40:43], v[244:247], v[52:55], v[40:43]
    v_mfma_f32_16x16x32_bf16 v[44:47], v[248:251], v[52:55], v[44:47]
    s_waitcnt lgkmcnt(0)
    v_mfma_f32_16x16x32_bf16 v[32:35], v[240:243], v[48:51], v[32:35]
    v_mfma_f32_16x16x32_bf16 v[36:39], v[244:247], v[48:51], v[36:39]
    v_mfma_f32_16x16x32_bf16 v[40:43], v[248:251], v[48:51], v[40:43]
    v_mfma_f32_16x16x32_bf16 v[44:47], v[252:255], v[48:51], v[44:47]
    s_nop 4
    ds_write_b128 v6, v[32:35] offset:0
    ds_write_b128 v6, v[36:39] offset:1024
    ds_write_b128 v6, v[40:43] offset:2048
    ds_write_b128 v6, v[44:47] offset:3072
L_pb_19:
    s_branch L_pbt_19
.p2align 12
L_pbt_19:
    s_waitcnt vmcnt(15)
    s_waitcnt lgkmcnt(0)
    s_barrier
    ds_read_b64_tr_b16 a[130:131], v118 offset:0
    ds_read_b64_tr_b16 a[134:135], v118 offset:2048
    ds_read_b64_tr_b16 a[138:139], v118 offset:4096
    ds_read_b64_tr_b16 a[142:143], v118 offset:6144
    ds_read_b64_tr_b16 a[146:147], v118 offset:8192
    ds_read_b64_tr_b16 a[150:151], v118 offset:10240
    ds_read_b64_tr_b16 a[154:155], v118 offset:12288
    ds_read_b64_tr_b16 a[158:159], v118 offset:14336
    ds_read_b64_tr_b16 a[162:163], v118 offset:16384
    ds_read_b64_tr_b16 a[166:167], v118 offset:18432
    ds_read_b64_tr_b16 a[170:171], v118 offset:20480
    ds_read_b64_tr_b16 a[174:175], v118 offset:22528
    ds_read_b64_tr_b16 a[178:179], v118 offset:24576
    ds_read_b64_tr_b16 a[182:183], v118 offset:26624
    ds_read_b64_tr_b16 a[186:187], v118 offset:28672
    ds_read_b64_tr_b16 a[190:191], v118 offset:30720
    ds_read_b64_tr_b16 a[2:3], v116 offset:0
    ds_read_b64_tr_b16 a[6:7], v116 offset:2048
    ds_read_b64_tr_b16 a[10:11], v116 offset:4096
    ds_read_b64_tr_b16 a[14:15], v116 offset:6144
    ds_read_b64_tr_b16 a[18:19], v116 offset:8192
    ds_read_b64_tr_b16 a[22:23], v116 offset:10240
    ds_read_b64_tr_b16 a[26:27], v116 offset:12288
    ds_read_b64_tr_b16 a[30:31], v116 offset:14336
    ds_read_b64_tr_b16 a[34:35], v116 offset:16384
    ds_read_b64_tr_b16 a[38:39], v116 offset:18432
    ds_read_b64_tr_b16 a[42:43], v116 offset:20480
    ds_read_b64_tr_b16 a[46:47], v116 offset:22528
    ds_read_b64_tr_b16 a[50:51], v116 offset:24576
    ds_read_b64_tr_b16 a[54:55], v116 offset:26624
    ds_read_b64_tr_b16 a[58:59], v116 offset:28672
    ds_read_b64_tr_b16 a[62:63], v116 offset:30720
    ds_read_b64_tr_b16 a[66:67], v117 offset:0
    ds_read_b64_tr_b16 a[70:71], v117 offset:2048
    ds_read_b64_tr_b16 a[74:75], v117 offset:4096
    ds_read_b64_tr_b16 a[78:79], v117 offset:6144
    ds_read_b64_tr_b16 a[82:83], v117 offset:8192
    ds_read_b64_tr_b16 a[86:87], v117 offset:10240
    ds_read_b64_tr_b16 a[90:91], v117 offset:12288
    ds_read_b64_tr_b16 a[94:95], v117 offset:14336
    ds_read_b64_tr_b16 a[98:99], v117 offset:16384
    ds_read_b64_tr_b16 a[102:103], v117 offset:18432
    ds_read_b64_tr_b16 a[106:107], v117 offset:20480
    ds_read_b64_tr_b16 a[110:111], v117 offset:22528
    ds_read_b64_tr_b16 a[114:115], v117 offset:24576
    ds_read_b64_tr_b16 a[118:119], v117 offset:26624
    ds_read_b64_tr_b16 a[122:123], v117 offset:28672
    ds_read_b64_tr_b16 a[126:127], v117 offset:30720
    s_waitcnt lgkmcnt(0)
    s_barrier
    s_cmp_lg_u32 s9, 0
    s_cbranch_scc1 L_slow_30
    s_lshr_b32 s64, s95, 3
    s_lshl1_add_u32 s64, s6, s64
    s_lshl_b32 s64, s64, 14
    s_and_b32 s65, s95, 7
    s_lshl3_add_u32 s64, s65, s64
    s_add_u32 s78, s64, 4194304
    v_lshlrev_b32 v19, 6, v0
    s_lshl_b32 s79, s4, 12
    s_add_u32 s79, s79, 32768
    s_mul_i32 s92, s7, 229376
    s_lshl_b32 s70, s3, 8
    s_waitcnt vmcnt(14)
    v_lshlrev_b32 v36, 16, v96
    s_waitcnt vmcnt(12)
    v_lshlrev_b32 v52, 16, v100
    v_and_b32 v37, s62, v96
    s_add_u32 s92, s92, s70
    s_lshl_b32 s70, s100, 15
    v_and_b32 v53, s62, v100
    v_lshlrev_b32 v38, 16, v97
    v_lshlrev_b32 v54, 16, v101
    s_add_u32 s92, s92, s70
    s_lshl_b32 s93, s3, 15
    v_and_b32 v39, s62, v97
    v_and_b32 v55, s62, v101
    v_lshlrev_b32 v40, 16, v98
    s_add_u32 s93, s93, 32768
    s_lshl_b32 s71, s3, 1
    s_waitcnt vmcnt(11)
    v_lshlrev_b32 v56, 16, v102
    v_and_b32 v41, s62, v98
    v_and_b32 v57, s62, v102
    s_mov_b32 s91, s6
    s_and_b32 s91, s91, 3
    v_lshlrev_b32 v42, 16, v99
    v_lshlrev_b32 v58, 16, v103
    v_and_b32 v43, s62, v99
    s_lshl_b32 s70, s91, 12
    s_add_u32 m0, s70, s93
    v_and_b32 v59, s62, v103
    v_add_f32 v68, v36, v37
    v_add_f32 v72, v52, v53
    s_lshl_b32 s70, s91, 15
    s_add_u32 s70, s70, s92
    v_mul_f32 v69, v36, v36
    v_mul_f32 v73, v52, v52
    v_fmac_f32 v69, v37, v37
    s_add_u32 s91, s91, 1
    buffer_load_dwordx4 v124, s[32:35], s70 offen offset:0 lds
    v_fmac_f32 v73, v53, v53
    v_add_f32 v68, v68, v38
    v_add_f32 v72, v72, v54
    buffer_load_dwordx4 v125, s[32:35], s70 offen offset:1024 lds
    buffer_load_dwordx4 v126, s[32:35], s70 offen offset:2048 lds
    v_fmac_f32 v69, v38, v38
    v_fmac_f32 v73, v54, v54
    v_add_f32 v68, v68, v39
    buffer_load_dwordx4 v127, s[32:35], s70 offen offset:3072 lds
    s_add_u32 m0, m0, 16384
    v_add_f32 v72, v72, v55
    v_fmac_f32 v69, v39, v39
    v_fmac_f32 v73, v55, v55
    s_add_u32 s70, s70, 128
    buffer_load_dwordx4 v124, s[32:35], s70 offen offset:0 lds
    v_add_f32 v68, v68, v40
    v_add_f32 v72, v72, v56
    v_fmac_f32 v69, v40, v40
    buffer_load_dwordx4 v125, s[32:35], s70 offen offset:1024 lds
    buffer_load_dwordx4 v126, s[32:35], s70 offen offset:2048 lds
    v_fmac_f32 v73, v56, v56
    v_add_f32 v68, v68, v41
    v_add_f32 v72, v72, v57
    buffer_load_dwordx4 v127, s[32:35], s70 offen offset:3072 lds
    s_and_b32 s91, s91, 3
    v_fmac_f32 v69, v41, v41
    v_fmac_f32 v73, v57, v57
    v_add_f32 v68, v68, v42
    s_lshl_b32 s70, s91, 12
    s_add_u32 m0, s70, s93
    v_add_f32 v72, v72, v58
    v_fmac_f32 v69, v42, v42
    v_fmac_f32 v73, v58, v58
    s_lshl_b32 s70, s91, 15
    s_add_u32 s70, s70, s92
    v_add_f32 v68, v68, v43
    v_add_f32 v72, v72, v59
    v_fmac_f32 v69, v43, v43
    s_add_u32 s91, s91, 1
    buffer_load_dwordx4 v124, s[32:35], s70 offen offset:0 lds
    v_fmac_f32 v73, v59, v59
    v_permlane32_swap_b32 v68, v69
    s_nop 0
    v_permlane32_swap_b32 v72, v73
    buffer_load_dwordx4 v125, s[32:35], s70 offen offset:1024 lds
    buffer_load_dwordx4 v126, s[32:35], s70 offen offset:2048 lds
    v_add_f32 v68, v68, v69
    v_add_f32 v72, v72, v73
    s_nop 0
    v_add_f32_dpp v68, v68, v68 quad_perm:[1,0,3,2] row_mask:0xf bank_mask:0xf
    buffer_load_dwordx4 v127, s[32:35], s70 offen offset:3072 lds
    s_add_u32 m0, m0, 16384
    v_add_f32_dpp v72, v72, v72 quad_perm:[1,0,3,2] row_mask:0xf bank_mask:0xf
    v_add_f32_dpp v68, v68, v68 quad_perm:[2,3,0,1] row_mask:0xf bank_mask:0xf
    s_nop 0
    v_add_f32_dpp v72, v72, v72 quad_perm:[2,3,0,1] row_mask:0xf bank_mask:0xf
    s_add_u32 s70, s70, 128
    buffer_load_dwordx4 v124, s[32:35], s70 offen offset:0 lds
    v_add_f32_dpp v68, v68, v68 row_half_mirror row_mask:0xf bank_mask:0xf
    v_add_f32_dpp v72, v72, v72 row_half_mirror row_mask:0xf bank_mask:0xf
    s_nop 0
    v_add_f32_dpp v68, v68, v68 row_mirror row_mask:0xf bank_mask:0xf
    buffer_load_dwordx4 v125, s[32:35], s70 offen offset:1024 lds
    buffer_load_dwordx4 v126, s[32:35], s70 offen offset:2048 lds
    v_add_f32_dpp v72, v72, v72 row_mirror row_mask:0xf bank_mask:0xf
    v_add_f32_dpp v68, v68, v68 row_bcast:15 row_mask:0xa bank_mask:0xf
    s_nop 0
    v_add_f32_dpp v72, v72, v72 row_bcast:15 row_mask:0xa bank_mask:0xf
    buffer_load_dwordx4 v127, s[32:35], s70 offen offset:3072 lds
    s_and_b32 s91, s91, 3
    v_mul_f32 v68, 0x3b000000, v68
    v_mul_f32 v72, 0x3b000000, v72
    v_readlane_b32 s72, v68, 31
    s_lshl_b32 s70, s91, 12
    s_add_u32 m0, s70, s93
    v_readlane_b32 s74, v72, 31
    v_readlane_b32 s73, v68, 63
    v_readlane_b32 s75, v72, 63
    s_lshl_b32 s70, s91, 15
    s_add_u32 s70, s70, s92
    v_mov_b32 v69, s72
    v_mov_b32 v73, s74
    v_fma_f32 v68, -v69, v69, s73
    s_add_u32 s91, s91, 1
    buffer_load_dwordx4 v124, s[32:35], s70 offen offset:0 lds
    v_fma_f32 v72, -v73, v73, s75
    v_max_f32 v68, 0, v68
    v_max_f32 v72, 0, v72
    buffer_load_dwordx4 v125, s[32:35], s70 offen offset:1024 lds
    buffer_load_dwordx4 v126, s[32:35], s70 offen offset:2048 lds
    v_add_f32 v68, 0x3727c5ac, v68
    v_add_f32 v72, 0x3727c5ac, v72
    v_rsq_f32 v68, v68
    buffer_load_dwordx4 v127, s[32:35], s70 offen offset:3072 lds
    s_add_u32 m0, m0, 16384
    v_rsq_f32 v72, v72
    v_mul_f32_e64 v69, -v69, v68
    v_mul_f32_e64 v73, -v73, v72
    s_add_u32 s70, s70, 128
    buffer_load_dwordx4 v124, s[32:35], s70 offen offset:0 lds
    v_fma_f32 v44, v36, v68, v69
    v_fma_f32 v60, v52, v72, v73
    v_fma_f32 v45, v37, v68, v69
    buffer_load_dwordx4 v125, s[32:35], s70 offen offset:1024 lds
    buffer_load_dwordx4 v126, s[32:35], s70 offen offset:2048 lds
    v_fma_f32 v61, v53, v72, v73
    v_fma_f32 v46, v38, v68, v69
    v_fma_f32 v62, v54, v72, v73
    buffer_load_dwordx4 v127, s[32:35], s70 offen offset:3072 lds
    s_and_b32 s91, s91, 3
    v_fma_f32 v47, v39, v68, v69
    v_fma_f32 v63, v55, v72, v73
    v_fma_f32 v48, v40, v68, v69
    s_lshl_b32 s70, s91, 12
    s_add_u32 m0, s70, s93
    v_fma_f32 v64, v56, v72, v73
    v_fma_f32 v49, v41, v68, v69
    v_fma_f32 v65, v57, v72, v73
    s_lshl_b32 s70, s91, 15
    s_add_u32 s70, s70, s92
    v_fma_f32 v50, v42, v68, v69
    v_fma_f32 v66, v58, v72, v73
    v_fma_f32 v51, v43, v68, v69
    s_add_u32 s91, s91, 1
    buffer_load_dwordx4 v124, s[32:35], s70 offen offset:0 lds
    v_fma_f32 v67, v59, v72, v73
    buffer_load_dwordx4 v125, s[32:35], s70 offen offset:1024 lds
    buffer_load_dwordx4 v126, s[32:35], s70 offen offset:2048 lds
    buffer_load_dwordx4 v127, s[32:35], s70 offen offset:3072 lds
    s_add_u32 m0, m0, 16384
    s_add_u32 s70, s70, 128
    buffer_load_dwordx4 v124, s[32:35], s70 offen offset:0 lds
    buffer_load_dwordx4 v125, s[32:35], s70 offen offset:1024 lds
    buffer_load_dwordx4 v126, s[32:35], s70 offen offset:2048 lds
    buffer_load_dwordx4 v127, s[32:35], s70 offen offset:3072 lds
    v_lshrrev_b32 v10, 4, v0
    v_and_b32 v11, 15, v0
    s_lshl_b32 s64, s3, 11
    s_add_u32 s64, s64, 57344
    v_add_u32 v4, s64, v3
    v_lshrrev_b32 v5, 1, v11
    v_lshlrev_b32 v5, 14, v5
    v_lshl_add_u32 v5, v10, 4, v5
    v_and_b32 v16, 1, v0
    v_lshl_add_u32 v5, v16, 6, v5
    s_lshl_b32 s66, s7, 11
    s_lshl_b32 s67, s3, 9
    s_add_u32 s66, s66, s67
    v_add_u32 v5, s66, v5
    s_lshl_b32 s66, s3, 15
    s_add_u32 s66, s66, 32768
    v_add_u32 v12, s66, v3
    s_waitcnt vmcnt(36)
    v_lshlrev_b32 v20, 16, v80
    v_and_b32 v21, s62, v80
    v_lshlrev_b32 v22, 16, v81
    v_and_b32 v23, s62, v81
    s_waitcnt vmcnt(35)
    v_lshlrev_b32 v24, 16, v82
    v_and_b32 v25, s62, v82
    v_lshlrev_b32 v26, 16, v83
    v_and_b32 v27, s62, v83
    s_waitcnt vmcnt(34)
    v_lshlrev_b32 v28, 16, v84
    v_and_b32 v29, s62, v84
    v_lshlrev_b32 v30, 16, v85
    v_and_b32 v31, s62, v85
    v_min_u32 v6, 31, v0
    v_lshlrev_b32 v6, 2, v6
    v_and_b32 v16, 7, v0
    v_xor_b32 v16, v16, v10
    v_lshlrev_b32 v16, 4, v16
    v_lshl_add_u32 v8, v11, 7, v16
    v_xor_b32 v34, 64, v8
    v_and_b32 v16, 3, v0
    v_lshlrev_b32 v16, 4, v16
    v_lshrrev_b32 v17, 2, v11
    v_lshl_add_u32 v16, v17, 7, v16
    v_lshl_add_u32 v7, v10, 11, v16
    s_lshl_b32 s64, s7, 14
    s_lshl_b32 s65, s99, 6
    s_add_u32 s64, s64, s65
    v_add_u32 v7, s64, v7
    s_lshl4_add_u32 s64, s6, s95
    s_lshl_b32 s64, s64, 11
    v_lshl_add_u32 v35, v0, 3, s64
    s_lshl_b32 s64, s99, 3
    s_add_u32 s64, s64, 62464
    v_add_u32 v13, s64, v3
    s_and_b32 s64, s95, 7
    v_and_b32 v16, 7, v0
    v_xor_b32 v16, s64, v16
    v_lshlrev_b32 v16, 4, v16
    v_lshrrev_b32 v17, 3, v0
    v_lshl_add_u32 v16, v17, 11, v16
    s_lshl_b32 s64, s95, 7
    v_add_u32 v15, s64, v16
    v_and_b32 v16, 1, v11
    v_lshlrev_b32 v16, 4, v16
    v_mov_b32 v17, 0x3f80
    v_lshlrev_b32 v16, v16, v17
    v_lshrrev_b32 v11, 1, v11
    v_cmp_eq_u32 vcc, 0, v11
    s_nop 1
    v_cndmask_b32 v17, 0, v16, vcc
    v_accvgpr_write_b32 a192, v17
    v_cmp_eq_u32 vcc, 1, v11
    s_nop 1
    v_cndmask_b32 v17, 0, v16, vcc
    v_accvgpr_write_b32 a193, v17
    v_cmp_eq_u32 vcc, 2, v11
    s_nop 1
    v_cndmask_b32 v17, 0, v16, vcc
    v_accvgpr_write_b32 a194, v17
    v_cmp_eq_u32 vcc, 3, v11
    s_nop 1
    v_cndmask_b32 v17, 0, v16, vcc
    v_accvgpr_write_b32 a195, v17
    v_cmp_eq_u32 vcc, 4, v11
    s_nop 1
    v_cndmask_b32 v17, 0, v16, vcc
    v_accvgpr_write_b32 a196, v17
    v_cmp_eq_u32 vcc, 5, v11
    s_nop 1
    v_cndmask_b32 v17, 0, v16, vcc
    v_accvgpr_write_b32 a197, v17
    v_cmp_eq_u32 vcc, 6, v11
    s_nop 1
    v_cndmask_b32 v17, 0, v16, vcc
    v_accvgpr_write_b32 a198, v17
    v_cmp_eq_u32 vcc, 7, v11
    s_nop 1
    v_cndmask_b32 v17, 0, v16, vcc
    v_accvgpr_write_b32 a199, v17
    v_xor_b32 v10, 0x800, v4
    s_mov_b32 s10, 400000
    s_nop 0
L_poll_31:
    buffer_load_dwordx4 v[96:99], v3, s[12:15], s79 offen sc1
    buffer_load_dwordx4 v[100:103], v3, s[12:15], s79 offen offset:1024 sc1
    s_waitcnt vmcnt(0)
    v_xor_b32 v96, s8, v96
    v_xor_b32 v97, s8, v97
    v_xor_b32 v98, s8, v98
    v_xor_b32 v99, s8, v99
    v_xor_b32 v100, s8, v100
    v_xor_b32 v101, s8, v101
    v_xor_b32 v102, s8, v102
    v_xor_b32 v103, s8, v103
    v_or3_b32 v96, v96, v97, v98
    v_or3_b32 v99, v99, v100, v101
    v_or3_b32 v96, v96, v102, v103
    v_or_b32 v96, v96, v99
    v_cmp_ne_u32 vcc, 0, v96
    s_nop 0
    s_cbranch_vccz L_polld_32
    s_sleep 12
    s_sub_u32 s10, s10, 1
    s_cmp_lg_u32 s10, 0
    s_cbranch_scc1 L_poll_31
L_polld_32:
    buffer_load_dwordx2 v[76:77], v19, s[12:15], s78 offen sc1
    s_add_u32 s78, s78, 4096
    buffer_load_dwordx2 v[78:79], v19, s[12:15], s78 offen sc1
    s_add_u32 s78, s78, 4096
    buffer_load_dwordx2 v[80:81], v19, s[12:15], s78 offen sc1
    s_add_u32 s78, s78, 4096
    buffer_load_dwordx2 v[82:83], v19, s[12:15], s78 offen sc1
    s_add_u32 s78, s78, 1036288
    s_lshl_b32 s64, s3, 15
    s_add_u32 s64, s64, 32768
    v_add_u32 v116, s64, v112
    v_add_u32 v117, s64, v113
    v_add_u32 v118, s64, v114
    v_add_u32 v119, s64, v115
    ds_read_b64_tr_b16 v[128:129], v116 offset:0
    ds_read_b64_tr_b16 v[130:131], v116 offset:2048
    ds_read_b64_tr_b16 v[132:133], v117 offset:0
    ds_read_b64_tr_b16 v[134:135], v117 offset:2048
    ds_read_b64_tr_b16 v[136:137], v118 offset:0
    ds_read_b64_tr_b16 v[138:139], v118 offset:2048
    ds_read_b64_tr_b16 v[140:141], v119 offset:0
    ds_read_b64_tr_b16 v[142:143], v119 offset:2048
    ds_read_b64_tr_b16 v[144:145], v116 offset:16384
    ds_read_b64_tr_b16 v[146:147], v116 offset:18432
    ds_read_b64_tr_b16 v[148:149], v117 offset:16384
    ds_read_b64_tr_b16 v[150:151], v117 offset:18432
    ds_read_b64_tr_b16 v[152:153], v118 offset:16384
    ds_read_b64_tr_b16 v[154:155], v118 offset:18432
    ds_read_b64_tr_b16 v[156:157], v119 offset:16384
    ds_read_b64_tr_b16 v[158:159], v119 offset:18432
    ds_read_b64_tr_b16 v[160:161], v116 offset:4096
    ds_read_b64_tr_b16 v[162:163], v116 offset:6144
    ds_read_b64_tr_b16 v[164:165], v117 offset:4096
    ds_read_b64_tr_b16 v[166:167], v117 offset:6144
    ds_read_b64_tr_b16 v[168:169], v118 offset:4096
    ds_read_b64_tr_b16 v[170:171], v118 offset:6144
    ds_read_b64_tr_b16 v[172:173], v119 offset:4096
    ds_read_b64_tr_b16 v[174:175], v119 offset:6144
    ds_read_b64_tr_b16 v[176:177], v116 offset:20480
    ds_read_b64_tr_b16 v[178:179], v116 offset:22528
    ds_read_b64_tr_b16 v[180:181], v117 offset:20480
    ds_read_b64_tr_b16 v[182:183], v117 offset:22528
    ds_read_b64_tr_b16 v[184:185], v118 offset:20480
    ds_read_b64_tr_b16 v[186:187], v118 offset:22528
    ds_read_b64_tr_b16 v[188:189], v119 offset:20480
    ds_read_b64_tr_b16 v[190:191], v119 offset:22528
    ds_read_b64_tr_b16 v[192:193], v116 offset:8192
    ds_read_b64_tr_b16 v[194:195], v116 offset:10240
    ds_read_b64_tr_b16 v[196:197], v117 offset:8192
    ds_read_b64_tr_b16 v[198:199], v117 offset:10240
    ds_read_b64_tr_b16 v[200:201], v118 offset:8192
    ds_read_b64_tr_b16 v[202:203], v118 offset:10240
    ds_read_b64_tr_b16 v[204:205], v119 offset:8192
    ds_read_b64_tr_b16 v[206:207], v119 offset:10240
    ds_read_b64_tr_b16 v[208:209], v116 offset:24576
    ds_read_b64_tr_b16 v[210:211], v116 offset:26624
    ds_read_b64_tr_b16 v[212:213], v117 offset:24576
    ds_read_b64_tr_b16 v[214:215], v117 offset:26624
    ds_read_b64_tr_b16 v[216:217], v118 offset:24576
    ds_read_b64_tr_b16 v[218:219], v118 offset:26624
    ds_read_b64_tr_b16 v[220:221], v119 offset:24576
    ds_read_b64_tr_b16 v[222:223], v119 offset:26624
    ds_read_b64_tr_b16 v[224:225], v116 offset:12288
    ds_read_b64_tr_b16 v[226:227], v116 offset:14336
    ds_read_b64_tr_b16 v[228:229], v117 offset:12288
    ds_read_b64_tr_b16 v[230:231], v117 offset:14336
    ds_read_b64_tr_b16 v[232:233], v118 offset:12288
    ds_read_b64_tr_b16 v[234:235], v118 offset:14336
    ds_read_b64_tr_b16 v[236:237], v119 offset:12288
    ds_read_b64_tr_b16 v[238:239], v119 offset:14336
    ds_read_b64_tr_b16 v[240:241], v116 offset:28672
    ds_read_b64_tr_b16 v[242:243], v116 offset:30720
    ds_read_b64_tr_b16 v[244:245], v117 offset:28672
    ds_read_b64_tr_b16 v[246:247], v117 offset:30720
    ds_read_b64_tr_b16 v[248:249], v118 offset:28672
    ds_read_b64_tr_b16 v[250:251], v118 offset:30720
    ds_read_b64_tr_b16 v[252:253], v119 offset:28672
    ds_read_b64_tr_b16 v[254:255], v119 offset:30720
L_pb_20:
    s_branch L_pbt_20
.p2align 12
L_pbt_20:
    s_waitcnt lgkmcnt(0)
    s_mov_b32 s66, 0
    s_mov_b32 s67, 16384
    s_lshl_b32 s68, s95, 2
    s_add_u32 s68, s68, 50176
    s_waitcnt vmcnt(3)
    v_lshlrev_b32 v16, 16, v76
    v_lshlrev_b32 v70, 16, v77
    v_and_b32 v17, s62, v76
    v_and_b32 v71, s62, v77
    v_fmac_f32 v36, v44, v16
    v_fmac_f32 v52, v60, v70
    v_fmac_f32 v37, v45, v17
    v_fmac_f32 v53, v61, v71
    s_waitcnt vmcnt(2)
    v_lshlrev_b32 v16, 16, v78
    v_lshlrev_b32 v70, 16, v79
    v_and_b32 v17, s62, v78
    v_and_b32 v71, s62, v79
    v_fmac_f32 v38, v46, v16
    v_fmac_f32 v54, v62, v70
    v_fmac_f32 v39, v47, v17
    v_fmac_f32 v55, v63, v71
    s_waitcnt vmcnt(1)
    v_lshlrev_b32 v16, 16, v80
    v_lshlrev_b32 v70, 16, v81
    v_and_b32 v17, s62, v80
    v_and_b32 v71, s62, v81
    v_fmac_f32 v40, v48, v16
    v_fmac_f32 v56, v64, v70
    v_fmac_f32 v41, v49, v17
    v_fmac_f32 v57, v65, v71
    s_waitcnt vmcnt(0)
    v_lshlrev_b32 v16, 16, v82
    v_lshlrev_b32 v70, 16, v83
    v_and_b32 v17, s62, v82
    v_and_b32 v71, s62, v83
    v_fmac_f32 v42, v50, v16
    v_fmac_f32 v58, v66, v70
    v_fmac_f32 v43, v51, v17
    v_fmac_f32 v59, v67, v71
    v_add_f32 v68, v36, v37
    v_add_f32 v72, v52, v53
    v_mul_f32 v69, v36, v36
    v_mul_f32 v73, v52, v52
    v_fmac_f32 v69, v37, v37
    v_fmac_f32 v73, v53, v53
    v_add_f32 v68, v68, v38
    v_add_f32 v72, v72, v54
    v_fmac_f32 v69, v38, v38
    v_fmac_f32 v73, v54, v54
    v_add_f32 v68, v68, v39
    v_add_f32 v72, v72, v55
    v_fmac_f32 v69, v39, v39
    v_fmac_f32 v73, v55, v55
    v_add_f32 v68, v68, v40
    v_add_f32 v72, v72, v56
    v_fmac_f32 v69, v40, v40
    v_fmac_f32 v73, v56, v56
    v_add_f32 v68, v68, v41
    v_add_f32 v72, v72, v57
    v_fmac_f32 v69, v41, v41
    v_fmac_f32 v73, v57, v57
    v_add_f32 v68, v68, v42
    v_add_f32 v72, v72, v58
    v_fmac_f32 v69, v42, v42
    v_fmac_f32 v73, v58, v58
    v_add_f32 v68, v68, v43
    v_add_f32 v72, v72, v59
    v_fmac_f32 v69, v43, v43
    v_fmac_f32 v73, v59, v59
    s_nop 0
    v_permlane32_swap_b32 v68, v69
    v_permlane32_swap_b32 v72, v73
    v_add_f32 v68, v68, v69
    v_add_f32 v72, v72, v73
    s_nop 0
    v_add_f32_dpp v68, v68, v68 quad_perm:[1,0,3,2] row_mask:0xf bank_mask:0xf
    v_add_f32_dpp v72, v72, v72 quad_perm:[1,0,3,2] row_mask:0xf bank_mask:0xf
    s_nop 0
    v_add_f32_dpp v68, v68, v68 quad_perm:[2,3,0,1] row_mask:0xf bank_mask:0xf
    v_add_f32_dpp v72, v72, v72 quad_perm:[2,3,0,1] row_mask:0xf bank_mask:0xf
    s_nop 0
    v_add_f32_dpp v68, v68, v68 row_half_mirror row_mask:0xf bank_mask:0xf
    v_add_f32_dpp v72, v72, v72 row_half_mirror row_mask:0xf bank_mask:0xf
    s_nop 0
    v_add_f32_dpp v68, v68, v68 row_mirror row_mask:0xf bank_mask:0xf
    v_add_f32_dpp v72, v72, v72 row_mirror row_mask:0xf bank_mask:0xf
    s_nop 0
    v_add_f32_dpp v68, v68, v68 row_bcast:15 row_mask:0xa bank_mask:0xf
    v_add_f32_dpp v72, v72, v72 row_bcast:15 row_mask:0xa bank_mask:0xf
    v_mul_f32 v68, 0x3b000000, v68
    v_mul_f32 v72, 0x3b000000, v72
    v_readlane_b32 s72, v68, 31
    v_readlane_b32 s74, v72, 31
    v_readlane_b32 s73, v68, 63
    v_readlane_b32 s75, v72, 63
    v_mov_b32 v69, s72
    v_mov_b32 v73, s74
    v_fma_f32 v68, -v69, v69, s73
    v_fma_f32 v72, -v73, v73, s75
    v_max_f32 v68, 0, v68
    v_max_f32 v72, 0, v72
    v_add_f32 v68, 0x3727c5ac, v68
    v_add_f32 v72, 0x3727c5ac, v72
    v_rsq_f32 v68, v68
    v_rsq_f32 v72, v72
    v_mul_f32_e64 v69, -v69, v68
    v_mul_f32_e64 v73, -v73, v72
    v_fma_f32 v44, v36, v68, v69
    v_fma_f32 v60, v52, v72, v73
    v_fma_f32 v45, v37, v68, v69
    v_fma_f32 v61, v53, v72, v73
    v_fma_f32 v46, v38, v68, v69
    v_fma_f32 v62, v54, v72, v73
    v_fma_f32 v47, v39, v68, v69
    v_fma_f32 v63, v55, v72, v73
    v_fma_f32 v48, v40, v68, v69
    v_fma_f32 v64, v56, v72, v73
    v_fma_f32 v49, v41, v68, v69
    v_fma_f32 v65, v57, v72, v73
    v_fma_f32 v50, v42, v68, v69
    v_fma_f32 v66, v58, v72, v73
    v_fma_f32 v51, v43, v68, v69
    v_fma_f32 v67, v59, v72, v73
    v_cvt_pk_bf16_f32 v44, v44, v45
    v_cvt_pk_bf16_f32 v60, v60, v61
    v_cvt_pk_bf16_f32 v45, v46, v47
    v_cvt_pk_bf16_f32 v61, v62, v63
    v_cvt_pk_bf16_f32 v46, v48, v49
    v_cvt_pk_bf16_f32 v62, v64, v65
    v_cvt_pk_bf16_f32 v47, v50, v51
    v_cvt_pk_bf16_f32 v63, v66, v67
    buffer_store_dwordx4 v[44:47], v15, s[20:23], s66 offen
    buffer_store_dwordx4 v[60:63], v15, s[20:23], s67 offen
    v_mov_b32 v68, v76
    v_mov_b32 v69, v78
    v_mov_b32 v70, v80
    v_mov_b32 v71, v82
    v_mov_b32 v72, v77
    v_mov_b32 v73, v79
    v_mov_b32 v74, v81
    v_mov_b32 v75, v83
    s_mul_i32 s92, s7, 229376
    s_lshl_b32 s70, s3, 8
    s_add_u32 s92, s92, s70
    s_cmp_eq_u32 s3, 3
    s_cselect_b32 s77, 6, 4
    s_cselect_b32 s71, -1, 1
    s_add_u32 s77, s77, s100
    s_lshl_b32 s93, s3, 15
    s_add_u32 s93, s93, 32768
    s_and_b32 s91, s6, 3
    s_cmp_ge_u32 s91, 3
    s_cselect_b32 s91, 0, s91
    s_lshl_b32 s70, s91, 12
    s_add_u32 m0, s70, s93
    s_mul_i32 s70, s91, s71
    s_add_u32 s70, s70, s77
    s_cmp_eq_u32 s70, 7
    s_cselect_b32 s70, 0, s70
    s_lshl_b32 s70, s70, 15
    s_add_u32 s70, s70, s92
    s_add_u32 s91, s91, 1
    buffer_load_dwordx4 v124, s[32:35], s70 offen offset:0 lds
    buffer_load_dwordx4 v125, s[32:35], s70 offen offset:1024 lds
    buffer_load_dwordx4 v126, s[32:35], s70 offen offset:2048 lds
    buffer_load_dwordx4 v127, s[32:35], s70 offen offset:3072 lds
    s_add_u32 m0, m0, 12288
    s_add_u32 s70, s70, 128
    buffer_load_dwordx4 v124, s[32:35], s70 offen offset:0 lds
    buffer_load_dwordx4 v125, s[32:35], s70 offen offset:1024 lds
    buffer_load_dwordx4 v126, s[32:35], s70 offen offset:2048 lds
    buffer_load_dwordx4 v127, s[32:35], s70 offen offset:3072 lds
    s_cmp_ge_u32 s91, 3
    s_cselect_b32 s91, 0, s91
    s_lshl_b32 s70, s91, 12
    s_add_u32 m0, s70, s93
    s_mul_i32 s70, s91, s71
    s_add_u32 s70, s70, s77
    s_cmp_eq_u32 s70, 7
    s_cselect_b32 s70, 0, s70
    s_lshl_b32 s70, s70, 15
    s_add_u32 s70, s70, s92
    s_add_u32 s91, s91, 1
    buffer_load_dwordx4 v124, s[32:35], s70 offen offset:0 lds
    buffer_load_dwordx4 v125, s[32:35], s70 offen offset:1024 lds
    buffer_load_dwordx4 v126, s[32:35], s70 offen offset:2048 lds
    buffer_load_dwordx4 v127, s[32:35], s70 offen offset:3072 lds
    s_add_u32 m0, m0, 12288
    s_add_u32 s70, s70, 128
    buffer_load_dwordx4 v124, s[32:35], s70 offen offset:0 lds
    buffer_load_dwordx4 v125, s[32:35], s70 offen offset:1024 lds
    buffer_load_dwordx4 v126, s[32:35], s70 offen offset:2048 lds
    buffer_load_dwordx4 v127, s[32:35], s70 offen offset:3072 lds
    s_cmp_ge_u32 s91, 3
    s_cselect_b32 s91, 0, s91
    s_lshl_b32 s70, s91, 12
    s_add_u32 m0, s70, s93
    s_mul_i32 s70, s91, s71
    s_add_u32 s70, s70, s77
    s_cmp_eq_u32 s70, 7
    s_cselect_b32 s70, 0, s70
    s_lshl_b32 s70, s70, 15
    s_add_u32 s70, s70, s92
    s_add_u32 s91, s91, 1
    buffer_load_dwordx4 v124, s[32:35], s70 offen offset:0 lds
    buffer_load_dwordx4 v125, s[32:35], s70 offen offset:1024 lds
    buffer_load_dwordx4 v126, s[32:35], s70 offen offset:2048 lds
    buffer_load_dwordx4 v127, s[32:35], s70 offen offset:3072 lds
    s_add_u32 m0, m0, 12288
    s_add_u32 s70, s70, 128
    buffer_load_dwordx4 v124, s[32:35], s70 offen offset:0 lds
    buffer_load_dwordx4 v125, s[32:35], s70 offen offset:1024 lds
    buffer_load_dwordx4 v126, s[32:35], s70 offen offset:2048 lds
    buffer_load_dwordx4 v127, s[32:35], s70 offen offset:3072 lds
    v_lshlrev_b32 v120, 16, v90
    v_and_b32 v121, s62, v90
    v_lshlrev_b32 v122, 16, v91
    v_and_b32 v123, s62, v91
    v_lshlrev_b32 v124, 16, v92
    v_and_b32 v125, s62, v92
    v_lshlrev_b32 v126, 16, v93
    v_and_b32 v127, s62, v93
    v_add_u32 v18, 24576, v12
    v_add_f32 v36, v36, v120
    v_add_f32 v37, v37, v121
    v_add_f32 v38, v38, v122
    v_add_f32 v39, v39, v123
    v_add_f32 v40, v40, v124
    v_add_f32 v41, v41, v125
    v_add_f32 v42, v42, v126
    v_add_f32 v43, v43, v127
    ds_write_b128 v18, v[36:39] offset:0
    ds_write_b128 v18, v[40:43] offset:1024
    v_add_f32 v52, v52, v120
    v_add_f32 v53, v53, v121
    v_add_f32 v54, v54, v122
    v_add_f32 v55, v55, v123
    v_add_f32 v56, v56, v124
    v_add_f32 v57, v57, v125
    v_add_f32 v58, v58, v126
    v_add_f32 v59, v59, v127
    ds_write_b128 v18, v[52:55] offset:2048
    ds_write_b128 v18, v[56:59] offset:3072
    v_lshlrev_b32 v44, 16, v104
    v_and_b32 v45, s62, v104
    v_lshlrev_b32 v46, 16, v105
    v_and_b32 v47, s62, v105
    v_lshlrev_b32 v48, 16, v106
    v_and_b32 v49, s62, v106
    v_lshlrev_b32 v50, 16, v107
    v_and_b32 v51, s62, v107
    ds_write_b128 v18, v[44:47] offset:4096
    ds_write_b128 v18, v[48:51] offset:5120
    v_lshlrev_b32 v60, 16, v108
    v_and_b32 v61, s62, v108
    v_lshlrev_b32 v62, 16, v109
    v_and_b32 v63, s62, v109
    v_lshlrev_b32 v64, 16, v110
    v_and_b32 v65, s62, v110
    v_lshlrev_b32 v66, 16, v111
    v_and_b32 v67, s62, v111
    ds_write_b128 v18, v[60:63] offset:6144
    ds_write_b128 v18, v[64:67] offset:7168
L_pb_21:
    s_waitcnt vmcnt(24)
    buffer_store_dword v1, v2, s[20:23], s68 offen
    buffer_store_dword v1, v2, s[20:23], s68 offen offset:128
    v_accvgpr_write_b32 a200, 0
    v_accvgpr_write_b32 a201, 0
    v_accvgpr_write_b32 a202, 0
    v_accvgpr_write_b32 a203, 0
    v_accvgpr_write_b32 a204, 0
    v_accvgpr_write_b32 a205, 0
    v_accvgpr_write_b32 a206, 0
    v_accvgpr_write_b32 a207, 0
    v_accvgpr_write_b32 a208, 0
    v_accvgpr_write_b32 a209, 0
    v_accvgpr_write_b32 a210, 0
    v_accvgpr_write_b32 a211, 0
    v_accvgpr_write_b32 a212, 0
    v_accvgpr_write_b32 a213, 0
    v_accvgpr_write_b32 a214, 0
    v_accvgpr_write_b32 a215, 0
    v_accvgpr_write_b32 a216, 0
    v_accvgpr_write_b32 a217, 0
    v_accvgpr_write_b32 a218, 0
    v_accvgpr_write_b32 a219, 0
    v_accvgpr_write_b32 a220, 0
    v_accvgpr_write_b32 a221, 0
    v_accvgpr_write_b32 a222, 0
    v_accvgpr_write_b32 a223, 0
    v_accvgpr_write_b32 a224, 0
    v_accvgpr_write_b32 a225, 0
    v_accvgpr_write_b32 a226, 0
    v_accvgpr_write_b32 a227, 0
    v_accvgpr_write_b32 a228, 0
    v_accvgpr_write_b32 a229, 0
    v_accvgpr_write_b32 a230, 0
    v_accvgpr_write_b32 a231, 0
    s_add_u32 s79, s79, 2048
    s_mov_b32 s10, 400000
L_poll_33:
    buffer_load_dwordx4 v[96:99], v3, s[12:15], s79 offen sc1
    buffer_load_dwordx4 v[100:103], v3, s[12:15], s79 offen offset:1024 sc1
    s_waitcnt vmcnt(0)
    v_xor_b32 v96, s8, v96
    v_xor_b32 v97, s8, v97
    v_xor_b32 v98, s8, v98
    v_xor_b32 v99, s8, v99
    v_xor_b32 v100, s8, v100
    v_xor_b32 v101, s8, v101
    v_xor_b32 v102, s8, v102
    v_xor_b32 v103, s8, v103
    v_or3_b32 v96, v96, v97, v98
    v_or3_b32 v99, v99, v100, v101
    v_or3_b32 v96, v96, v102, v103
    v_or_b32 v96, v96, v99
    v_cmp_ne_u32 vcc, 0, v96
    s_nop 0
    s_cbranch_vccz L_polld_34
    s_sleep 12
    s_sub_u32 s10, s10, 1
    s_cmp_lg_u32 s10, 0
    s_cbranch_scc1 L_poll_33
L_polld_34:
    buffer_load_dwordx2 v[104:105], v19, s[12:15], s78 offen sc1
    s_add_u32 s78, s78, 4096
    buffer_load_dwordx2 v[106:107], v19, s[12:15], s78 offen sc1
    s_add_u32 s78, s78, 4096
    buffer_load_dwordx2 v[108:109], v19, s[12:15], s78 offen sc1
    s_add_u32 s78, s78, 4096
    buffer_load_dwordx2 v[110:111], v19, s[12:15], s78 offen sc1
    s_add_u32 s78, s78, 1036288
    s_add_u32 s65, s2, s99
    s_cmp_eq_u32 s65, 0
    s_cselect_b32 s65, 0, 2146435072
    buffer_store_dword v1, v2, s[12:15], s65 offen sc1
L_pb_22:
    ds_read_b64_tr_b16 v[36:37], v116 offset:0
    ds_read_b64_tr_b16 v[38:39], v116 offset:2048
    ds_read_b64_tr_b16 v[40:41], v117 offset:0
    ds_read_b64_tr_b16 v[42:43], v117 offset:2048
    ds_read_b64_tr_b16 v[44:45], v118 offset:0
    ds_read_b64_tr_b16 v[46:47], v118 offset:2048
    ds_read_b64_tr_b16 v[48:49], v119 offset:0
    ds_read_b64_tr_b16 v[50:51], v119 offset:2048
    ds_read_b64_tr_b16 v[52:53], v116 offset:4096
    ds_read_b64_tr_b16 v[54:55], v116 offset:6144
    ds_read_b64_tr_b16 v[56:57], v117 offset:4096
    ds_read_b64_tr_b16 v[58:59], v117 offset:6144
    ds_read_b64_tr_b16 v[60:61], v118 offset:4096
    ds_read_b64_tr_b16 v[62:63], v118 offset:6144
    ds_read_b64_tr_b16 v[64:65], v119 offset:4096
    ds_read_b64_tr_b16 v[66:67], v119 offset:6144
    s_waitcnt lgkmcnt(8)
    v_mov_b32 v11, v51
    ds_write_b128 v12, v[36:39] offset:0
    ds_write_b128 v12, v[40:43] offset:1024
    ds_write_b128 v12, v[44:47] offset:2048
    ds_write_b128 v12, v[48:51] offset:3072
    ds_read_b64_tr_b16 v[36:37], v116 offset:8192
    ds_read_b64_tr_b16 v[38:39], v116 offset:10240
    ds_read_b64_tr_b16 v[40:41], v117 offset:8192
    ds_read_b64_tr_b16 v[42:43], v117 offset:10240
    ds_read_b64_tr_b16 v[44:45], v118 offset:8192
    ds_read_b64_tr_b16 v[46:47], v118 offset:10240
    ds_read_b64_tr_b16 v[48:49], v119 offset:8192
    ds_read_b64_tr_b16 v[50:51], v119 offset:10240
    s_waitcnt lgkmcnt(12)
    v_mov_b32 v11, v67
    ds_write_b128 v12, v[52:55] offset:4096
    ds_write_b128 v12, v[56:59] offset:5120
    ds_write_b128 v12, v[60:63] offset:6144
    ds_write_b128 v12, v[64:67] offset:7168
    ds_read_b64_tr_b16 v[52:53], v116 offset:12288
    ds_read_b64_tr_b16 v[54:55], v116 offset:14336
    ds_read_b64_tr_b16 v[56:57], v117 offset:12288
    ds_read_b64_tr_b16 v[58:59], v117 offset:14336
    ds_read_b64_tr_b16 v[60:61], v118 offset:12288
    ds_read_b64_tr_b16 v[62:63], v118 offset:14336
    ds_read_b64_tr_b16 v[64:65], v119 offset:12288
    ds_read_b64_tr_b16 v[66:67], v119 offset:14336
    s_waitcnt lgkmcnt(12)
    v_mov_b32 v11, v51
    ds_write_b128 v12, v[36:39] offset:8192
    ds_write_b128 v12, v[40:43] offset:9216
    ds_write_b128 v12, v[44:47] offset:10240
    ds_write_b128 v12, v[48:51] offset:11264
    ds_read_b64_tr_b16 v[36:37], v116 offset:16384
    ds_read_b64_tr_b16 v[38:39], v116 offset:18432
    ds_read_b64_tr_b16 v[40:41], v117 offset:16384
    ds_read_b64_tr_b16 v[42:43], v117 offset:18432
    ds_read_b64_tr_b16 v[44:45], v118 offset:16384
    ds_read_b64_tr_b16 v[46:47], v118 offset:18432
    ds_read_b64_tr_b16 v[48:49], v119 offset:16384
    ds_read_b64_tr_b16 v[50:51], v119 offset:18432
    s_waitcnt lgkmcnt(12)
    v_mov_b32 v11, v67
    ds_write_b128 v12, v[52:55] offset:12288
    ds_write_b128 v12, v[56:59] offset:13312
    ds_write_b128 v12, v[60:63] offset:14336
    ds_write_b128 v12, v[64:67] offset:15360
    ds_read_b64_tr_b16 v[52:53], v116 offset:20480
    ds_read_b64_tr_b16 v[54:55], v116 offset:22528
    ds_read_b64_tr_b16 v[56:57], v117 offset:20480
    ds_read_b64_tr_b16 v[58:59], v117 offset:22528
    ds_read_b64_tr_b16 v[60:61], v118 offset:20480
    ds_read_b64_tr_b16 v[62:63], v118 offset:22528
    ds_read_b64_tr_b16 v[64:65], v119 offset:20480
    ds_read_b64_tr_b16 v[66:67], v119 offset:22528
    s_waitcnt lgkmcnt(12)
    v_mov_b32 v11, v51
    ds_write_b128 v12, v[36:39] offset:16384
    ds_write_b128 v12, v[40:43] offset:17408
    ds_write_b128 v12, v[44:47] offset:18432
    ds_write_b128 v12, v[48:51] offset:19456
    s_waitcnt lgkmcnt(4)
    v_mov_b32 v11, v67
    ds_write_b128 v12, v[52:55] offset:20480
    ds_write_b128 v12, v[56:59] offset:21504
    ds_write_b128 v12, v[60:63] offset:22528
    ds_write_b128 v12, v[64:67] offset:23552
    s_waitcnt vmcnt(4)
    v_mov_b32 v96, v104
    s_waitcnt vmcnt(3)
    v_mov_b32 v97, v106
    s_waitcnt vmcnt(2)
    v_mov_b32 v98, v108
    s_waitcnt vmcnt(1)
    v_mov_b32 v99, v110
    v_mov_b32 v100, v105
    v_mov_b32 v101, v107
    v_mov_b32 v102, v109
    v_mov_b32 v103, v111
    s_mov_b32 s80, 0
    s_mov_b32 s94, 0
    s_mov_b32 s82, 2146435072
    s_mov_b32 s83, 2146435072
    s_lshl2_add_u32 s90, s7, s3
    s_lshl_b32 s90, s90, 2
    s_add_u32 s90, s90, 49152
    s_lshl_b32 s70, s95, 2
    s_add_u32 s70, s70, 50304
    s_lshl_b32 s71, s99, 12
    s_add_u32 s71, s71, 90112
    s_mov_b32 s88, 16384
    v_add_u32 v16, s71, v3
L_pb_23:
    s_branch L_pbt_23
.p2align 12
L_pbt_23:
    s_waitcnt vmcnt(0) lgkmcnt(0)
    s_barrier
    ds_write_b128 v16, v[68:71] offset:0
    ds_write_b128 v16, v[72:75] offset:1024
    ds_write_b128 v16, v[96:99] offset:2048
    ds_write_b128 v16, v[100:103] offset:3072
    ds_read_b128 v[84:87], v8 offset:0
    ds_read_b128 v[88:91], v34 offset:0
    s_waitcnt lgkmcnt(0)
L_pass_35:
    ds_read_b128 v[92:95], v8 offset:2048
    s_waitcnt lgkmcnt(2)
    v_mfma_f32_16x16x32_bf16 v[36:39], a[0:3], v[84:87], v[20:23]
    s_add_u32 s65, s80, 2
    s_and_b32 s65, s65, 3
    s_lshl_b32 s67, s65, 11
    v_mfma_f32_16x16x32_bf16 v[40:43], a[64:67], v[84:87], v[24:27]
    v_add_u32 v14, s67, v12
    ds_read_b128 v[112:115], v14 offset:24576
    v_mfma_f32_16x16x32_bf16 v[44:47], a[128:131], v[84:87], v[28:31]
    ds_read_b128 v[84:87], v34 offset:2048
    v_cvt_pk_bf16_f32 v64, v64, v65
    s_waitcnt lgkmcnt(3)
    v_mfma_f32_16x16x32_bf16 v[36:39], a[4:7], v[88:91], v[36:39]
    v_cvt_pk_bf16_f32 v65, v66, v67
    ds_read_b128 v[116:119], v14 offset:25600
    v_mfma_f32_16x16x32_bf16 v[40:43], a[68:71], v[88:91], v[40:43]
    v_cvt_pk_bf16_f32 v66, v80, v81
    v_mfma_f32_16x16x32_bf16 v[44:47], a[132:135], v[88:91], v[44:47]
    s_waitcnt vmcnt(2)
    buffer_store_dword v1, v2, s[20:23], s70 offen
    s_add_u32 s70, s70, 128
    ds_read_b128 v[88:91], v8 offset:4096
    v_cvt_pk_bf16_f32 v67, v82, v83
    s_waitcnt lgkmcnt(3)
    v_mfma_f32_16x16x32_bf16 v[112:115], a[192:195], a[200:203], v[112:115]
    s_bitcmp1_b32 6, s80
    s_cbranch_scc1 L_pss_36
    buffer_store_dwordx4 v[64:67], v5, s[44:47], s82 offen offset:384
L_psb_37:
    s_waitcnt lgkmcnt(1)
    v_mfma_f32_16x16x32_bf16 v[116:119], a[192:195], a[208:211], v[116:119]
    s_lshl_b32 s67, s65, 10
    s_add_u32 s67, s67, s71
    v_add_u32 v16, s67, v3
    v_mfma_f32_16x16x32_bf16 v[112:115], a[196:199], a[204:207], v[112:115]
    ds_read_b128 v[96:99], v34 offset:4096
    v_mfma_f32_16x16x32_bf16 v[116:119], a[196:199], a[212:215], v[116:119]
    ds_read_b128 v[48:51], v16
    v_mfma_f32_16x16x32_bf16 v[112:115], a[192:195], a[216:219], v[112:115]
    s_add_u32 s88, s88, 16384
    s_cmp_ge_u32 s88, 49152
    s_cselect_b32 s88, 0, s88
    v_mfma_f32_16x16x32_bf16 v[116:119], a[192:195], a[224:227], v[116:119]
    ds_read_b128 v[100:103], v8 offset:6144
    v_mfma_f32_16x16x32_bf16 v[112:115], a[196:199], a[220:223], v[112:115]
    s_lshl_b32 s89, s65, 10
    s_cmp_lt_u32 s80, 6
    s_cselect_b32 s89, 2146435072, s89
    v_mfma_f32_16x16x32_bf16 v[116:119], a[196:199], a[228:231], v[116:119]
    s_nop 2
    v_mfma_f32_16x16x32_bf16 v[36:39], a[8:11], v[92:95], v[36:39]
    ds_read_b128 v[104:107], v34 offset:6144
    v_add_f32 v32, v112, v113
    v_mfma_f32_16x16x32_bf16 v[40:43], a[72:75], v[92:95], v[40:43]
    v_mul_f32 v33, v112, v112
    v_fmac_f32 v33, v113, v113
    v_mfma_f32_16x16x32_bf16 v[44:47], a[136:139], v[92:95], v[44:47]
    v_add_f32 v32, v32, v114
    v_fmac_f32 v33, v114, v114
    v_mfma_f32_16x16x32_bf16 v[36:39], a[12:15], v[84:87], v[36:39]
    ds_read_b128 v[92:95], v8 offset:8192
    v_add_f32 v32, v32, v115
    v_mfma_f32_16x16x32_bf16 v[40:43], a[76:79], v[84:87], v[40:43]
    v_fmac_f32 v33, v115, v115
    v_add_f32 v32, v32, v116
    v_mfma_f32_16x16x32_bf16 v[44:47], a[140:143], v[84:87], v[44:47]
    s_waitcnt lgkmcnt(4)
    v_fmac_f32 v33, v116, v116
    v_add_f32 v32, v32, v117
    v_mfma_f32_16x16x32_bf16 v[36:39], a[16:19], v[88:91], v[36:39]
    ds_read_b128 v[84:87], v34 offset:8192
    v_fmac_f32 v33, v117, v117
    v_mfma_f32_16x16x32_bf16 v[40:43], a[80:83], v[88:91], v[40:43]
    v_add_f32 v32, v32, v118
    v_fmac_f32 v33, v118, v118
    v_mfma_f32_16x16x32_bf16 v[44:47], a[144:147], v[88:91], v[44:47]
    v_add_f32 v32, v32, v119
    v_fmac_f32 v33, v119, v119
    v_mfma_f32_16x16x32_bf16 v[36:39], a[20:23], v[96:99], v[36:39]
    ds_read_b128 v[88:91], v8 offset:10240
    v_permlane32_swap_b32 v32, v33
    v_mfma_f32_16x16x32_bf16 v[40:43], a[84:87], v[96:99], v[40:43]
    v_cvt_pk_bf16_f32 v16, v112, v113
    v_add_f32 v32, v32, v33
    v_mfma_f32_16x16x32_bf16 v[44:47], a[148:151], v[96:99], v[44:47]
    s_waitcnt lgkmcnt(3)
    v_cvt_pk_bf16_f32 v17, v114, v115
    v_add_f32_dpp v32, v32, v32 quad_perm:[1,0,3,2] row_mask:0xf bank_mask:0xf
    v_mfma_f32_16x16x32_bf16 v[36:39], a[24:27], v[100:103], v[36:39]
    ds_read_b128 v[96:99], v34 offset:10240
    v_cvt_pk_bf16_f32 v18, v116, v117
    v_mfma_f32_16x16x32_bf16 v[40:43], a[88:91], v[100:103], v[40:43]
    v_add_f32_dpp v32, v32, v32 quad_perm:[2,3,0,1] row_mask:0xf bank_mask:0xf
    v_cvt_pk_bf16_f32 v19, v118, v119
    v_mfma_f32_16x16x32_bf16 v[44:47], a[152:155], v[100:103], v[44:47]
    v_add_f32_dpp v32, v32, v32 row_half_mirror row_mask:0xf bank_mask:0xf
    v_mfma_f32_16x16x32_bf16 v[36:39], a[28:31], v[104:107], v[36:39]
    buffer_store_dwordx2 v[16:17], v35, s[40:43], s89 offen
    ds_read_b128 v[100:103], v8 offset:12288
    v_mfma_f32_16x16x32_bf16 v[40:43], a[92:95], v[104:107], v[40:43]
    v_add_f32_dpp v32, v32, v32 row_mirror row_mask:0xf bank_mask:0xf
    v_mfma_f32_16x16x32_bf16 v[44:47], a[156:159], v[104:107], v[44:47]
    s_waitcnt vmcnt(1)
    buffer_store_dword v1, v2, s[20:23], s83 offen
    s_waitcnt lgkmcnt(3)
    v_mfma_f32_16x16x32_bf16 v[36:39], a[32:35], v[92:95], v[36:39]
    buffer_store_dwordx2 v[18:19], v35, s[40:43], s89 offen offset:512
    ds_read_b128 v[104:107], v34 offset:12288
    s_mov_b32 s86, s82
    v_mfma_f32_16x16x32_bf16 v[40:43], a[96:99], v[92:95], v[40:43]
    s_add_u32 s87, s82, 8192
    v_add_f32_dpp v32, v32, v32 row_bcast:15 row_mask:0xa bank_mask:0xf
    v_mul_f32 v32, 0x3b000000, v32
    v_mfma_f32_16x16x32_bf16 v[44:47], a[160:163], v[92:95], v[44:47]
    s_andn2_b32 s85, s83, 127
    v_readlane_b32 s72, v32, 31
    v_readlane_b32 s73, v32, 63
    v_mfma_f32_16x16x32_bf16 v[36:39], a[36:39], v[84:87], v[36:39]
    ds_read_b128 v[92:95], v8 offset:14336
    s_cmp_ge_u32 s80, 1
    s_cselect_b32 s84, s8, 0
    v_mfma_f32_16x16x32_bf16 v[40:43], a[100:103], v[84:87], v[40:43]
    s_and_b32 s64, s80, 1
    v_mov_b32 v33, s72
    v_fma_f32 v32, -v33, v33, s73
    v_mfma_f32_16x16x32_bf16 v[44:47], a[164:167], v[84:87], v[44:47]
    s_waitcnt lgkmcnt(3)
    s_lshl_b32 s82, s64, 17
    v_max_f32 v32, 0, v32
    v_mfma_f32_16x16x32_bf16 v[36:39], a[40:43], v[88:91], v[36:39]
    ds_read_b128 v[84:87], v34 offset:14336
    s_lshl_b32 s64, s80, 7
    v_mfma_f32_16x16x32_bf16 v[40:43], a[104:107], v[88:91], v[40:43]
    s_add_u32 s83, s64, s90
    v_add_f32 v32, 0x3727c5ac, v32
    v_mfma_f32_16x16x32_bf16 v[44:47], a[168:171], v[88:91], v[44:47]
    v_rsq_f32 v32, v32
    v_mfma_f32_16x16x32_bf16 v[36:39], a[44:47], v[96:99], v[36:39]
    v_mul_f32_e64 v33, -v33, v32
    v_lshlrev_b32 v16, 16, v48
    v_mfma_f32_16x16x32_bf16 v[40:43], a[108:111], v[96:99], v[40:43]
    v_and_b32 v17, s62, v48
    v_fma_f32 v18, v112, v32, v33
    v_mfma_f32_16x16x32_bf16 v[44:47], a[172:175], v[96:99], v[44:47]
    s_waitcnt lgkmcnt(2)
    v_fma_f32 v19, v113, v32, v33
    v_fmac_f32 v112, v18, v16
    v_mfma_f32_16x16x32_bf16 v[36:39], a[48:51], v[100:103], v[36:39]
    v_fmac_f32 v113, v19, v17
    v_lshlrev_b32 v16, 16, v49
    v_mfma_f32_16x16x32_bf16 v[40:43], a[112:115], v[100:103], v[40:43]
    ds_read_b128 v[96:99], v12 offset:0
    v_and_b32 v17, s62, v49
    v_mfma_f32_16x16x32_bf16 v[44:47], a[176:179], v[100:103], v[44:47]
    ds_read_b128 v[100:103], v12 offset:1024
    v_fma_f32 v18, v114, v32, v33
    v_mfma_f32_16x16x32_bf16 v[36:39], a[52:55], v[104:107], v[36:39]
    ds_read_b128 v[88:91], v12 offset:2048
    v_fma_f32 v19, v115, v32, v33
    v_mfma_f32_16x16x32_bf16 v[40:43], a[116:119], v[104:107], v[40:43]
    ds_read_b128 v[108:111], v12 offset:3072
    v_fmac_f32 v114, v18, v16
    v_mfma_f32_16x16x32_bf16 v[44:47], a[180:183], v[104:107], v[44:47]
    ds_read_b128 v[104:107], v12 offset:12288
    s_waitcnt lgkmcnt(5)
    v_mfma_f32_16x16x32_bf16 v[36:39], a[56:59], v[92:95], v[36:39]
    v_fmac_f32 v115, v19, v17
    v_lshlrev_b32 v16, 16, v50
    v_mfma_f32_16x16x32_bf16 v[40:43], a[120:123], v[92:95], v[40:43]
    v_and_b32 v17, s62, v50
    v_fma_f32 v18, v116, v32, v33
    v_mfma_f32_16x16x32_bf16 v[44:47], a[184:187], v[92:95], v[44:47]
    ds_read_b128 v[92:95], v12 offset:13312
    v_fma_f32 v19, v117, v32, v33
    v_mfma_f32_16x16x32_bf16 v[36:39], a[60:63], v[84:87], v[36:39]
    v_fmac_f32 v116, v18, v16
    v_fmac_f32 v117, v19, v17
    v_mfma_f32_16x16x32_bf16 v[40:43], a[124:127], v[84:87], v[40:43]
    buffer_load_dword v11, v6, s[20:23], s85 offen offset:0 sc1
    v_lshlrev_b32 v16, 16, v51
    v_and_b32 v17, s62, v51
    v_mfma_f32_16x16x32_bf16 v[44:47], a[188:191], v[84:87], v[44:47]
    v_fma_f32 v18, v118, v32, v33
    v_fma_f32 v19, v119, v32, v33
    v_fmac_f32 v118, v18, v16
    v_fmac_f32 v119, v19, v17
    v_add_f32 v32, v112, v113
    v_mul_f32 v33, v112, v112
    v_fmac_f32 v33, v113, v113
    v_add_f32 v32, v32, v114
    v_mul_f32_e64 v36, v36, |v36|
    v_mul_f32_e64 v37, v37, |v37|
    v_mul_f32_e64 v38, v38, |v38|
    v_mul_f32_e64 v39, v39, |v39|
    v_cvt_pk_bf16_f32 v36, v36, v37
    v_cvt_pk_bf16_f32 v37, v38, v39
    v_pk_max_i16 v36, v36, 0
    v_pk_max_i16 v37, v37, 0
    v_mul_f32_e64 v40, v40, |v40|
    v_mul_f32_e64 v41, v41, |v41|
    v_mul_f32_e64 v42, v42, |v42|
    v_mul_f32_e64 v43, v43, |v43|
    v_cvt_pk_bf16_f32 v38, v40, v41
    v_cvt_pk_bf16_f32 v39, v42, v43
    v_pk_max_i16 v38, v38, 0
    v_pk_max_i16 v39, v39, 0
    ds_write_b128 v4, v[36:39]
    v_mul_f32_e64 v44, v44, |v44|
    v_mul_f32_e64 v45, v45, |v45|
    v_mul_f32_e64 v46, v46, |v46|
    v_mul_f32_e64 v47, v47, |v47|
    v_cvt_pk_bf16_f32 v44, v44, v45
    v_cvt_pk_bf16_f32 v45, v46, v47
    v_pk_max_i16 v44, v44, 0
    v_pk_max_i16 v45, v45, 0
    ds_write_b64 v13, v[44:45]
    v_fmac_f32 v33, v114, v114
    v_add_f32 v32, v32, v115
    v_fmac_f32 v33, v115, v115
    v_add_f32 v32, v32, v116
    v_fmac_f32 v33, v116, v116
    v_add_f32 v32, v32, v117
    v_fmac_f32 v33, v117, v117
    v_add_f32 v32, v32, v118
    v_fmac_f32 v33, v118, v118
    v_add_f32 v32, v32, v119
    ds_read_b128 v[84:87], v12 offset:14336
    s_waitcnt lgkmcnt(7)
    v_mfma_f32_16x16x32_bf16 v[52:55], v[96:99], v[36:39], 0
    ds_read_b128 v[40:43], v12 offset:15360
    v_fmac_f32 v33, v119, v119
    v_mfma_f32_16x16x32_bf16 v[56:59], v[100:103], v[36:39], 0
    s_waitcnt lgkmcnt(2)
    s_barrier
    ds_read_b128 v[100:103], v3 offset:57344
    v_mfma_f32_16x16x32_bf16 v[60:63], v[88:91], v[36:39], 0
    ds_read_b128 v[44:47], v3 offset:58368
    v_permlane32_swap_b32 v32, v33
    v_mfma_f32_16x16x32_bf16 v[64:67], v[108:111], v[36:39], 0
    ds_read_b128 v[96:99], v10 offset:0
    v_add_f32 v32, v32, v33
    v_mfma_f32_16x16x32_bf16 v[68:71], v[104:107], v[36:39], 0
    ds_read_b128 v[108:111], v3 offset:59392
    v_add_f32_dpp v32, v32, v32 quad_perm:[1,0,3,2] row_mask:0xf bank_mask:0xf
    v_mfma_f32_16x16x32_bf16 v[72:75], v[92:95], v[36:39], 0
    ds_read_b128 v[104:107], v3 offset:62464
    s_waitcnt lgkmcnt(5)
    v_mfma_f32_16x16x32_bf16 v[76:79], v[84:87], v[36:39], 0
    v_add_f32_dpp v32, v32, v32 quad_perm:[2,3,0,1] row_mask:0xf bank_mask:0xf
    v_mfma_f32_16x16x32_bf16 v[80:83], v[40:43], v[36:39], 0
    ds_read_b128 v[40:43], v12 offset:8192
    s_waitcnt lgkmcnt(5)
    v_mfma_f32_16x16x32_bf16 v[52:55], v[128:131], v[100:103], v[52:55]
    ds_read_b128 v[36:39], v12 offset:20480
    v_add_f32_dpp v32, v32, v32 row_half_mirror row_mask:0xf bank_mask:0xf
    v_mfma_f32_16x16x32_bf16 v[56:59], v[132:135], v[100:103], v[56:59]
    s_nop 0
    v_add_f32_dpp v32, v32, v32 row_mirror row_mask:0xf bank_mask:0xf
    v_mfma_f32_16x16x32_bf16 v[60:63], v[136:139], v[100:103], v[60:63]
    s_nop 0
    v_add_f32_dpp v32, v32, v32 row_bcast:15 row_mask:0xa bank_mask:0xf
    v_mul_f32 v32, 0x3b000000, v32
    v_mfma_f32_16x16x32_bf16 v[64:67], v[140:143], v[100:103], v[64:67]
    ds_read_b128 v[84:87], v12 offset:4096
    v_readlane_b32 s72, v32, 31
    v_mfma_f32_16x16x32_bf16 v[68:71], v[144:147], v[100:103], v[68:71]
    ds_read_b128 v[92:95], v12 offset:16384
    v_readlane_b32 s73, v32, 63
    v_mfma_f32_16x16x32_bf16 v[72:75], v[148:151], v[100:103], v[72:75]
    s_waitcnt vmcnt(0)
    v_cmp_ne_u32 vcc, s84, v11
    s_nop 0
    s_cbranch_vccnz L_ops_38
L_opb_39:
    v_mfma_f32_16x16x32_bf16 v[76:79], v[152:155], v[100:103], v[76:79]
    buffer_load_dwordx4 a[200:203], v7, s[44:47], s86 offen offset:0 sc1
    v_mov_b32 v33, s72
    v_fma_f32 v32, -v33, v33, s73
    v_mfma_f32_16x16x32_bf16 v[80:83], v[156:159], v[100:103], v[80:83]
    buffer_load_dwordx4 a[204:207], v7, s[44:47], s86 offen offset:512 sc1
    ds_read_b128 v[100:103], v3 offset:60416
    s_waitcnt lgkmcnt(8)
    v_mfma_f32_16x16x32_bf16 v[52:55], v[160:163], v[44:47], v[52:55]
    buffer_load_dwordx4 a[208:211], v7, s[44:47], s86 offen offset:1024 sc1
    v_xor_b32 v8, 0x4000, v8
    v_max_f32 v32, 0, v32
    v_mfma_f32_16x16x32_bf16 v[68:71], v[176:179], v[44:47], v[68:71]
    buffer_load_dwordx4 a[212:215], v7, s[44:47], s86 offen offset:1536 sc1
    ds_read_b128 v[88:91], v12 offset:9216
    s_waitcnt lgkmcnt(4)
    v_mfma_f32_16x16x32_bf16 v[52:55], v[40:43], v[96:99], v[52:55]
    buffer_load_dwordx4 a[216:219], v7, s[44:47], s87 offen offset:0 sc1
    ds_read_b128 v[40:43], v12 offset:21504
    v_mfma_f32_16x16x32_bf16 v[68:71], v[36:39], v[96:99], v[68:71]
    buffer_load_dwordx4 a[220:223], v7, s[44:47], s87 offen offset:512 sc1
    v_add_f32 v32, 0x3727c5ac, v32
    v_mfma_f32_16x16x32_bf16 v[52:55], v[192:195], v[108:111], v[52:55]
    buffer_load_dwordx4 a[224:227], v7, s[44:47], s87 offen offset:1024 sc1
    v_xor_b32 v34, 0x4000, v34
    v_mfma_f32_16x16x32_bf16 v[68:71], v[208:211], v[108:111], v[68:71]
    buffer_load_dwordx4 a[228:231], v7, s[44:47], s87 offen offset:1536 sc1
    ds_read_b128 v[36:39], v12 offset:5120
    s_waitcnt lgkmcnt(4)
    v_mfma_f32_16x16x32_bf16 v[52:55], v[84:87], v[104:107], v[52:55]
    ds_read_b128 v[84:87], v12 offset:17408
    v_mfma_f32_16x16x32_bf16 v[68:71], v[92:95], v[104:107], v[68:71]
    v_rsq_f32 v32, v32
    s_waitcnt lgkmcnt(4)
    v_mfma_f32_16x16x32_bf16 v[52:55], v[224:227], v[100:103], v[52:55]
    v_mul_f32_e64 v33, -v33, v32
    v_fma_f32 v16, v112, v32, v33
    v_mfma_f32_16x16x32_bf16 v[68:71], v[240:243], v[100:103], v[68:71]
    v_fma_f32 v17, v113, v32, v33
    v_cvt_pk_bf16_f32 v48, v16, v17
    v_mfma_f32_16x16x32_bf16 v[56:59], v[164:167], v[44:47], v[56:59]
    v_fma_f32 v18, v114, v32, v33
    v_fma_f32 v19, v115, v32, v33
    v_mfma_f32_16x16x32_bf16 v[72:75], v[180:183], v[44:47], v[72:75]
    ds_read_b128 v[92:95], v12 offset:10240
    s_waitcnt lgkmcnt(3)
    v_mfma_f32_16x16x32_bf16 v[56:59], v[88:91], v[96:99], v[56:59]
    ds_read_b128 v[88:91], v12 offset:22528
    v_cvt_pk_bf16_f32 v52, v52, v53
    v_mfma_f32_16x16x32_bf16 v[72:75], v[40:43], v[96:99], v[72:75]
    v_cvt_pk_bf16_f32 v53, v54, v55
    v_cvt_pk_bf16_f32 v49, v18, v19
    v_mfma_f32_16x16x32_bf16 v[56:59], v[196:199], v[108:111], v[56:59]
    v_cvt_pk_bf16_f32 v54, v68, v69
    v_fma_f32 v16, v116, v32, v33
    v_mfma_f32_16x16x32_bf16 v[72:75], v[212:215], v[108:111], v[72:75]
    s_barrier
    ds_read_b128 v[40:43], v12 offset:6144
    s_waitcnt lgkmcnt(3)
    v_cvt_pk_bf16_f32 v55, v70, v71
    v_mfma_f32_16x16x32_bf16 v[56:59], v[36:39], v[104:107], v[56:59]
    s_bitcmp1_b32 3, s80
    s_cbranch_scc1 L_pss_40
    buffer_store_dwordx4 v[52:55], v5, s[44:47], s82 offen offset:0
L_psb_41:
    ds_read_b128 v[36:39], v12 offset:18432
    v_mfma_f32_16x16x32_bf16 v[72:75], v[84:87], v[104:107], v[72:75]
    v_fma_f32 v17, v117, v32, v33
    v_cvt_pk_bf16_f32 v50, v16, v17
    v_mfma_f32_16x16x32_bf16 v[56:59], v[228:231], v[100:103], v[56:59]
    v_fma_f32 v18, v118, v32, v33
    v_fma_f32 v19, v119, v32, v33
    v_mfma_f32_16x16x32_bf16 v[72:75], v[244:247], v[100:103], v[72:75]
    v_cvt_pk_bf16_f32 v51, v18, v19
    v_mfma_f32_16x16x32_bf16 v[60:63], v[168:171], v[44:47], v[60:63]
    buffer_store_dwordx4 v[48:51], v15, s[20:23], s88 offen
    v_add_f32 v112, v112, v120
    v_mfma_f32_16x16x32_bf16 v[76:79], v[184:187], v[44:47], v[76:79]
    s_waitcnt lgkmcnt(2)
    v_add_f32 v113, v113, v121
    v_add_f32 v114, v114, v122
    v_mfma_f32_16x16x32_bf16 v[60:63], v[92:95], v[96:99], v[60:63]
    ds_read_b128 v[92:95], v12 offset:11264
    v_cvt_pk_bf16_f32 v56, v56, v57
    v_mfma_f32_16x16x32_bf16 v[76:79], v[88:91], v[96:99], v[76:79]
    v_cvt_pk_bf16_f32 v57, v58, v59
    v_add_f32 v115, v115, v123
    v_mfma_f32_16x16x32_bf16 v[60:63], v[200:203], v[108:111], v[60:63]
    v_cvt_pk_bf16_f32 v58, v72, v73
    v_add_f32 v116, v116, v124
    v_mfma_f32_16x16x32_bf16 v[76:79], v[216:219], v[108:111], v[76:79]
    s_waitcnt lgkmcnt(1)
    v_cvt_pk_bf16_f32 v59, v74, v75
    v_add_f32 v117, v117, v125
    v_mfma_f32_16x16x32_bf16 v[60:63], v[40:43], v[104:107], v[60:63]
    s_bitcmp1_b32 3, s80
    s_cbranch_scc1 L_pss_42
    buffer_store_dwordx4 v[56:59], v5, s[44:47], s82 offen offset:128
L_psb_43:
    ds_read_b128 v[40:43], v12 offset:23552
    v_mfma_f32_16x16x32_bf16 v[76:79], v[36:39], v[104:107], v[76:79]
    ds_read_b128 v[36:39], v12 offset:7168
    v_add_f32 v118, v118, v126
    v_mfma_f32_16x16x32_bf16 v[60:63], v[232:235], v[100:103], v[60:63]
    v_add_f32 v119, v119, v127
    v_mfma_f32_16x16x32_bf16 v[76:79], v[248:251], v[100:103], v[76:79]
    ds_write_b128 v14, v[112:115] offset:24576
    v_mfma_f32_16x16x32_bf16 v[64:67], v[172:175], v[44:47], v[64:67]
    ds_write_b128 v14, v[116:119] offset:25600
    v_mfma_f32_16x16x32_bf16 v[80:83], v[188:191], v[44:47], v[80:83]
    ds_read_b128 v[44:47], v12 offset:19456
    ds_read_b128 v[84:87], v8 offset:0
    s_waitcnt lgkmcnt(5)
    v_mfma_f32_16x16x32_bf16 v[64:67], v[92:95], v[96:99], v[64:67]
    v_cvt_pk_bf16_f32 v60, v60, v61
    v_mfma_f32_16x16x32_bf16 v[80:83], v[40:43], v[96:99], v[80:83]
    ds_read_b128 v[88:91], v34 offset:0
    v_cvt_pk_bf16_f32 v61, v62, v63
    v_mfma_f32_16x16x32_bf16 v[64:67], v[204:207], v[108:111], v[64:67]
    v_cvt_pk_bf16_f32 v62, v76, v77
    v_mfma_f32_16x16x32_bf16 v[80:83], v[220:223], v[108:111], v[80:83]
    s_waitcnt lgkmcnt(2)
    v_cvt_pk_bf16_f32 v63, v78, v79
    v_mfma_f32_16x16x32_bf16 v[64:67], v[36:39], v[104:107], v[64:67]
    s_bitcmp1_b32 3, s80
    s_cbranch_scc1 L_pss_44
    buffer_store_dwordx4 v[60:63], v5, s[44:47], s82 offen offset:256
L_psb_45:
    v_mfma_f32_16x16x32_bf16 v[80:83], v[44:47], v[104:107], v[80:83]
    v_mfma_f32_16x16x32_bf16 v[64:67], v[236:239], v[100:103], v[64:67]
    v_mfma_f32_16x16x32_bf16 v[80:83], v[252:255], v[100:103], v[80:83]
    s_add_u32 s80, s80, 1
    s_cmp_lt_u32 s80, 8
    s_cbranch_scc1 L_pass_35
    s_nop 3
    v_cvt_pk_bf16_f32 v64, v64, v65
    v_cvt_pk_bf16_f32 v65, v66, v67
    v_cvt_pk_bf16_f32 v66, v80, v81
    v_cvt_pk_bf16_f32 v67, v82, v83
    buffer_store_dwordx4 v[64:67], v5, s[44:47], s82 offen offset:384
    s_mov_b32 s89, 1048576
    ds_read_b128 v[112:115], v12 offset:28672
    ds_read_b128 v[116:119], v12 offset:29696
    s_waitcnt vmcnt(12) lgkmcnt(1)
    v_mfma_f32_16x16x32_bf16 v[112:115], a[192:195], a[200:203], v[112:115]
    s_waitcnt vmcnt(10) lgkmcnt(0)
    v_mfma_f32_16x16x32_bf16 v[116:119], a[192:195], a[208:211], v[116:119]
    v_mfma_f32_16x16x32_bf16 v[112:115], a[196:199], a[204:207], v[112:115]
    s_waitcnt vmcnt(9)
    v_mfma_f32_16x16x32_bf16 v[116:119], a[196:199], a[212:215], v[116:119]
    s_waitcnt vmcnt(8)
    v_mfma_f32_16x16x32_bf16 v[112:115], a[192:195], a[216:219], v[112:115]
    s_waitcnt vmcnt(6)
    v_mfma_f32_16x16x32_bf16 v[116:119], a[192:195], a[224:227], v[116:119]
    v_mfma_f32_16x16x32_bf16 v[112:115], a[196:199], a[220:223], v[112:115]
    s_waitcnt vmcnt(5)
    v_mfma_f32_16x16x32_bf16 v[116:119], a[196:199], a[228:231], v[116:119]
    s_nop 5
    v_cvt_pk_bf16_f32 v16, v112, v113
    v_cvt_pk_bf16_f32 v17, v114, v115
    v_cvt_pk_bf16_f32 v18, v116, v117
    v_cvt_pk_bf16_f32 v19, v118, v119
    buffer_store_dwordx2 v[16:17], v35, s[40:43], s89 offen
    buffer_store_dwordx2 v[18:19], v35, s[40:43], s89 offen offset:512
    s_waitcnt vmcnt(2)
    buffer_store_dword v1, v2, s[20:23], s83 offen
    s_mov_b32 s89, 1049600
    ds_read_b128 v[112:115], v12 offset:30720
    ds_read_b128 v[116:119], v12 offset:31744
    s_mov_b32 s86, 131072
    s_mov_b32 s87, 139264
    s_mov_b32 s64, 50048
    s_mov_b32 s10, 400000
L_poll_46:
    buffer_load_dword v11, v6, s[20:23], s64 offen offset:0 sc1
    s_waitcnt vmcnt(0)
    v_cmp_ne_u32 vcc, s8, v11
    s_nop 0
    s_cbranch_vccz L_polld_47
    s_sub_u32 s10, s10, 1
    s_cmp_lg_u32 s10, 0
    s_nop 0
    s_cbranch_scc1 L_poll_46
L_polld_47:
    buffer_load_dwordx4 a[200:203], v7, s[44:47], s86 offen offset:0 sc1
    buffer_load_dwordx4 a[204:207], v7, s[44:47], s86 offen offset:512 sc1
    buffer_load_dwordx4 a[208:211], v7, s[44:47], s86 offen offset:1024 sc1
    buffer_load_dwordx4 a[212:215], v7, s[44:47], s86 offen offset:1536 sc1
    buffer_load_dwordx4 a[216:219], v7, s[44:47], s87 offen offset:0 sc1
    buffer_load_dwordx4 a[220:223], v7, s[44:47], s87 offen offset:512 sc1
    buffer_load_dwordx4 a[224:227], v7, s[44:47], s87 offen offset:1024 sc1
    buffer_load_dwordx4 a[228:231], v7, s[44:47], s87 offen offset:1536 sc1
    s_waitcnt vmcnt(7) lgkmcnt(1)
    v_mfma_f32_16x16x32_bf16 v[112:115], a[192:195], a[200:203], v[112:115]
    s_waitcnt vmcnt(5) lgkmcnt(0)
    v_mfma_f32_16x16x32_bf16 v[116:119], a[192:195], a[208:211], v[116:119]
    v_mfma_f32_16x16x32_bf16 v[112:115], a[196:199], a[204:207], v[112:115]
    s_waitcnt vmcnt(4)
    v_mfma_f32_16x16x32_bf16 v[116:119], a[196:199], a[212:215], v[116:119]
    s_waitcnt vmcnt(3)
    v_mfma_f32_16x16x32_bf16 v[112:115], a[192:195], a[216:219], v[112:115]
    s_waitcnt vmcnt(1)
    v_mfma_f32_16x16x32_bf16 v[116:119], a[192:195], a[224:227], v[116:119]
    v_mfma_f32_16x16x32_bf16 v[112:115], a[196:199], a[220:223], v[112:115]
    s_waitcnt vmcnt(0)
    v_mfma_f32_16x16x32_bf16 v[116:119], a[196:199], a[228:231], v[116:119]
    s_nop 5
    v_cvt_pk_bf16_f32 v16, v112, v113
    v_cvt_pk_bf16_f32 v17, v114, v115
    v_cvt_pk_bf16_f32 v18, v116, v117
    v_cvt_pk_bf16_f32 v19, v118, v119
    buffer_store_dwordx2 v[16:17], v35, s[40:43], s89 offen
    buffer_store_dwordx2 v[18:19], v35, s[40:43], s89 offen offset:512
    s_waitcnt vmcnt(0)
    s_endpgm
L_pe_24:
L_pss_36:
    buffer_store_dwordx4 v[64:67], v5, s[44:47], s82 offen offset:384 sc1
    s_branch L_psb_37
L_ops_38:
    s_add_u32 s94, s94, 1
    s_mov_b32 s10, 400000
L_ops_38_l:
    buffer_load_dword v11, v6, s[20:23], s85 offen offset:0 sc1
    s_waitcnt vmcnt(0)
    v_cmp_ne_u32 vcc, s84, v11
    s_nop 1
    s_cbranch_vccz L_opb_39
    s_sub_u32 s10, s10, 1
    s_cmp_lg_u32 s10, 0
    s_cbranch_scc1 L_ops_38_l
    s_branch L_opb_39
L_pss_40:
    buffer_store_dwordx4 v[52:55], v5, s[44:47], s82 offen offset:0 sc1
    s_branch L_psb_41
L_pss_42:
    buffer_store_dwordx4 v[56:59], v5, s[44:47], s82 offen offset:128 sc1
    s_branch L_psb_43
L_pss_44:
    buffer_store_dwordx4 v[60:63], v5, s[44:47], s82 offen offset:256 sc1
    s_branch L_psb_45
L_hotend:
L_slow_7:
    s_mul_i32 s92, s7, 229376
    s_lshl_b32 s70, s3, 8
    s_add_u32 s92, s92, s70
    s_cmp_eq_u32 s3, 3
    s_cselect_b32 s77, 6, 4
    s_cselect_b32 s71, -1, 1
    s_add_u32 s77, s77, s100
    s_lshl_b32 s93, s3, 15
    s_add_u32 s93, s93, 32768
    s_and_b32 s91, s6, 3
    s_cmp_ge_u32 s91, 3
    s_cselect_b32 s91, 0, s91
    s_lshl_b32 s70, s91, 12
    s_add_u32 m0, s70, s93
    s_mul_i32 s70, s91, s71
    s_add_u32 s70, s70, s77
    s_cmp_eq_u32 s70, 7
    s_cselect_b32 s70, 0, s70
    s_lshl_b32 s70, s70, 15
    s_add_u32 s70, s70, s92
    s_add_u32 s91, s91, 1
    buffer_load_dwordx4 v124, s[32:35], s70 offen offset:0 lds
    buffer_load_dwordx4 v125, s[32:35], s70 offen offset:1024 lds
    buffer_load_dwordx4 v126, s[32:35], s70 offen offset:2048 lds
    buffer_load_dwordx4 v127, s[32:35], s70 offen offset:3072 lds
    s_add_u32 m0, m0, 12288
    s_add_u32 s70, s70, 128
    buffer_load_dwordx4 v124, s[32:35], s70 offen offset:0 lds
    buffer_load_dwordx4 v125, s[32:35], s70 offen offset:1024 lds
    buffer_load_dwordx4 v126, s[32:35], s70 offen offset:2048 lds
    buffer_load_dwordx4 v127, s[32:35], s70 offen offset:3072 lds
    s_cmp_ge_u32 s91, 3
    s_cselect_b32 s91, 0, s91
    s_lshl_b32 s70, s91, 12
    s_add_u32 m0, s70, s93
    s_mul_i32 s70, s91, s71
    s_add_u32 s70, s70, s77
    s_cmp_eq_u32 s70, 7
    s_cselect_b32 s70, 0, s70
    s_lshl_b32 s70, s70, 15
    s_add_u32 s70, s70, s92
    s_add_u32 s91, s91, 1
    buffer_load_dwordx4 v124, s[32:35], s70 offen offset:0 lds
    buffer_load_dwordx4 v125, s[32:35], s70 offen offset:1024 lds
    buffer_load_dwordx4 v126, s[32:35], s70 offen offset:2048 lds
    buffer_load_dwordx4 v127, s[32:35], s70 offen offset:3072 lds
    s_add_u32 m0, m0, 12288
    s_add_u32 s70, s70, 128
    buffer_load_dwordx4 v124, s[32:35], s70 offen offset:0 lds
    buffer_load_dwordx4 v125, s[32:35], s70 offen offset:1024 lds
    buffer_load_dwordx4 v126, s[32:35], s70 offen offset:2048 lds
    buffer_load_dwordx4 v127, s[32:35], s70 offen offset:3072 lds
    s_cmp_ge_u32 s91, 3
    s_cselect_b32 s91, 0, s91
    s_lshl_b32 s70, s91, 12
    s_add_u32 m0, s70, s93
    s_mul_i32 s70, s91, s71
    s_add_u32 s70, s70, s77
    s_cmp_eq_u32 s70, 7
    s_cselect_b32 s70, 0, s70
    s_lshl_b32 s70, s70, 15
    s_add_u32 s70, s70, s92
    s_add_u32 s91, s91, 1
    buffer_load_dwordx4 v124, s[32:35], s70 offen offset:0 lds
    buffer_load_dwordx4 v125, s[32:35], s70 offen offset:1024 lds
    buffer_load_dwordx4 v126, s[32:35], s70 offen offset:2048 lds
    buffer_load_dwordx4 v127, s[32:35], s70 offen offset:3072 lds
    s_add_u32 m0, m0, 12288
    s_add_u32 s70, s70, 128
    buffer_load_dwordx4 v124, s[32:35], s70 offen offset:0 lds
    buffer_load_dwordx4 v125, s[32:35], s70 offen offset:1024 lds
    buffer_load_dwordx4 v126, s[32:35], s70 offen offset:2048 lds
    buffer_load_dwordx4 v127, s[32:35], s70 offen offset:3072 lds
L_pb_12:
    s_waitcnt vmcnt(0)
    ds_read_b64_tr_b16 v[36:37], v116 offset:0
    ds_read_b64_tr_b16 v[38:39], v116 offset:2048
    ds_read_b64_tr_b16 v[40:41], v117 offset:0
    ds_read_b64_tr_b16 v[42:43], v117 offset:2048
    ds_read_b64_tr_b16 v[44:45], v118 offset:0
    ds_read_b64_tr_b16 v[46:47], v118 offset:2048
    ds_read_b64_tr_b16 v[48:49], v119 offset:0
    ds_read_b64_tr_b16 v[50:51], v119 offset:2048
    ds_read_b64_tr_b16 v[52:53], v116 offset:4096
    ds_read_b64_tr_b16 v[54:55], v116 offset:6144
    ds_read_b64_tr_b16 v[56:57], v117 offset:4096
    ds_read_b64_tr_b16 v[58:59], v117 offset:6144
    ds_read_b64_tr_b16 v[60:61], v118 offset:4096
    ds_read_b64_tr_b16 v[62:63], v118 offset:6144
    ds_read_b64_tr_b16 v[64:65], v119 offset:4096
    ds_read_b64_tr_b16 v[66:67], v119 offset:6144
    ds_read_b64_tr_b16 v[68:69], v116 offset:8192
    ds_read_b64_tr_b16 v[70:71], v116 offset:10240
    ds_read_b64_tr_b16 v[72:73], v117 offset:8192
    ds_read_b64_tr_b16 v[74:75], v117 offset:10240
    ds_read_b64_tr_b16 v[76:77], v118 offset:8192
    ds_read_b64_tr_b16 v[78:79], v118 offset:10240
    ds_read_b64_tr_b16 v[80:81], v119 offset:8192
    ds_read_b64_tr_b16 v[82:83], v119 offset:10240
    s_waitcnt lgkmcnt(15)
    v_mov_b32 v11, v51
    ds_write_b128 v12, v[36:39] offset:0
    ds_write_b128 v12, v[40:43] offset:1024
    ds_write_b128 v12, v[44:47] offset:2048
    ds_write_b128 v12, v[48:51] offset:3072
    ds_read_b64_tr_b16 v[36:37], v116 offset:12288
    ds_read_b64_tr_b16 v[38:39], v116 offset:14336
    ds_read_b64_tr_b16 v[40:41], v117 offset:12288
    ds_read_b64_tr_b16 v[42:43], v117 offset:14336
    ds_read_b64_tr_b16 v[44:45], v118 offset:12288
    ds_read_b64_tr_b16 v[46:47], v118 offset:14336
    ds_read_b64_tr_b16 v[48:49], v119 offset:12288
    ds_read_b64_tr_b16 v[50:51], v119 offset:14336
    s_waitcnt lgkmcnt(15)
    v_mov_b32 v11, v67
    ds_write_b128 v12, v[52:55] offset:4096
    ds_write_b128 v12, v[56:59] offset:5120
    ds_write_b128 v12, v[60:63] offset:6144
    ds_write_b128 v12, v[64:67] offset:7168
    ds_read_b64_tr_b16 v[52:53], v116 offset:16384
    ds_read_b64_tr_b16 v[54:55], v116 offset:18432
    ds_read_b64_tr_b16 v[56:57], v117 offset:16384
    ds_read_b64_tr_b16 v[58:59], v117 offset:18432
    ds_read_b64_tr_b16 v[60:61], v118 offset:16384
    ds_read_b64_tr_b16 v[62:63], v118 offset:18432
    ds_read_b64_tr_b16 v[64:65], v119 offset:16384
    ds_read_b64_tr_b16 v[66:67], v119 offset:18432
    s_waitcnt lgkmcnt(15)
    v_mov_b32 v11, v83
    ds_write_b128 v12, v[68:71] offset:8192
    ds_write_b128 v12, v[72:75] offset:9216
    ds_write_b128 v12, v[76:79] offset:10240
    ds_write_b128 v12, v[80:83] offset:11264
    ds_read_b64_tr_b16 v[68:69], v116 offset:20480
    ds_read_b64_tr_b16 v[70:71], v116 offset:22528
    ds_read_b64_tr_b16 v[72:73], v117 offset:20480
    ds_read_b64_tr_b16 v[74:75], v117 offset:22528
    ds_read_b64_tr_b16 v[76:77], v118 offset:20480
    ds_read_b64_tr_b16 v[78:79], v118 offset:22528
    ds_read_b64_tr_b16 v[80:81], v119 offset:20480
    ds_read_b64_tr_b16 v[82:83], v119 offset:22528
    s_waitcnt lgkmcnt(15)
    v_mov_b32 v11, v51
    ds_write_b128 v12, v[36:39] offset:12288
    ds_write_b128 v12, v[40:43] offset:13312
    ds_write_b128 v12, v[44:47] offset:14336
    ds_write_b128 v12, v[48:51] offset:15360
    s_waitcnt lgkmcnt(15)
    v_mov_b32 v11, v67
    ds_write_b128 v12, v[52:55] offset:16384
    ds_write_b128 v12, v[56:59] offset:17408
    ds_write_b128 v12, v[60:63] offset:18432
    ds_write_b128 v12, v[64:67] offset:19456
    s_waitcnt lgkmcnt(8)
    v_mov_b32 v11, v83
    ds_write_b128 v12, v[68:71] offset:20480
    ds_write_b128 v12, v[72:75] offset:21504
    ds_write_b128 v12, v[76:79] offset:22528
    ds_write_b128 v12, v[80:83] offset:23552
    s_lshl_b32 s64, s3, 13
    s_add_u32 m0, s64, 0
    s_mov_b32 s65, 50176
    s_mov_b32 s10, 400000
L_poll_21:
    buffer_load_dword v11, v6, s[20:23], s65 offen offset:0 sc1
    s_waitcnt vmcnt(0)
    v_cmp_ne_u32 vcc, s8, v11
    s_nop 0
    s_cbranch_vccz L_polld_22
    s_sleep 2
    s_sub_u32 s10, s10, 1
    s_cmp_lg_u32 s10, 0
    s_cbranch_scc1 L_poll_21
L_polld_22:
    buffer_load_dwordx4 v3, s[20:23], s64 offen offset:0 sc1 lds
    buffer_load_dwordx4 v3, s[20:23], s64 offen offset:1024 sc1 lds
    buffer_load_dwordx4 v3, s[20:23], s64 offen offset:2048 sc1 lds
    buffer_load_dwordx4 v3, s[20:23], s64 offen offset:3072 sc1 lds
    s_add_u32 s64, s64, 4096
    s_add_u32 m0, m0, 4096
    s_nop 0
    buffer_load_dwordx4 v3, s[20:23], s64 offen offset:0 sc1 lds
    buffer_load_dwordx4 v3, s[20:23], s64 offen offset:1024 sc1 lds
    buffer_load_dwordx4 v3, s[20:23], s64 offen offset:2048 sc1 lds
    buffer_load_dwordx4 v3, s[20:23], s64 offen offset:3072 sc1 lds
L_pb_13:
    s_waitcnt vmcnt(0)
    s_mov_b32 s80, 0
    s_mov_b32 s94, 0
    s_mov_b32 s82, 2146435072
    s_mov_b32 s83, 2146435072
    s_lshl2_add_u32 s90, s7, s3
    s_lshl_b32 s90, s90, 2
    s_add_u32 s90, s90, 49152
    s_lshl_b32 s88, s3, 13
    s_mov_b32 s87, s88
    s_mov_b32 s71, s88
    s_mov_b32 s85, 50176
    s_mov_b32 s89, 0x20000
L_pb_14:
    s_waitcnt vmcnt(0) lgkmcnt(0)
    s_barrier
    ds_read_b128 v[84:87], v8 offset:0
    ds_read_b128 v[88:91], v13 offset:0
    s_waitcnt lgkmcnt(0)
L_pass_23:
    ds_read_b128 v[92:95], v8 offset:2048
    s_add_u32 s85, s85, 128
    v_mfma_f32_16x16x32_bf16 v[36:39], a[0:3], v[84:87], v[20:23]
    ds_read_b128 v[96:99], v13 offset:2048
    v_mfma_f32_16x16x32_bf16 v[40:43], a[64:67], v[84:87], v[24:27]
    ds_read_b128 v[100:103], v8 offset:4096
    v_mfma_f32_16x16x32_bf16 v[44:47], a[128:131], v[84:87], v[28:31]
    v_cvt_pk_bf16_f32 v64, v64, v65
    s_add_u32 s87, s87, 16384
    s_cmp_ge_u32 s87, 49152
    s_cselect_b32 s87, s71, s87
    v_mfma_f32_16x16x32_bf16 v[48:51], a[192:195], v[84:87], v[32:35]
    v_cvt_pk_bf16_f32 v65, v66, v67
    s_add_u32 s86, s87, 4096
    s_waitcnt lgkmcnt(3)
    v_mfma_f32_16x16x32_bf16 v[36:39], a[4:7], v[88:91], v[36:39]
    v_cvt_pk_bf16_f32 v66, v80, v81
    s_xor_b32 s88, s88, 0x4000
    s_mov_b32 m0, s88
    v_mfma_f32_16x16x32_bf16 v[40:43], a[68:71], v[88:91], v[40:43]
    ds_read_b128 v[84:87], v13 offset:4096
    v_cvt_pk_bf16_f32 v67, v82, v83
    v_mfma_f32_16x16x32_bf16 v[44:47], a[132:135], v[88:91], v[44:47]
    buffer_store_dwordx4 v[64:67], v5, s[44:47], s82 offen offset:384 sc1
    v_mfma_f32_16x16x32_bf16 v[48:51], a[196:199], v[88:91], v[48:51]
    s_waitcnt lgkmcnt(2)
    v_mfma_f32_16x16x32_bf16 v[36:39], a[8:11], v[92:95], v[36:39]
    v_mfma_f32_16x16x32_bf16 v[40:43], a[72:75], v[92:95], v[40:43]
    ds_read_b128 v[88:91], v8 offset:6144
    v_mfma_f32_16x16x32_bf16 v[44:47], a[136:139], v[92:95], v[44:47]
    v_mfma_f32_16x16x32_bf16 v[48:51], a[200:203], v[92:95], v[48:51]
    ds_read_b128 v[92:95], v13 offset:6144
    v_mfma_f32_16x16x32_bf16 v[36:39], a[12:15], v[96:99], v[36:39]
    v_mfma_f32_16x16x32_bf16 v[40:43], a[76:79], v[96:99], v[40:43]
    ds_read_b128 v[104:107], v8 offset:8192
    v_mfma_f32_16x16x32_bf16 v[44:47], a[140:143], v[96:99], v[44:47]
    v_mfma_f32_16x16x32_bf16 v[48:51], a[204:207], v[96:99], v[48:51]
    ds_read_b128 v[96:99], v13 offset:8192
    s_waitcnt lgkmcnt(4)
    v_mfma_f32_16x16x32_bf16 v[36:39], a[16:19], v[100:103], v[36:39]
    v_mfma_f32_16x16x32_bf16 v[40:43], a[80:83], v[100:103], v[40:43]
    ds_read_b128 v[108:111], v8 offset:10240
    v_mfma_f32_16x16x32_bf16 v[44:47], a[144:147], v[100:103], v[44:47]
    v_mfma_f32_16x16x32_bf16 v[48:51], a[208:211], v[100:103], v[48:51]
    ds_read_b128 v[100:103], v13 offset:10240
    v_mfma_f32_16x16x32_bf16 v[36:39], a[20:23], v[84:87], v[36:39]
    v_mfma_f32_16x16x32_bf16 v[40:43], a[84:87], v[84:87], v[40:43]
    ds_read_b128 v[112:115], v8 offset:12288
    v_mfma_f32_16x16x32_bf16 v[44:47], a[148:151], v[84:87], v[44:47]
    v_mfma_f32_16x16x32_bf16 v[48:51], a[212:215], v[84:87], v[48:51]
    ds_read_b128 v[84:87], v13 offset:12288
    s_waitcnt lgkmcnt(6)
    v_mfma_f32_16x16x32_bf16 v[36:39], a[24:27], v[88:91], v[36:39]
    v_mfma_f32_16x16x32_bf16 v[40:43], a[88:91], v[88:91], v[40:43]
    ds_read_b128 v[116:119], v8 offset:14336
    v_mfma_f32_16x16x32_bf16 v[36:39], a[28:31], v[92:95], v[36:39]
    v_mfma_f32_16x16x32_bf16 v[40:43], a[92:95], v[92:95], v[40:43]
    ds_read_b128 v[120:123], v13 offset:14336
    s_waitcnt lgkmcnt(6)
    v_mfma_f32_16x16x32_bf16 v[36:39], a[32:35], v[104:107], v[36:39]
    v_mfma_f32_16x16x32_bf16 v[40:43], a[96:99], v[104:107], v[40:43]
    v_mfma_f32_16x16x32_bf16 v[36:39], a[36:39], v[96:99], v[36:39]
    v_mfma_f32_16x16x32_bf16 v[40:43], a[100:103], v[96:99], v[40:43]
    s_waitcnt vmcnt(0)
    buffer_store_dword v1, v2, s[20:23], s83 offen sc1
    s_waitcnt lgkmcnt(4)
    v_mfma_f32_16x16x32_bf16 v[36:39], a[40:43], v[108:111], v[36:39]
    s_and_b32 s64, s80, 1
    v_mfma_f32_16x16x32_bf16 v[40:43], a[104:107], v[108:111], v[40:43]
    buffer_load_dword v11, v6, s[20:23], s85 offen offset:0 sc1
    s_lshl_b32 s82, s64, 17
    v_mfma_f32_16x16x32_bf16 v[36:39], a[44:47], v[100:103], v[36:39]
    s_lshl_b32 s64, s80, 7
    v_mfma_f32_16x16x32_bf16 v[40:43], a[108:111], v[100:103], v[40:43]
    s_waitcnt lgkmcnt(2)
    s_add_u32 s83, s64, s90
    v_mfma_f32_16x16x32_bf16 v[36:39], a[48:51], v[112:115], v[36:39]
    v_mfma_f32_16x16x32_bf16 v[40:43], a[112:115], v[112:115], v[40:43]
    v_mfma_f32_16x16x32_bf16 v[36:39], a[52:55], v[84:87], v[36:39]
    v_mfma_f32_16x16x32_bf16 v[40:43], a[116:119], v[84:87], v[40:43]
    s_waitcnt lgkmcnt(0)
    v_mfma_f32_16x16x32_bf16 v[36:39], a[56:59], v[116:119], v[36:39]
    v_mfma_f32_16x16x32_bf16 v[40:43], a[120:123], v[116:119], v[40:43]
    v_mfma_f32_16x16x32_bf16 v[36:39], a[60:63], v[120:123], v[36:39]
    v_mfma_f32_16x16x32_bf16 v[40:43], a[124:127], v[120:123], v[40:43]
    s_nop 2
    v_mfma_f32_16x16x32_bf16 v[44:47], a[152:155], v[88:91], v[44:47]
    s_nop 1
    v_mfma_f32_16x16x32_bf16 v[44:47], a[156:159], v[92:95], v[44:47]
    v_mul_f32_e64 v36, v36, |v36|
    v_mul_f32_e64 v37, v37, |v37|
    v_mfma_f32_16x16x32_bf16 v[44:47], a[160:163], v[104:107], v[44:47]
    v_mul_f32_e64 v38, v38, |v38|
    v_mul_f32_e64 v39, v39, |v39|
    v_mfma_f32_16x16x32_bf16 v[44:47], a[164:167], v[96:99], v[44:47]
    v_cvt_pk_bf16_f32 v36, v36, v37
    v_cvt_pk_bf16_f32 v37, v38, v39
    v_mfma_f32_16x16x32_bf16 v[44:47], a[168:171], v[108:111], v[44:47]
    v_pk_max_i16 v36, v36, 0
    v_pk_max_i16 v37, v37, 0
    v_mfma_f32_16x16x32_bf16 v[44:47], a[172:175], v[100:103], v[44:47]
    v_mul_f32_e64 v40, v40, |v40|
    v_mul_f32_e64 v41, v41, |v41|
    v_mfma_f32_16x16x32_bf16 v[44:47], a[176:179], v[112:115], v[44:47]
    v_mul_f32_e64 v42, v42, |v42|
    v_mul_f32_e64 v43, v43, |v43|
    v_mfma_f32_16x16x32_bf16 v[44:47], a[180:183], v[84:87], v[44:47]
    v_cvt_pk_bf16_f32 v38, v40, v41
    v_cvt_pk_bf16_f32 v39, v42, v43
    v_mfma_f32_16x16x32_bf16 v[44:47], a[184:187], v[116:119], v[44:47]
    v_pk_max_i16 v38, v38, 0
    v_pk_max_i16 v39, v39, 0
    v_mfma_f32_16x16x32_bf16 v[44:47], a[188:191], v[120:123], v[44:47]
    ds_write_b128 v4, v[36:39]
    v_mfma_f32_16x16x32_bf16 v[48:51], a[216:219], v[88:91], v[48:51]
    s_nop 2
    v_mfma_f32_16x16x32_bf16 v[48:51], a[220:223], v[92:95], v[48:51]
    s_nop 1
    v_mul_f32_e64 v44, v44, |v44|
    v_mfma_f32_16x16x32_bf16 v[48:51], a[224:227], v[104:107], v[48:51]
    v_mul_f32_e64 v45, v45, |v45|
    v_mul_f32_e64 v46, v46, |v46|
    v_mfma_f32_16x16x32_bf16 v[48:51], a[228:231], v[96:99], v[48:51]
    s_waitcnt vmcnt(0)
    v_cmp_ne_u32 vcc, s8, v11
    s_nop 0
    s_cbranch_vccnz L_ops_24
L_opb_25:
    v_mfma_f32_16x16x32_bf16 v[48:51], a[232:235], v[108:111], v[48:51]
    buffer_load_dwordx4 v3, s[20:23], s87 offen offset:0 sc1 lds
    v_mul_f32_e64 v47, v47, |v47|
    v_cvt_pk_bf16_f32 v44, v44, v45
    v_mfma_f32_16x16x32_bf16 v[48:51], a[236:239], v[100:103], v[48:51]
    v_cvt_pk_bf16_f32 v45, v46, v47
    v_pk_max_i16 v44, v44, 0
    v_mfma_f32_16x16x32_bf16 v[48:51], a[240:243], v[112:115], v[48:51]
    v_pk_max_i16 v45, v45, 0
    v_mfma_f32_16x16x32_bf16 v[48:51], a[244:247], v[84:87], v[48:51]
    buffer_load_dwordx4 v3, s[20:23], s87 offen offset:1024 sc1 lds
    v_mfma_f32_16x16x32_bf16 v[48:51], a[248:251], v[116:119], v[48:51]
    v_mfma_f32_16x16x32_bf16 v[48:51], a[252:255], v[120:123], v[48:51]
    s_nop 2
    v_mfma_f32_16x16x32_bf16 v[52:55], v[128:131], v[36:39], 0
    buffer_load_dwordx4 v3, s[20:23], s87 offen offset:2048 sc1 lds
    s_nop 1
    v_mfma_f32_16x16x32_bf16 v[56:59], v[132:135], v[36:39], 0
    v_mul_f32_e64 v48, v48, |v48|
    v_mul_f32_e64 v49, v49, |v49|
    v_mfma_f32_16x16x32_bf16 v[60:63], v[136:139], v[36:39], 0
    v_mul_f32_e64 v50, v50, |v50|
    v_mul_f32_e64 v51, v51, |v51|
    v_mfma_f32_16x16x32_bf16 v[64:67], v[140:143], v[36:39], 0
    buffer_load_dwordx4 v3, s[20:23], s87 offen offset:3072 sc1 lds
    s_add_u32 m0, m0, 4096
    v_cvt_pk_bf16_f32 v46, v48, v49
    v_mfma_f32_16x16x32_bf16 v[68:71], v[144:147], v[36:39], 0
    v_cvt_pk_bf16_f32 v47, v50, v51
    v_pk_max_i16 v46, v46, 0
    v_mfma_f32_16x16x32_bf16 v[72:75], v[148:151], v[36:39], 0
    v_pk_max_i16 v47, v47, 0
    v_mfma_f32_16x16x32_bf16 v[76:79], v[152:155], v[36:39], 0
    buffer_load_dwordx4 v3, s[20:23], s86 offen offset:0 sc1 lds
    v_mfma_f32_16x16x32_bf16 v[80:83], v[156:159], v[36:39], 0
    ds_write_b128 v4, v[44:47] offset:1024
    ds_read_b128 v[116:119], v12 offset:0
    v_mfma_f32_16x16x32_bf16 v[52:55], v[160:163], v[44:47], v[52:55]
    ds_read_b128 v[84:87], v12 offset:12288
    v_mfma_f32_16x16x32_bf16 v[56:59], v[164:167], v[44:47], v[56:59]
    s_waitcnt lgkmcnt(2)
    s_barrier
    buffer_load_dwordx4 v3, s[20:23], s86 offen offset:1024 sc1 lds
    ds_read_b128 v[120:123], v14 offset:0
    v_mfma_f32_16x16x32_bf16 v[60:63], v[168:171], v[44:47], v[60:63]
    ds_read_b128 v[112:115], v3 offset:61440
    v_mfma_f32_16x16x32_bf16 v[64:67], v[172:175], v[44:47], v[64:67]
    ds_read_b128 v[100:103], v14 offset:1024
    v_mfma_f32_16x16x32_bf16 v[68:71], v[176:179], v[44:47], v[68:71]
    buffer_load_dwordx4 v3, s[20:23], s86 offen offset:2048 sc1 lds
    ds_read_b128 v[108:111], v12 offset:4096
    v_mfma_f32_16x16x32_bf16 v[72:75], v[180:183], v[44:47], v[72:75]
    ds_read_b128 v[96:99], v3 offset:62464
    v_mfma_f32_16x16x32_bf16 v[76:79], v[184:187], v[44:47], v[76:79]
    ds_read_b128 v[104:107], v12 offset:16384
    v_mfma_f32_16x16x32_bf16 v[80:83], v[188:191], v[44:47], v[80:83]
    buffer_load_dwordx4 v3, s[20:23], s86 offen offset:3072 sc1 lds
    ds_read_b128 v[92:95], v12 offset:8192
    s_waitcnt lgkmcnt(6)
    v_mfma_f32_16x16x32_bf16 v[52:55], v[192:195], v[120:123], v[52:55]
    ds_read_b128 v[124:127], v3 offset:63488
    v_xor_b32 v8, 0x4000, v8
    v_mfma_f32_16x16x32_bf16 v[68:71], v[208:211], v[120:123], v[68:71]
    ds_read_b128 v[88:91], v12 offset:20480
    s_waitcnt lgkmcnt(7)
    v_mfma_f32_16x16x32_bf16 v[52:55], v[116:119], v[112:115], v[52:55]
    ds_read_b128 v[116:119], v12 offset:1024
    v_mfma_f32_16x16x32_bf16 v[68:71], v[84:87], v[112:115], v[68:71]
    ds_read_b128 v[84:87], v12 offset:13312
    s_waitcnt lgkmcnt(8)
    v_mfma_f32_16x16x32_bf16 v[52:55], v[224:227], v[100:103], v[52:55]
    v_xor_b32 v13, 0x4000, v13
    v_mfma_f32_16x16x32_bf16 v[68:71], v[240:243], v[100:103], v[68:71]
    s_waitcnt lgkmcnt(5)
    v_mfma_f32_16x16x32_bf16 v[52:55], v[108:111], v[96:99], v[52:55]
    ds_read_b128 v[108:111], v12 offset:5120
    v_mfma_f32_16x16x32_bf16 v[68:71], v[104:107], v[96:99], v[68:71]
    ds_read_b128 v[104:107], v12 offset:17408
    s_waitcnt lgkmcnt(4)
    v_mfma_f32_16x16x32_bf16 v[52:55], v[92:95], v[124:127], v[52:55]
    ds_read_b128 v[92:95], v12 offset:9216
    v_mfma_f32_16x16x32_bf16 v[68:71], v[88:91], v[124:127], v[68:71]
    ds_read_b128 v[88:91], v12 offset:21504
    v_mfma_f32_16x16x32_bf16 v[56:59], v[196:199], v[120:123], v[56:59]
    v_mfma_f32_16x16x32_bf16 v[72:75], v[212:215], v[120:123], v[72:75]
    s_waitcnt lgkmcnt(4)
    v_mfma_f32_16x16x32_bf16 v[56:59], v[116:119], v[112:115], v[56:59]
    ds_read_b128 v[116:119], v12 offset:2048
    v_cvt_pk_bf16_f32 v52, v52, v53
    v_mfma_f32_16x16x32_bf16 v[72:75], v[84:87], v[112:115], v[72:75]
    ds_read_b128 v[84:87], v12 offset:14336
    v_cvt_pk_bf16_f32 v53, v54, v55
    v_mfma_f32_16x16x32_bf16 v[56:59], v[228:231], v[100:103], v[56:59]
    v_cvt_pk_bf16_f32 v54, v68, v69
    v_mfma_f32_16x16x32_bf16 v[72:75], v[244:247], v[100:103], v[72:75]
    s_waitcnt lgkmcnt(4)
    v_cvt_pk_bf16_f32 v55, v70, v71
    v_mfma_f32_16x16x32_bf16 v[56:59], v[108:111], v[96:99], v[56:59]
    buffer_store_dwordx4 v[52:55], v5, s[44:47], s82 offen offset:0 sc1
    ds_read_b128 v[108:111], v12 offset:6144
    v_mfma_f32_16x16x32_bf16 v[72:75], v[104:107], v[96:99], v[72:75]
    ds_read_b128 v[104:107], v12 offset:18432
    s_waitcnt lgkmcnt(4)
    v_mfma_f32_16x16x32_bf16 v[56:59], v[92:95], v[124:127], v[56:59]
    ds_read_b128 v[92:95], v12 offset:10240
    v_mfma_f32_16x16x32_bf16 v[72:75], v[88:91], v[124:127], v[72:75]
    ds_read_b128 v[88:91], v12 offset:22528
    v_mfma_f32_16x16x32_bf16 v[60:63], v[200:203], v[120:123], v[60:63]
    v_mfma_f32_16x16x32_bf16 v[76:79], v[216:219], v[120:123], v[76:79]
    s_waitcnt lgkmcnt(4)
    v_mfma_f32_16x16x32_bf16 v[60:63], v[116:119], v[112:115], v[60:63]
    ds_read_b128 v[116:119], v12 offset:3072
    v_cvt_pk_bf16_f32 v56, v56, v57
    v_mfma_f32_16x16x32_bf16 v[76:79], v[84:87], v[112:115], v[76:79]
    s_waitcnt vmcnt(1)
    s_barrier
    v_cvt_pk_bf16_f32 v57, v58, v59
    v_mfma_f32_16x16x32_bf16 v[60:63], v[232:235], v[100:103], v[60:63]
    v_cvt_pk_bf16_f32 v58, v72, v73
    v_mfma_f32_16x16x32_bf16 v[76:79], v[248:251], v[100:103], v[76:79]
    s_waitcnt lgkmcnt(3)
    v_cvt_pk_bf16_f32 v59, v74, v75
    v_mfma_f32_16x16x32_bf16 v[60:63], v[108:111], v[96:99], v[60:63]
    buffer_store_dwordx4 v[56:59], v5, s[44:47], s82 offen offset:128 sc1
    ds_read_b128 v[108:111], v12 offset:15360
    v_mfma_f32_16x16x32_bf16 v[76:79], v[104:107], v[96:99], v[76:79]
    ds_read_b128 v[104:107], v12 offset:7168
    s_waitcnt lgkmcnt(3)
    v_mfma_f32_16x16x32_bf16 v[60:63], v[92:95], v[124:127], v[60:63]
    ds_read_b128 v[92:95], v12 offset:19456
    v_mfma_f32_16x16x32_bf16 v[76:79], v[88:91], v[124:127], v[76:79]
    v_mfma_f32_16x16x32_bf16 v[64:67], v[204:207], v[120:123], v[64:67]
    v_mfma_f32_16x16x32_bf16 v[80:83], v[220:223], v[120:123], v[80:83]
    ds_read_b128 v[120:123], v12 offset:11264
    ds_read_b128 v[84:87], v8 offset:0
    s_waitcnt lgkmcnt(4)
    v_mfma_f32_16x16x32_bf16 v[64:67], v[116:119], v[112:115], v[64:67]
    ds_read_b128 v[116:119], v12 offset:23552
    v_cvt_pk_bf16_f32 v60, v60, v61
    v_mfma_f32_16x16x32_bf16 v[80:83], v[108:111], v[112:115], v[80:83]
    ds_read_b128 v[88:91], v13 offset:0
    v_cvt_pk_bf16_f32 v61, v62, v63
    v_mfma_f32_16x16x32_bf16 v[64:67], v[236:239], v[100:103], v[64:67]
    v_cvt_pk_bf16_f32 v62, v76, v77
    v_mfma_f32_16x16x32_bf16 v[80:83], v[252:255], v[100:103], v[80:83]
    s_waitcnt lgkmcnt(4)
    v_cvt_pk_bf16_f32 v63, v78, v79
    v_mfma_f32_16x16x32_bf16 v[64:67], v[104:107], v[96:99], v[64:67]
    buffer_store_dwordx4 v[60:63], v5, s[44:47], s82 offen offset:256 sc1
    v_mfma_f32_16x16x32_bf16 v[80:83], v[92:95], v[96:99], v[80:83]
    s_waitcnt lgkmcnt(1)
    v_mfma_f32_16x16x32_bf16 v[64:67], v[120:123], v[124:127], v[64:67]
    v_mfma_f32_16x16x32_bf16 v[80:83], v[116:119], v[124:127], v[80:83]
    s_add_u32 s80, s80, 1
    s_cmp_lt_u32 s80, 8
    s_cbranch_scc1 L_pass_23
    s_nop 3
    v_cvt_pk_bf16_f32 v64, v64, v65
    v_cvt_pk_bf16_f32 v65, v66, v67
    v_cvt_pk_bf16_f32 v66, v80, v81
    v_cvt_pk_bf16_f32 v67, v82, v83
    buffer_store_dwordx4 v[64:67], v5, s[44:47], s82 offen offset:384 sc1
    s_waitcnt vmcnt(0)
    buffer_store_dword v1, v2, s[20:23], s83 offen sc1
    s_waitcnt vmcnt(0)
    s_endpgm
L_pe_15:
L_ops_24:
    s_add_u32 s94, s94, 1
    s_mov_b32 s10, 400000
L_ops_24_l:
    buffer_load_dword v11, v6, s[20:23], s85 offen offset:0 sc1
    s_waitcnt vmcnt(0)
    v_cmp_ne_u32 vcc, s8, v11
    s_nop 1
    s_cbranch_vccz L_opb_25
    s_sub_u32 s10, s10, 1
    s_cmp_lg_u32 s10, 0
    s_cbranch_scc1 L_ops_24_l
    s_branch L_opb_25
L_slow_30:
    s_lshr_b32 s64, s95, 3
    s_lshl1_add_u32 s64, s6, s64
    s_lshl_b32 s64, s64, 14
    s_and_b32 s65, s95, 7
    s_lshl3_add_u32 s64, s65, s64
    s_add_u32 s78, s64, 4194304
    v_lshlrev_b32 v19, 6, v0
    s_lshl_b32 s79, s4, 12
    s_add_u32 s79, s79, 32768
    s_mul_i32 s92, s7, 229376
    s_lshl_b32 s70, s3, 8
    s_waitcnt vmcnt(14)
    v_lshlrev_b32 v36, 16, v96
    s_waitcnt vmcnt(12)
    v_lshlrev_b32 v52, 16, v100
    v_and_b32 v37, s62, v96
    s_add_u32 s92, s92, s70
    s_lshl_b32 s70, s100, 15
    v_and_b32 v53, s62, v100
    v_lshlrev_b32 v38, 16, v97
    v_lshlrev_b32 v54, 16, v101
    s_add_u32 s92, s92, s70
    s_lshl_b32 s93, s3, 15
    v_and_b32 v39, s62, v97
    v_and_b32 v55, s62, v101
    v_lshlrev_b32 v40, 16, v98
    s_add_u32 s93, s93, 32768
    s_lshl_b32 s71, s3, 1
    s_waitcnt vmcnt(11)
    v_lshlrev_b32 v56, 16, v102
    v_and_b32 v41, s62, v98
    v_and_b32 v57, s62, v102
    s_mov_b32 s91, s6
    s_and_b32 s91, s91, 3
    v_lshlrev_b32 v42, 16, v99
    v_lshlrev_b32 v58, 16, v103
    v_and_b32 v43, s62, v99
    s_lshl_b32 s70, s91, 12
    s_add_u32 m0, s70, s93
    v_and_b32 v59, s62, v103
    v_add_f32 v68, v36, v37
    v_add_f32 v72, v52, v53
    s_lshl_b32 s70, s91, 15
    s_add_u32 s70, s70, s92
    v_mul_f32 v69, v36, v36
    v_mul_f32 v73, v52, v52
    v_fmac_f32 v69, v37, v37
    s_add_u32 s91, s91, 1
    buffer_load_dwordx4 v124, s[32:35], s70 offen offset:0 lds
    v_fmac_f32 v73, v53, v53
    v_add_f32 v68, v68, v38
    v_add_f32 v72, v72, v54
    buffer_load_dwordx4 v125, s[32:35], s70 offen offset:1024 lds
    buffer_load_dwordx4 v126, s[32:35], s70 offen offset:2048 lds
    v_fmac_f32 v69, v38, v38
    v_fmac_f32 v73, v54, v54
    v_add_f32 v68, v68, v39
    buffer_load_dwordx4 v127, s[32:35], s70 offen offset:3072 lds
    s_add_u32 m0, m0, 16384
    v_add_f32 v72, v72, v55
    v_fmac_f32 v69, v39, v39
    v_fmac_f32 v73, v55, v55
    s_add_u32 s70, s70, 128
    buffer_load_dwordx4 v124, s[32:35], s70 offen offset:0 lds
    v_add_f32 v68, v68, v40
    v_add_f32 v72, v72, v56
    v_fmac_f32 v69, v40, v40
    buffer_load_dwordx4 v125, s[32:35], s70 offen offset:1024 lds
    buffer_load_dwordx4 v126, s[32:35], s70 offen offset:2048 lds
    v_fmac_f32 v73, v56, v56
    v_add_f32 v68, v68, v41
    v_add_f32 v72, v72, v57
    buffer_load_dwordx4 v127, s[32:35], s70 offen offset:3072 lds
    s_and_b32 s91, s91, 3
    v_fmac_f32 v69, v41, v41
    v_fmac_f32 v73, v57, v57
    v_add_f32 v68, v68, v42
    s_lshl_b32 s70, s91, 12
    s_add_u32 m0, s70, s93
    v_add_f32 v72, v72, v58
    v_fmac_f32 v69, v42, v42
    v_fmac_f32 v73, v58, v58
    s_lshl_b32 s70, s91, 15
    s_add_u32 s70, s70, s92
    v_add_f32 v68, v68, v43
    v_add_f32 v72, v72, v59
    v_fmac_f32 v69, v43, v43
    s_add_u32 s91, s91, 1
    buffer_load_dwordx4 v124, s[32:35], s70 offen offset:0 lds
    v_fmac_f32 v73, v59, v59
    v_permlane32_swap_b32 v68, v69
    s_nop 0
    v_permlane32_swap_b32 v72, v73
    buffer_load_dwordx4 v125, s[32:35], s70 offen offset:1024 lds
    buffer_load_dwordx4 v126, s[32:35], s70 offen offset:2048 lds
    v_add_f32 v68, v68, v69
    v_add_f32 v72, v72, v73
    s_nop 0
    v_add_f32_dpp v68, v68, v68 quad_perm:[1,0,3,2] row_mask:0xf bank_mask:0xf
    buffer_load_dwordx4 v127, s[32:35], s70 offen offset:3072 lds
    s_add_u32 m0, m0, 16384
    v_add_f32_dpp v72, v72, v72 quad_perm:[1,0,3,2] row_mask:0xf bank_mask:0xf
    v_add_f32_dpp v68, v68, v68 quad_perm:[2,3,0,1] row_mask:0xf bank_mask:0xf
    s_nop 0
    v_add_f32_dpp v72, v72, v72 quad_perm:[2,3,0,1] row_mask:0xf bank_mask:0xf
    s_add_u32 s70, s70, 128
    buffer_load_dwordx4 v124, s[32:35], s70 offen offset:0 lds
    v_add_f32_dpp v68, v68, v68 row_half_mirror row_mask:0xf bank_mask:0xf
    v_add_f32_dpp v72, v72, v72 row_half_mirror row_mask:0xf bank_mask:0xf
    s_nop 0
    v_add_f32_dpp v68, v68, v68 row_mirror row_mask:0xf bank_mask:0xf
    buffer_load_dwordx4 v125, s[32:35], s70 offen offset:1024 lds
    buffer_load_dwordx4 v126, s[32:35], s70 offen offset:2048 lds
    v_add_f32_dpp v72, v72, v72 row_mirror row_mask:0xf bank_mask:0xf
    v_add_f32_dpp v68, v68, v68 row_bcast:15 row_mask:0xa bank_mask:0xf
    s_nop 0
    v_add_f32_dpp v72, v72, v72 row_bcast:15 row_mask:0xa bank_mask:0xf
    buffer_load_dwordx4 v127, s[32:35], s70 offen offset:3072 lds
    s_and_b32 s91, s91, 3
    v_mul_f32 v68, 0x3b000000, v68
    v_mul_f32 v72, 0x3b000000, v72
    v_readlane_b32 s72, v68, 31
    s_lshl_b32 s70, s91, 12
    s_add_u32 m0, s70, s93
    v_readlane_b32 s74, v72, 31
    v_readlane_b32 s73, v68, 63
    v_readlane_b32 s75, v72, 63
    s_lshl_b32 s70, s91, 15
    s_add_u32 s70, s70, s92
    v_mov_b32 v69, s72
    v_mov_b32 v73, s74
    v_fma_f32 v68, -v69, v69, s73
    s_add_u32 s91, s91, 1
    buffer_load_dwordx4 v124, s[32:35], s70 offen offset:0 lds
    v_fma_f32 v72, -v73, v73, s75
    v_max_f32 v68, 0, v68
    v_max_f32 v72, 0, v72
    buffer_load_dwordx4 v125, s[32:35], s70 offen offset:1024 lds
    buffer_load_dwordx4 v126, s[32:35], s70 offen offset:2048 lds
    v_add_f32 v68, 0x3727c5ac, v68
    v_add_f32 v72, 0x3727c5ac, v72
    v_rsq_f32 v68, v68
    buffer_load_dwordx4 v127, s[32:35], s70 offen offset:3072 lds
    s_add_u32 m0, m0, 16384
    v_rsq_f32 v72, v72
    v_mul_f32_e64 v69, -v69, v68
    v_mul_f32_e64 v73, -v73, v72
    s_add_u32 s70, s70, 128
    buffer_load_dwordx4 v124, s[32:35], s70 offen offset:0 lds
    v_fma_f32 v44, v36, v68, v69
    v_fma_f32 v60, v52, v72, v73
    v_fma_f32 v45, v37, v68, v69
    buffer_load_dwordx4 v125, s[32:35], s70 offen offset:1024 lds
    buffer_load_dwordx4 v126, s[32:35], s70 offen offset:2048 lds
    v_fma_f32 v61, v53, v72, v73
    v_fma_f32 v46, v38, v68, v69
    v_fma_f32 v62, v54, v72, v73
    buffer_load_dwordx4 v127, s[32:35], s70 offen offset:3072 lds
    s_and_b32 s91, s91, 3
    v_fma_f32 v47, v39, v68, v69
    v_fma_f32 v63, v55, v72, v73
    v_fma_f32 v48, v40, v68, v69
    s_lshl_b32 s70, s91, 12
    s_add_u32 m0, s70, s93
    v_fma_f32 v64, v56, v72, v73
    v_fma_f32 v49, v41, v68, v69
    v_fma_f32 v65, v57, v72, v73
    s_lshl_b32 s70, s91, 15
    s_add_u32 s70, s70, s92
    v_fma_f32 v50, v42, v68, v69
    v_fma_f32 v66, v58, v72, v73
    v_fma_f32 v51, v43, v68, v69
    s_add_u32 s91, s91, 1
    buffer_load_dwordx4 v124, s[32:35], s70 offen offset:0 lds
    v_fma_f32 v67, v59, v72, v73
    buffer_load_dwordx4 v125, s[32:35], s70 offen offset:1024 lds
    buffer_load_dwordx4 v126, s[32:35], s70 offen offset:2048 lds
    buffer_load_dwordx4 v127, s[32:35], s70 offen offset:3072 lds
    s_add_u32 m0, m0, 16384
    s_add_u32 s70, s70, 128
    buffer_load_dwordx4 v124, s[32:35], s70 offen offset:0 lds
    buffer_load_dwordx4 v125, s[32:35], s70 offen offset:1024 lds
    buffer_load_dwordx4 v126, s[32:35], s70 offen offset:2048 lds
    buffer_load_dwordx4 v127, s[32:35], s70 offen offset:3072 lds
    v_lshrrev_b32 v10, 4, v0
    v_and_b32 v11, 15, v0
    s_lshl_b32 s64, s3, 11
    s_add_u32 s64, s64, 57344
    v_add_u32 v4, s64, v3
    v_lshrrev_b32 v5, 1, v11
    v_lshlrev_b32 v5, 14, v5
    v_lshl_add_u32 v5, v10, 4, v5
    v_and_b32 v16, 1, v0
    v_lshl_add_u32 v5, v16, 6, v5
    s_lshl_b32 s66, s7, 11
    s_lshl_b32 s67, s3, 9
    s_add_u32 s66, s66, s67
    v_add_u32 v5, s66, v5
    s_lshl_b32 s66, s3, 15
    s_add_u32 s66, s66, 32768
    v_add_u32 v12, s66, v3
    s_waitcnt vmcnt(36)
    v_lshlrev_b32 v20, 16, v80
    v_and_b32 v21, s62, v80
    v_lshlrev_b32 v22, 16, v81
    v_and_b32 v23, s62, v81
    s_waitcnt vmcnt(35)
    v_lshlrev_b32 v24, 16, v82
    v_and_b32 v25, s62, v82
    v_lshlrev_b32 v26, 16, v83
    v_and_b32 v27, s62, v83
    s_waitcnt vmcnt(34)
    v_lshlrev_b32 v28, 16, v84
    v_and_b32 v29, s62, v84
    v_lshlrev_b32 v30, 16, v85
    v_and_b32 v31, s62, v85
    v_min_u32 v6, 31, v0
    v_lshlrev_b32 v6, 2, v6
    v_and_b32 v16, 7, v0
    v_xor_b32 v16, v16, v10
    v_lshlrev_b32 v16, 4, v16
    v_lshl_add_u32 v8, v11, 7, v16
    v_xor_b32 v34, 64, v8
    v_and_b32 v16, 3, v0
    v_lshlrev_b32 v16, 4, v16
    v_lshrrev_b32 v17, 2, v11
    v_lshl_add_u32 v16, v17, 7, v16
    v_lshl_add_u32 v7, v10, 11, v16
    s_lshl_b32 s64, s7, 14
    s_lshl_b32 s65, s99, 6
    s_add_u32 s64, s64, s65
    v_add_u32 v7, s64, v7
    s_lshl4_add_u32 s64, s6, s95
    s_lshl_b32 s64, s64, 11
    v_lshl_add_u32 v35, v0, 3, s64
    s_lshl_b32 s64, s99, 3
    s_add_u32 s64, s64, 62464
    v_add_u32 v13, s64, v3
    s_and_b32 s64, s95, 7
    v_and_b32 v16, 7, v0
    v_xor_b32 v16, s64, v16
    v_lshlrev_b32 v16, 4, v16
    v_lshrrev_b32 v17, 3, v0
    v_lshl_add_u32 v16, v17, 11, v16
    s_lshl_b32 s64, s95, 7
    v_add_u32 v15, s64, v16
    v_and_b32 v16, 1, v11
    v_lshlrev_b32 v16, 4, v16
    v_mov_b32 v17, 0x3f80
    v_lshlrev_b32 v16, v16, v17
    v_lshrrev_b32 v11, 1, v11
    v_cmp_eq_u32 vcc, 0, v11
    s_nop 1
    v_cndmask_b32 v17, 0, v16, vcc
    v_accvgpr_write_b32 a192, v17
    v_cmp_eq_u32 vcc, 1, v11
    s_nop 1
    v_cndmask_b32 v17, 0, v16, vcc
    v_accvgpr_write_b32 a193, v17
    v_cmp_eq_u32 vcc, 2, v11
    s_nop 1
    v_cndmask_b32 v17, 0, v16, vcc
    v_accvgpr_write_b32 a194, v17
    v_cmp_eq_u32 vcc, 3, v11
    s_nop 1
    v_cndmask_b32 v17, 0, v16, vcc
    v_accvgpr_write_b32 a195, v17
    v_cmp_eq_u32 vcc, 4, v11
    s_nop 1
    v_cndmask_b32 v17, 0, v16, vcc
    v_accvgpr_write_b32 a196, v17
    v_cmp_eq_u32 vcc, 5, v11
    s_nop 1
    v_cndmask_b32 v17, 0, v16, vcc
    v_accvgpr_write_b32 a197, v17
    v_cmp_eq_u32 vcc, 6, v11
    s_nop 1
    v_cndmask_b32 v17, 0, v16, vcc
    v_accvgpr_write_b32 a198, v17
    v_cmp_eq_u32 vcc, 7, v11
    s_nop 1
    v_cndmask_b32 v17, 0, v16, vcc
    v_accvgpr_write_b32 a199, v17
    v_xor_b32 v10, 0x800, v4
    s_mov_b32 s10, 400000
    s_nop 0
L_poll_48:
    buffer_load_dwordx4 v[96:99], v3, s[12:15], s79 offen sc1
    buffer_load_dwordx4 v[100:103], v3, s[12:15], s79 offen offset:1024 sc1
    s_waitcnt vmcnt(0)
    v_xor_b32 v96, s8, v96
    v_xor_b32 v97, s8, v97
    v_xor_b32 v98, s8, v98
    v_xor_b32 v99, s8, v99
    v_xor_b32 v100, s8, v100
    v_xor_b32 v101, s8, v101
    v_xor_b32 v102, s8, v102
    v_xor_b32 v103, s8, v103
    v_or3_b32 v96, v96, v97, v98
    v_or3_b32 v99, v99, v100, v101
    v_or3_b32 v96, v96, v102, v103
    v_or_b32 v96, v96, v99
    v_cmp_ne_u32 vcc, 0, v96
    s_nop 0
    s_cbranch_vccz L_polld_49
    s_sleep 12
    s_sub_u32 s10, s10, 1
    s_cmp_lg_u32 s10, 0
    s_cbranch_scc1 L_poll_48
L_polld_49:
    buffer_load_dwordx2 v[76:77], v19, s[12:15], s78 offen sc1
    s_add_u32 s78, s78, 4096
    buffer_load_dwordx2 v[78:79], v19, s[12:15], s78 offen sc1
    s_add_u32 s78, s78, 4096
    buffer_load_dwordx2 v[80:81], v19, s[12:15], s78 offen sc1
    s_add_u32 s78, s78, 4096
    buffer_load_dwordx2 v[82:83], v19, s[12:15], s78 offen sc1
    s_add_u32 s78, s78, 1036288
    s_lshl_b32 s64, s3, 15
    s_add_u32 s64, s64, 32768
    v_add_u32 v116, s64, v112
    v_add_u32 v117, s64, v113
    v_add_u32 v118, s64, v114
    v_add_u32 v119, s64, v115
    ds_read_b64_tr_b16 v[128:129], v116 offset:0
    ds_read_b64_tr_b16 v[130:131], v116 offset:2048
    ds_read_b64_tr_b16 v[132:133], v117 offset:0
    ds_read_b64_tr_b16 v[134:135], v117 offset:2048
    ds_read_b64_tr_b16 v[136:137], v118 offset:0
    ds_read_b64_tr_b16 v[138:139], v118 offset:2048
    ds_read_b64_tr_b16 v[140:141], v119 offset:0
    ds_read_b64_tr_b16 v[142:143], v119 offset:2048
    ds_read_b64_tr_b16 v[144:145], v116 offset:16384
    ds_read_b64_tr_b16 v[146:147], v116 offset:18432
    ds_read_b64_tr_b16 v[148:149], v117 offset:16384
    ds_read_b64_tr_b16 v[150:151], v117 offset:18432
    ds_read_b64_tr_b16 v[152:153], v118 offset:16384
    ds_read_b64_tr_b16 v[154:155], v118 offset:18432
    ds_read_b64_tr_b16 v[156:157], v119 offset:16384
    ds_read_b64_tr_b16 v[158:159], v119 offset:18432
    ds_read_b64_tr_b16 v[160:161], v116 offset:4096
    ds_read_b64_tr_b16 v[162:163], v116 offset:6144
    ds_read_b64_tr_b16 v[164:165], v117 offset:4096
    ds_read_b64_tr_b16 v[166:167], v117 offset:6144
    ds_read_b64_tr_b16 v[168:169], v118 offset:4096
    ds_read_b64_tr_b16 v[170:171], v118 offset:6144
    ds_read_b64_tr_b16 v[172:173], v119 offset:4096
    ds_read_b64_tr_b16 v[174:175], v119 offset:6144
    ds_read_b64_tr_b16 v[176:177], v116 offset:20480
    ds_read_b64_tr_b16 v[178:179], v116 offset:22528
    ds_read_b64_tr_b16 v[180:181], v117 offset:20480
    ds_read_b64_tr_b16 v[182:183], v117 offset:22528
    ds_read_b64_tr_b16 v[184:185], v118 offset:20480
    ds_read_b64_tr_b16 v[186:187], v118 offset:22528
    ds_read_b64_tr_b16 v[188:189], v119 offset:20480
    ds_read_b64_tr_b16 v[190:191], v119 offset:22528
    ds_read_b64_tr_b16 v[192:193], v116 offset:8192
    ds_read_b64_tr_b16 v[194:195], v116 offset:10240
    ds_read_b64_tr_b16 v[196:197], v117 offset:8192
    ds_read_b64_tr_b16 v[198:199], v117 offset:10240
    ds_read_b64_tr_b16 v[200:201], v118 offset:8192
    ds_read_b64_tr_b16 v[202:203], v118 offset:10240
    ds_read_b64_tr_b16 v[204:205], v119 offset:8192
    ds_read_b64_tr_b16 v[206:207], v119 offset:10240
    ds_read_b64_tr_b16 v[208:209], v116 offset:24576
    ds_read_b64_tr_b16 v[210:211], v116 offset:26624
    ds_read_b64_tr_b16 v[212:213], v117 offset:24576
    ds_read_b64_tr_b16 v[214:215], v117 offset:26624
    ds_read_b64_tr_b16 v[216:217], v118 offset:24576
    ds_read_b64_tr_b16 v[218:219], v118 offset:26624
    ds_read_b64_tr_b16 v[220:221], v119 offset:24576
    ds_read_b64_tr_b16 v[222:223], v119 offset:26624
    ds_read_b64_tr_b16 v[224:225], v116 offset:12288
    ds_read_b64_tr_b16 v[226:227], v116 offset:14336
    ds_read_b64_tr_b16 v[228:229], v117 offset:12288
    ds_read_b64_tr_b16 v[230:231], v117 offset:14336
    ds_read_b64_tr_b16 v[232:233], v118 offset:12288
    ds_read_b64_tr_b16 v[234:235], v118 offset:14336
    ds_read_b64_tr_b16 v[236:237], v119 offset:12288
    ds_read_b64_tr_b16 v[238:239], v119 offset:14336
    ds_read_b64_tr_b16 v[240:241], v116 offset:28672
    ds_read_b64_tr_b16 v[242:243], v116 offset:30720
    ds_read_b64_tr_b16 v[244:245], v117 offset:28672
    ds_read_b64_tr_b16 v[246:247], v117 offset:30720
    ds_read_b64_tr_b16 v[248:249], v118 offset:28672
    ds_read_b64_tr_b16 v[250:251], v118 offset:30720
    ds_read_b64_tr_b16 v[252:253], v119 offset:28672
    ds_read_b64_tr_b16 v[254:255], v119 offset:30720
L_pb_25:
    s_waitcnt lgkmcnt(0)
    s_mov_b32 s66, 0
    s_mov_b32 s67, 16384
    s_lshl_b32 s68, s95, 2
    s_add_u32 s68, s68, 50176
    s_waitcnt vmcnt(3)
    v_lshlrev_b32 v16, 16, v76
    v_lshlrev_b32 v70, 16, v77
    v_and_b32 v17, s62, v76
    v_and_b32 v71, s62, v77
    v_fmac_f32 v36, v44, v16
    v_fmac_f32 v52, v60, v70
    v_fmac_f32 v37, v45, v17
    v_fmac_f32 v53, v61, v71
    s_waitcnt vmcnt(2)
    v_lshlrev_b32 v16, 16, v78
    v_lshlrev_b32 v70, 16, v79
    v_and_b32 v17, s62, v78
    v_and_b32 v71, s62, v79
    v_fmac_f32 v38, v46, v16
    v_fmac_f32 v54, v62, v70
    v_fmac_f32 v39, v47, v17
    v_fmac_f32 v55, v63, v71
    s_waitcnt vmcnt(1)
    v_lshlrev_b32 v16, 16, v80
    v_lshlrev_b32 v70, 16, v81
    v_and_b32 v17, s62, v80
    v_and_b32 v71, s62, v81
    v_fmac_f32 v40, v48, v16
    v_fmac_f32 v56, v64, v70
    v_fmac_f32 v41, v49, v17
    v_fmac_f32 v57, v65, v71
    s_waitcnt vmcnt(0)
    v_lshlrev_b32 v16, 16, v82
    v_lshlrev_b32 v70, 16, v83
    v_and_b32 v17, s62, v82
    v_and_b32 v71, s62, v83
    v_fmac_f32 v42, v50, v16
    v_fmac_f32 v58, v66, v70
    v_fmac_f32 v43, v51, v17
    v_fmac_f32 v59, v67, v71
    v_add_f32 v68, v36, v37
    v_add_f32 v72, v52, v53
    v_mul_f32 v69, v36, v36
    v_mul_f32 v73, v52, v52
    v_fmac_f32 v69, v37, v37
    v_fmac_f32 v73, v53, v53
    v_add_f32 v68, v68, v38
    v_add_f32 v72, v72, v54
    v_fmac_f32 v69, v38, v38
    v_fmac_f32 v73, v54, v54
    v_add_f32 v68, v68, v39
    v_add_f32 v72, v72, v55
    v_fmac_f32 v69, v39, v39
    v_fmac_f32 v73, v55, v55
    v_add_f32 v68, v68, v40
    v_add_f32 v72, v72, v56
    v_fmac_f32 v69, v40, v40
    v_fmac_f32 v73, v56, v56
    v_add_f32 v68, v68, v41
    v_add_f32 v72, v72, v57
    v_fmac_f32 v69, v41, v41
    v_fmac_f32 v73, v57, v57
    v_add_f32 v68, v68, v42
    v_add_f32 v72, v72, v58
    v_fmac_f32 v69, v42, v42
    v_fmac_f32 v73, v58, v58
    v_add_f32 v68, v68, v43
    v_add_f32 v72, v72, v59
    v_fmac_f32 v69, v43, v43
    v_fmac_f32 v73, v59, v59
    s_nop 0
    v_permlane32_swap_b32 v68, v69
    v_permlane32_swap_b32 v72, v73
    v_add_f32 v68, v68, v69
    v_add_f32 v72, v72, v73
    s_nop 0
    v_add_f32_dpp v68, v68, v68 quad_perm:[1,0,3,2] row_mask:0xf bank_mask:0xf
    v_add_f32_dpp v72, v72, v72 quad_perm:[1,0,3,2] row_mask:0xf bank_mask:0xf
    s_nop 0
    v_add_f32_dpp v68, v68, v68 quad_perm:[2,3,0,1] row_mask:0xf bank_mask:0xf
    v_add_f32_dpp v72, v72, v72 quad_perm:[2,3,0,1] row_mask:0xf bank_mask:0xf
    s_nop 0
    v_add_f32_dpp v68, v68, v68 row_half_mirror row_mask:0xf bank_mask:0xf
    v_add_f32_dpp v72, v72, v72 row_half_mirror row_mask:0xf bank_mask:0xf
    s_nop 0
    v_add_f32_dpp v68, v68, v68 row_mirror row_mask:0xf bank_mask:0xf
    v_add_f32_dpp v72, v72, v72 row_mirror row_mask:0xf bank_mask:0xf
    s_nop 0
    v_add_f32_dpp v68, v68, v68 row_bcast:15 row_mask:0xa bank_mask:0xf
    v_add_f32_dpp v72, v72, v72 row_bcast:15 row_mask:0xa bank_mask:0xf
    v_mul_f32 v68, 0x3b000000, v68
    v_mul_f32 v72, 0x3b000000, v72
    v_readlane_b32 s72, v68, 31
    v_readlane_b32 s74, v72, 31
    v_readlane_b32 s73, v68, 63
    v_readlane_b32 s75, v72, 63
    v_mov_b32 v69, s72
    v_mov_b32 v73, s74
    v_fma_f32 v68, -v69, v69, s73
    v_fma_f32 v72, -v73, v73, s75
    v_max_f32 v68, 0, v68
    v_max_f32 v72, 0, v72
    v_add_f32 v68, 0x3727c5ac, v68
    v_add_f32 v72, 0x3727c5ac, v72
    v_rsq_f32 v68, v68
    v_rsq_f32 v72, v72
    v_mul_f32_e64 v69, -v69, v68
    v_mul_f32_e64 v73, -v73, v72
    v_fma_f32 v44, v36, v68, v69
    v_fma_f32 v60, v52, v72, v73
    v_fma_f32 v45, v37, v68, v69
    v_fma_f32 v61, v53, v72, v73
    v_fma_f32 v46, v38, v68, v69
    v_fma_f32 v62, v54, v72, v73
    v_fma_f32 v47, v39, v68, v69
    v_fma_f32 v63, v55, v72, v73
    v_fma_f32 v48, v40, v68, v69
    v_fma_f32 v64, v56, v72, v73
    v_fma_f32 v49, v41, v68, v69
    v_fma_f32 v65, v57, v72, v73
    v_fma_f32 v50, v42, v68, v69
    v_fma_f32 v66, v58, v72, v73
    v_fma_f32 v51, v43, v68, v69
    v_fma_f32 v67, v59, v72, v73
    v_cvt_pk_bf16_f32 v44, v44, v45
    v_cvt_pk_bf16_f32 v60, v60, v61
    v_cvt_pk_bf16_f32 v45, v46, v47
    v_cvt_pk_bf16_f32 v61, v62, v63
    v_cvt_pk_bf16_f32 v46, v48, v49
    v_cvt_pk_bf16_f32 v62, v64, v65
    v_cvt_pk_bf16_f32 v47, v50, v51
    v_cvt_pk_bf16_f32 v63, v66, v67
    buffer_store_dwordx4 v[44:47], v15, s[20:23], s66 offen sc1
    buffer_store_dwordx4 v[60:63], v15, s[20:23], s67 offen sc1
    v_mov_b32 v68, v76
    v_mov_b32 v69, v78
    v_mov_b32 v70, v80
    v_mov_b32 v71, v82
    v_mov_b32 v72, v77
    v_mov_b32 v73, v79
    v_mov_b32 v74, v81
    v_mov_b32 v75, v83
    s_mul_i32 s92, s7, 229376
    s_lshl_b32 s70, s3, 8
    s_add_u32 s92, s92, s70
    s_cmp_eq_u32 s3, 3
    s_cselect_b32 s77, 6, 4
    s_cselect_b32 s71, -1, 1
    s_add_u32 s77, s77, s100
    s_lshl_b32 s93, s3, 15
    s_add_u32 s93, s93, 32768
    s_and_b32 s91, s6, 3
    s_cmp_ge_u32 s91, 3
    s_cselect_b32 s91, 0, s91
    s_lshl_b32 s70, s91, 12
    s_add_u32 m0, s70, s93
    s_mul_i32 s70, s91, s71
    s_add_u32 s70, s70, s77
    s_cmp_eq_u32 s70, 7
    s_cselect_b32 s70, 0, s70
    s_lshl_b32 s70, s70, 15
    s_add_u32 s70, s70, s92
    s_add_u32 s91, s91, 1
    buffer_load_dwordx4 v124, s[32:35], s70 offen offset:0 lds
    buffer_load_dwordx4 v125, s[32:35], s70 offen offset:1024 lds
    buffer_load_dwordx4 v126, s[32:35], s70 offen offset:2048 lds
    buffer_load_dwordx4 v127, s[32:35], s70 offen offset:3072 lds
    s_add_u32 m0, m0, 12288
    s_add_u32 s70, s70, 128
    buffer_load_dwordx4 v124, s[32:35], s70 offen offset:0 lds
    buffer_load_dwordx4 v125, s[32:35], s70 offen offset:1024 lds
    buffer_load_dwordx4 v126, s[32:35], s70 offen offset:2048 lds
    buffer_load_dwordx4 v127, s[32:35], s70 offen offset:3072 lds
    s_cmp_ge_u32 s91, 3
    s_cselect_b32 s91, 0, s91
    s_lshl_b32 s70, s91, 12
    s_add_u32 m0, s70, s93
    s_mul_i32 s70, s91, s71
    s_add_u32 s70, s70, s77
    s_cmp_eq_u32 s70, 7
    s_cselect_b32 s70, 0, s70
    s_lshl_b32 s70, s70, 15
    s_add_u32 s70, s70, s92
    s_add_u32 s91, s91, 1
    buffer_load_dwordx4 v124, s[32:35], s70 offen offset:0 lds
    buffer_load_dwordx4 v125, s[32:35], s70 offen offset:1024 lds
    buffer_load_dwordx4 v126, s[32:35], s70 offen offset:2048 lds
    buffer_load_dwordx4 v127, s[32:35], s70 offen offset:3072 lds
    s_add_u32 m0, m0, 12288
    s_add_u32 s70, s70, 128
    buffer_load_dwordx4 v124, s[32:35], s70 offen offset:0 lds
    buffer_load_dwordx4 v125, s[32:35], s70 offen offset:1024 lds
    buffer_load_dwordx4 v126, s[32:35], s70 offen offset:2048 lds
    buffer_load_dwordx4 v127, s[32:35], s70 offen offset:3072 lds
    s_cmp_ge_u32 s91, 3
    s_cselect_b32 s91, 0, s91
    s_lshl_b32 s70, s91, 12
    s_add_u32 m0, s70, s93
    s_mul_i32 s70, s91, s71
    s_add_u32 s70, s70, s77
    s_cmp_eq_u32 s70, 7
    s_cselect_b32 s70, 0, s70
    s_lshl_b32 s70, s70, 15
    s_add_u32 s70, s70, s92
    s_add_u32 s91, s91, 1
    buffer_load_dwordx4 v124, s[32:35], s70 offen offset:0 lds
    buffer_load_dwordx4 v125, s[32:35], s70 offen offset:1024 lds
    buffer_load_dwordx4 v126, s[32:35], s70 offen offset:2048 lds
    buffer_load_dwordx4 v127, s[32:35], s70 offen offset:3072 lds
    s_add_u32 m0, m0, 12288
    s_add_u32 s70, s70, 128
    buffer_load_dwordx4 v124, s[32:35], s70 offen offset:0 lds
    buffer_load_dwordx4 v125, s[32:35], s70 offen offset:1024 lds
    buffer_load_dwordx4 v126, s[32:35], s70 offen offset:2048 lds
    buffer_load_dwordx4 v127, s[32:35], s70 offen offset:3072 lds
    v_lshlrev_b32 v120, 16, v90
    v_and_b32 v121, s62, v90
    v_lshlrev_b32 v122, 16, v91
    v_and_b32 v123, s62, v91
    v_lshlrev_b32 v124, 16, v92
    v_and_b32 v125, s62, v92
    v_lshlrev_b32 v126, 16, v93
    v_and_b32 v127, s62, v93
    v_add_u32 v18, 24576, v12
    v_add_f32 v36, v36, v120
    v_add_f32 v37, v37, v121
    v_add_f32 v38, v38, v122
    v_add_f32 v39, v39, v123
    v_add_f32 v40, v40, v124
    v_add_f32 v41, v41, v125
    v_add_f32 v42, v42, v126
    v_add_f32 v43, v43, v127
    ds_write_b128 v18, v[36:39] offset:0
    ds_write_b128 v18, v[40:43] offset:1024
    v_add_f32 v52, v52, v120
    v_add_f32 v53, v53, v121
    v_add_f32 v54, v54, v122
    v_add_f32 v55, v55, v123
    v_add_f32 v56, v56, v124
    v_add_f32 v57, v57, v125
    v_add_f32 v58, v58, v126
    v_add_f32 v59, v59, v127
    ds_write_b128 v18, v[52:55] offset:2048
    ds_write_b128 v18, v[56:59] offset:3072
    v_lshlrev_b32 v44, 16, v104
    v_and_b32 v45, s62, v104
    v_lshlrev_b32 v46, 16, v105
    v_and_b32 v47, s62, v105
    v_lshlrev_b32 v48, 16, v106
    v_and_b32 v49, s62, v106
    v_lshlrev_b32 v50, 16, v107
    v_and_b32 v51, s62, v107
    ds_write_b128 v18, v[44:47] offset:4096
    ds_write_b128 v18, v[48:51] offset:5120
    v_lshlrev_b32 v60, 16, v108
    v_and_b32 v61, s62, v108
    v_lshlrev_b32 v62, 16, v109
    v_and_b32 v63, s62, v109
    v_lshlrev_b32 v64, 16, v110
    v_and_b32 v65, s62, v110
    v_lshlrev_b32 v66, 16, v111
    v_and_b32 v67, s62, v111
    ds_write_b128 v18, v[60:63] offset:6144
    ds_write_b128 v18, v[64:67] offset:7168
L_pb_26:
    s_waitcnt vmcnt(24)
    buffer_store_dword v1, v2, s[20:23], s68 offen sc1
    buffer_store_dword v1, v2, s[20:23], s68 offen offset:128 sc1
    v_accvgpr_write_b32 a200, 0
    v_accvgpr_write_b32 a201, 0
    v_accvgpr_write_b32 a202, 0
    v_accvgpr_write_b32 a203, 0
    v_accvgpr_write_b32 a204, 0
    v_accvgpr_write_b32 a205, 0
    v_accvgpr_write_b32 a206, 0
    v_accvgpr_write_b32 a207, 0
    v_accvgpr_write_b32 a208, 0
    v_accvgpr_write_b32 a209, 0
    v_accvgpr_write_b32 a210, 0
    v_accvgpr_write_b32 a211, 0
    v_accvgpr_write_b32 a212, 0
    v_accvgpr_write_b32 a213, 0
    v_accvgpr_write_b32 a214, 0
    v_accvgpr_write_b32 a215, 0
    v_accvgpr_write_b32 a216, 0
    v_accvgpr_write_b32 a217, 0
    v_accvgpr_write_b32 a218, 0
    v_accvgpr_write_b32 a219, 0
    v_accvgpr_write_b32 a220, 0
    v_accvgpr_write_b32 a221, 0
    v_accvgpr_write_b32 a222, 0
    v_accvgpr_write_b32 a223, 0
    v_accvgpr_write_b32 a224, 0
    v_accvgpr_write_b32 a225, 0
    v_accvgpr_write_b32 a226, 0
    v_accvgpr_write_b32 a227, 0
    v_accvgpr_write_b32 a228, 0
    v_accvgpr_write_b32 a229, 0
    v_accvgpr_write_b32 a230, 0
    v_accvgpr_write_b32 a231, 0
    s_add_u32 s79, s79, 2048
    s_mov_b32 s10, 400000
L_poll_50:
    buffer_load_dwordx4 v[96:99], v3, s[12:15], s79 offen sc1
    buffer_load_dwordx4 v[100:103], v3, s[12:15], s79 offen offset:1024 sc1
    s_waitcnt vmcnt(0)
    v_xor_b32 v96, s8, v96
    v_xor_b32 v97, s8, v97
    v_xor_b32 v98, s8, v98
    v_xor_b32 v99, s8, v99
    v_xor_b32 v100, s8, v100
    v_xor_b32 v101, s8, v101
    v_xor_b32 v102, s8, v102
    v_xor_b32 v103, s8, v103
    v_or3_b32 v96, v96, v97, v98
    v_or3_b32 v99, v99, v100, v101
    v_or3_b32 v96, v96, v102, v103
    v_or_b32 v96, v96, v99
    v_cmp_ne_u32 vcc, 0, v96
    s_nop 0
    s_cbranch_vccz L_polld_51
    s_sleep 12
    s_sub_u32 s10, s10, 1
    s_cmp_lg_u32 s10, 0
    s_cbranch_scc1 L_poll_50
L_polld_51:
    buffer_load_dwordx2 v[104:105], v19, s[12:15], s78 offen sc1
    s_add_u32 s78, s78, 4096
    buffer_load_dwordx2 v[106:107], v19, s[12:15], s78 offen sc1
    s_add_u32 s78, s78, 4096
    buffer_load_dwordx2 v[108:109], v19, s[12:15], s78 offen sc1
    s_add_u32 s78, s78, 4096
    buffer_load_dwordx2 v[110:111], v19, s[12:15], s78 offen sc1
    s_add_u32 s78, s78, 1036288
    s_add_u32 s65, s2, s99
    s_cmp_eq_u32 s65, 0
    s_cselect_b32 s65, 0, 2146435072
    buffer_store_dword v1, v2, s[12:15], s65 offen sc1
L_pb_27:
    ds_read_b64_tr_b16 v[36:37], v116 offset:0
    ds_read_b64_tr_b16 v[38:39], v116 offset:2048
    ds_read_b64_tr_b16 v[40:41], v117 offset:0
    ds_read_b64_tr_b16 v[42:43], v117 offset:2048
    ds_read_b64_tr_b16 v[44:45], v118 offset:0
    ds_read_b64_tr_b16 v[46:47], v118 offset:2048
    ds_read_b64_tr_b16 v[48:49], v119 offset:0
    ds_read_b64_tr_b16 v[50:51], v119 offset:2048
    ds_read_b64_tr_b16 v[52:53], v116 offset:4096
    ds_read_b64_tr_b16 v[54:55], v116 offset:6144
    ds_read_b64_tr_b16 v[56:57], v117 offset:4096
    ds_read_b64_tr_b16 v[58:59], v117 offset:6144
    ds_read_b64_tr_b16 v[60:61], v118 offset:4096
    ds_read_b64_tr_b16 v[62:63], v118 offset:6144
    ds_read_b64_tr_b16 v[64:65], v119 offset:4096
    ds_read_b64_tr_b16 v[66:67], v119 offset:6144
    s_waitcnt lgkmcnt(8)
    v_mov_b32 v11, v51
    ds_write_b128 v12, v[36:39] offset:0
    ds_write_b128 v12, v[40:43] offset:1024
    ds_write_b128 v12, v[44:47] offset:2048
    ds_write_b128 v12, v[48:51] offset:3072
    ds_read_b64_tr_b16 v[36:37], v116 offset:8192
    ds_read_b64_tr_b16 v[38:39], v116 offset:10240
    ds_read_b64_tr_b16 v[40:41], v117 offset:8192
    ds_read_b64_tr_b16 v[42:43], v117 offset:10240
    ds_read_b64_tr_b16 v[44:45], v118 offset:8192
    ds_read_b64_tr_b16 v[46:47], v118 offset:10240
    ds_read_b64_tr_b16 v[48:49], v119 offset:8192
    ds_read_b64_tr_b16 v[50:51], v119 offset:10240
    s_waitcnt lgkmcnt(12)
    v_mov_b32 v11, v67
    ds_write_b128 v12, v[52:55] offset:4096
    ds_write_b128 v12, v[56:59] offset:5120
    ds_write_b128 v12, v[60:63] offset:6144
    ds_write_b128 v12, v[64:67] offset:7168
    ds_read_b64_tr_b16 v[52:53], v116 offset:12288
    ds_read_b64_tr_b16 v[54:55], v116 offset:14336
    ds_read_b64_tr_b16 v[56:57], v117 offset:12288
    ds_read_b64_tr_b16 v[58:59], v117 offset:14336
    ds_read_b64_tr_b16 v[60:61], v118 offset:12288
    ds_read_b64_tr_b16 v[62:63], v118 offset:14336
    ds_read_b64_tr_b16 v[64:65], v119 offset:12288
    ds_read_b64_tr_b16 v[66:67], v119 offset:14336
    s_waitcnt lgkmcnt(12)
    v_mov_b32 v11, v51
    ds_write_b128 v12, v[36:39] offset:8192
    ds_write_b128 v12, v[40:43] offset:9216
    ds_write_b128 v12, v[44:47] offset:10240
    ds_write_b128 v12, v[48:51] offset:11264
    ds_read_b64_tr_b16 v[36:37], v116 offset:16384
    ds_read_b64_tr_b16 v[38:39], v116 offset:18432
    ds_read_b64_tr_b16 v[40:41], v117 offset:16384
    ds_read_b64_tr_b16 v[42:43], v117 offset:18432
    ds_read_b64_tr_b16 v[44:45], v118 offset:16384
    ds_read_b64_tr_b16 v[46:47], v118 offset:18432
    ds_read_b64_tr_b16 v[48:49], v119 offset:16384
    ds_read_b64_tr_b16 v[50:51], v119 offset:18432
    s_waitcnt lgkmcnt(12)
    v_mov_b32 v11, v67
    ds_write_b128 v12, v[52:55] offset:12288
    ds_write_b128 v12, v[56:59] offset:13312
    ds_write_b128 v12, v[60:63] offset:14336
    ds_write_b128 v12, v[64:67] offset:15360
    ds_read_b64_tr_b16 v[52:53], v116 offset:20480
    ds_read_b64_tr_b16 v[54:55], v116 offset:22528
    ds_read_b64_tr_b16 v[56:57], v117 offset:20480
    ds_read_b64_tr_b16 v[58:59], v117 offset:22528
    ds_read_b64_tr_b16 v[60:61], v118 offset:20480
    ds_read_b64_tr_b16 v[62:63], v118 offset:22528
    ds_read_b64_tr_b16 v[64:65], v119 offset:20480
    ds_read_b64_tr_b16 v[66:67], v119 offset:22528
    s_waitcnt lgkmcnt(12)
    v_mov_b32 v11, v51
    ds_write_b128 v12, v[36:39] offset:16384
    ds_write_b128 v12, v[40:43] offset:17408
    ds_write_b128 v12, v[44:47] offset:18432
    ds_write_b128 v12, v[48:51] offset:19456
    s_waitcnt lgkmcnt(4)
    v_mov_b32 v11, v67
    ds_write_b128 v12, v[52:55] offset:20480
    ds_write_b128 v12, v[56:59] offset:21504
    ds_write_b128 v12, v[60:63] offset:22528
    ds_write_b128 v12, v[64:67] offset:23552
    s_waitcnt vmcnt(4)
    v_mov_b32 v96, v104
    s_waitcnt vmcnt(3)
    v_mov_b32 v97, v106
    s_waitcnt vmcnt(2)
    v_mov_b32 v98, v108
    s_waitcnt vmcnt(1)
    v_mov_b32 v99, v110
    v_mov_b32 v100, v105
    v_mov_b32 v101, v107
    v_mov_b32 v102, v109
    v_mov_b32 v103, v111
    s_mov_b32 s80, 0
    s_mov_b32 s94, 0
    s_mov_b32 s82, 2146435072
    s_mov_b32 s83, 2146435072
    s_lshl2_add_u32 s90, s7, s3
    s_lshl_b32 s90, s90, 2
    s_add_u32 s90, s90, 49152
    s_lshl_b32 s70, s95, 2
    s_add_u32 s70, s70, 50304
    s_lshl_b32 s71, s99, 12
    s_add_u32 s71, s71, 90112
    s_mov_b32 s88, 16384
    v_add_u32 v16, s71, v3
L_pb_28:
    s_waitcnt vmcnt(0) lgkmcnt(0)
    s_barrier
    ds_write_b128 v16, v[68:71] offset:0
    ds_write_b128 v16, v[72:75] offset:1024
    ds_write_b128 v16, v[96:99] offset:2048
    ds_write_b128 v16, v[100:103] offset:3072
    ds_read_b128 v[84:87], v8 offset:0
    ds_read_b128 v[88:91], v34 offset:0
    s_waitcnt lgkmcnt(0)
L_pass_52:
    ds_read_b128 v[92:95], v8 offset:2048
    s_waitcnt lgkmcnt(2)
    v_mfma_f32_16x16x32_bf16 v[36:39], a[0:3], v[84:87], v[20:23]
    s_add_u32 s65, s80, 2
    s_and_b32 s65, s65, 3
    s_lshl_b32 s67, s65, 11
    v_mfma_f32_16x16x32_bf16 v[40:43], a[64:67], v[84:87], v[24:27]
    v_add_u32 v14, s67, v12
    ds_read_b128 v[112:115], v14 offset:24576
    v_mfma_f32_16x16x32_bf16 v[44:47], a[128:131], v[84:87], v[28:31]
    ds_read_b128 v[84:87], v34 offset:2048
    v_cvt_pk_bf16_f32 v64, v64, v65
    s_waitcnt lgkmcnt(3)
    v_mfma_f32_16x16x32_bf16 v[36:39], a[4:7], v[88:91], v[36:39]
    v_cvt_pk_bf16_f32 v65, v66, v67
    ds_read_b128 v[116:119], v14 offset:25600
    v_mfma_f32_16x16x32_bf16 v[40:43], a[68:71], v[88:91], v[40:43]
    v_cvt_pk_bf16_f32 v66, v80, v81
    v_mfma_f32_16x16x32_bf16 v[44:47], a[132:135], v[88:91], v[44:47]
    s_waitcnt vmcnt(2)
    buffer_store_dword v1, v2, s[20:23], s70 offen sc1
    s_add_u32 s70, s70, 128
    ds_read_b128 v[88:91], v8 offset:4096
    v_cvt_pk_bf16_f32 v67, v82, v83
    s_waitcnt lgkmcnt(3)
    v_mfma_f32_16x16x32_bf16 v[112:115], a[192:195], a[200:203], v[112:115]
    buffer_store_dwordx4 v[64:67], v5, s[44:47], s82 offen offset:384 sc1
    s_waitcnt lgkmcnt(1)
    v_mfma_f32_16x16x32_bf16 v[116:119], a[192:195], a[208:211], v[116:119]
    s_lshl_b32 s67, s65, 10
    s_add_u32 s67, s67, s71
    v_add_u32 v16, s67, v3
    v_mfma_f32_16x16x32_bf16 v[112:115], a[196:199], a[204:207], v[112:115]
    ds_read_b128 v[96:99], v34 offset:4096
    v_mfma_f32_16x16x32_bf16 v[116:119], a[196:199], a[212:215], v[116:119]
    ds_read_b128 v[48:51], v16
    v_mfma_f32_16x16x32_bf16 v[112:115], a[192:195], a[216:219], v[112:115]
    s_add_u32 s88, s88, 16384
    s_cmp_ge_u32 s88, 49152
    s_cselect_b32 s88, 0, s88
    v_mfma_f32_16x16x32_bf16 v[116:119], a[192:195], a[224:227], v[116:119]
    ds_read_b128 v[100:103], v8 offset:6144
    v_mfma_f32_16x16x32_bf16 v[112:115], a[196:199], a[220:223], v[112:115]
    s_lshl_b32 s89, s65, 10
    s_cmp_lt_u32 s80, 6
    s_cselect_b32 s89, 2146435072, s89
    v_mfma_f32_16x16x32_bf16 v[116:119], a[196:199], a[228:231], v[116:119]
    s_nop 2
    v_mfma_f32_16x16x32_bf16 v[36:39], a[8:11], v[92:95], v[36:39]
    ds_read_b128 v[104:107], v34 offset:6144
    v_add_f32 v32, v112, v113
    v_mfma_f32_16x16x32_bf16 v[40:43], a[72:75], v[92:95], v[40:43]
    v_mul_f32 v33, v112, v112
    v_fmac_f32 v33, v113, v113
    v_mfma_f32_16x16x32_bf16 v[44:47], a[136:139], v[92:95], v[44:47]
    v_add_f32 v32, v32, v114
    v_fmac_f32 v33, v114, v114
    v_mfma_f32_16x16x32_bf16 v[36:39], a[12:15], v[84:87], v[36:39]
    ds_read_b128 v[92:95], v8 offset:8192
    v_add_f32 v32, v32, v115
    v_mfma_f32_16x16x32_bf16 v[40:43], a[76:79], v[84:87], v[40:43]
    v_fmac_f32 v33, v115, v115
    v_add_f32 v32, v32, v116
    v_mfma_f32_16x16x32_bf16 v[44:47], a[140:143], v[84:87], v[44:47]
    s_waitcnt lgkmcnt(4)
    v_fmac_f32 v33, v116, v116
    v_add_f32 v32, v32, v117
    v_mfma_f32_16x16x32_bf16 v[36:39], a[16:19], v[88:91], v[36:39]
    ds_read_b128 v[84:87], v34 offset:8192
    v_fmac_f32 v33, v117, v117
    v_mfma_f32_16x16x32_bf16 v[40:43], a[80:83], v[88:91], v[40:43]
    v_add_f32 v32, v32, v118
    v_fmac_f32 v33, v118, v118
    v_mfma_f32_16x16x32_bf16 v[44:47], a[144:147], v[88:91], v[44:47]
    v_add_f32 v32, v32, v119
    v_fmac_f32 v33, v119, v119
    v_mfma_f32_16x16x32_bf16 v[36:39], a[20:23], v[96:99], v[36:39]
    ds_read_b128 v[88:91], v8 offset:10240
    v_permlane32_swap_b32 v32, v33
    v_mfma_f32_16x16x32_bf16 v[40:43], a[84:87], v[96:99], v[40:43]
    v_cvt_pk_bf16_f32 v16, v112, v113
    v_add_f32 v32, v32, v33
    v_mfma_f32_16x16x32_bf16 v[44:47], a[148:151], v[96:99], v[44:47]
    s_waitcnt lgkmcnt(3)
    v_cvt_pk_bf16_f32 v17, v114, v115
    v_add_f32_dpp v32, v32, v32 quad_perm:[1,0,3,2] row_mask:0xf bank_mask:0xf
    v_mfma_f32_16x16x32_bf16 v[36:39], a[24:27], v[100:103], v[36:39]
    ds_read_b128 v[96:99], v34 offset:10240
    v_cvt_pk_bf16_f32 v18, v116, v117
    v_mfma_f32_16x16x32_bf16 v[40:43], a[88:91], v[100:103], v[40:43]
    v_add_f32_dpp v32, v32, v32 quad_perm:[2,3,0,1] row_mask:0xf bank_mask:0xf
    v_cvt_pk_bf16_f32 v19, v118, v119
    v_mfma_f32_16x16x32_bf16 v[44:47], a[152:155], v[100:103], v[44:47]
    v_add_f32_dpp v32, v32, v32 row_half_mirror row_mask:0xf bank_mask:0xf
    v_mfma_f32_16x16x32_bf16 v[36:39], a[28:31], v[104:107], v[36:39]
    buffer_store_dwordx2 v[16:17], v35, s[40:43], s89 offen
    ds_read_b128 v[100:103], v8 offset:12288
    v_mfma_f32_16x16x32_bf16 v[40:43], a[92:95], v[104:107], v[40:43]
    v_add_f32_dpp v32, v32, v32 row_mirror row_mask:0xf bank_mask:0xf
    v_mfma_f32_16x16x32_bf16 v[44:47], a[156:159], v[104:107], v[44:47]
    s_waitcnt vmcnt(1)
    buffer_store_dword v1, v2, s[20:23], s83 offen sc1
    s_waitcnt lgkmcnt(3)
    v_mfma_f32_16x16x32_bf16 v[36:39], a[32:35], v[92:95], v[36:39]
    buffer_store_dwordx2 v[18:19], v35, s[40:43], s89 offen offset:512
    ds_read_b128 v[104:107], v34 offset:12288
    s_mov_b32 s86, s82
    v_mfma_f32_16x16x32_bf16 v[40:43], a[96:99], v[92:95], v[40:43]
    s_add_u32 s87, s82, 8192
    v_add_f32_dpp v32, v32, v32 row_bcast:15 row_mask:0xa bank_mask:0xf
    v_mul_f32 v32, 0x3b000000, v32
    v_mfma_f32_16x16x32_bf16 v[44:47], a[160:163], v[92:95], v[44:47]
    s_andn2_b32 s85, s83, 127
    v_readlane_b32 s72, v32, 31
    v_readlane_b32 s73, v32, 63
    v_mfma_f32_16x16x32_bf16 v[36:39], a[36:39], v[84:87], v[36:39]
    ds_read_b128 v[92:95], v8 offset:14336
    s_cmp_ge_u32 s80, 1
    s_cselect_b32 s84, s8, 0
    v_mfma_f32_16x16x32_bf16 v[40:43], a[100:103], v[84:87], v[40:43]
    s_and_b32 s64, s80, 1
    v_mov_b32 v33, s72
    v_fma_f32 v32, -v33, v33, s73
    v_mfma_f32_16x16x32_bf16 v[44:47], a[164:167], v[84:87], v[44:47]
    s_waitcnt lgkmcnt(3)
    s_lshl_b32 s82, s64, 17
    v_max_f32 v32, 0, v32
    v_mfma_f32_16x16x32_bf16 v[36:39], a[40:43], v[88:91], v[36:39]
    ds_read_b128 v[84:87], v34 offset:14336
    s_lshl_b32 s64, s80, 7
    v_mfma_f32_16x16x32_bf16 v[40:43], a[104:107], v[88:91], v[40:43]
    s_add_u32 s83, s64, s90
    v_add_f32 v32, 0x3727c5ac, v32
    v_mfma_f32_16x16x32_bf16 v[44:47], a[168:171], v[88:91], v[44:47]
    v_rsq_f32 v32, v32
    v_mfma_f32_16x16x32_bf16 v[36:39], a[44:47], v[96:99], v[36:39]
    v_mul_f32_e64 v33, -v33, v32
    v_lshlrev_b32 v16, 16, v48
    v_mfma_f32_16x16x32_bf16 v[40:43], a[108:111], v[96:99], v[40:43]
    v_and_b32 v17, s62, v48
    v_fma_f32 v18, v112, v32, v33
    v_mfma_f32_16x16x32_bf16 v[44:47], a[172:175], v[96:99], v[44:47]
    s_waitcnt lgkmcnt(2)
    v_fma_f32 v19, v113, v32, v33
    v_fmac_f32 v112, v18, v16
    v_mfma_f32_16x16x32_bf16 v[36:39], a[48:51], v[100:103], v[36:39]
    v_fmac_f32 v113, v19, v17
    v_lshlrev_b32 v16, 16, v49
    v_mfma_f32_16x16x32_bf16 v[40:43], a[112:115], v[100:103], v[40:43]
    ds_read_b128 v[96:99], v12 offset:0
    v_and_b32 v17, s62, v49
    v_mfma_f32_16x16x32_bf16 v[44:47], a[176:179], v[100:103], v[44:47]
    ds_read_b128 v[100:103], v12 offset:1024
    v_fma_f32 v18, v114, v32, v33
    v_mfma_f32_16x16x32_bf16 v[36:39], a[52:55], v[104:107], v[36:39]
    ds_read_b128 v[88:91], v12 offset:2048
    v_fma_f32 v19, v115, v32, v33
    v_mfma_f32_16x16x32_bf16 v[40:43], a[116:119], v[104:107], v[40:43]
    ds_read_b128 v[108:111], v12 offset:3072
    v_fmac_f32 v114, v18, v16
    v_mfma_f32_16x16x32_bf16 v[44:47], a[180:183], v[104:107], v[44:47]
    ds_read_b128 v[104:107], v12 offset:12288
    s_waitcnt lgkmcnt(5)
    v_mfma_f32_16x16x32_bf16 v[36:39], a[56:59], v[92:95], v[36:39]
    v_fmac_f32 v115, v19, v17
    v_lshlrev_b32 v16, 16, v50
    v_mfma_f32_16x16x32_bf16 v[40:43], a[120:123], v[92:95], v[40:43]
    v_and_b32 v17, s62, v50
    v_fma_f32 v18, v116, v32, v33
    v_mfma_f32_16x16x32_bf16 v[44:47], a[184:187], v[92:95], v[44:47]
    ds_read_b128 v[92:95], v12 offset:13312
    v_fma_f32 v19, v117, v32, v33
    v_mfma_f32_16x16x32_bf16 v[36:39], a[60:63], v[84:87], v[36:39]
    v_fmac_f32 v116, v18, v16
    v_fmac_f32 v117, v19, v17
    v_mfma_f32_16x16x32_bf16 v[40:43], a[124:127], v[84:87], v[40:43]
    buffer_load_dword v11, v6, s[20:23], s85 offen offset:0 sc1
    v_lshlrev_b32 v16, 16, v51
    v_and_b32 v17, s62, v51
    v_mfma_f32_16x16x32_bf16 v[44:47], a[188:191], v[84:87], v[44:47]
    v_fma_f32 v18, v118, v32, v33
    v_fma_f32 v19, v119, v32, v33
    v_fmac_f32 v118, v18, v16
    v_fmac_f32 v119, v19, v17
    v_add_f32 v32, v112, v113
    v_mul_f32 v33, v112, v112
    v_fmac_f32 v33, v113, v113
    v_add_f32 v32, v32, v114
    v_mul_f32_e64 v36, v36, |v36|
    v_mul_f32_e64 v37, v37, |v37|
    v_mul_f32_e64 v38, v38, |v38|
    v_mul_f32_e64 v39, v39, |v39|
    v_cvt_pk_bf16_f32 v36, v36, v37
    v_cvt_pk_bf16_f32 v37, v38, v39
    v_pk_max_i16 v36, v36, 0
    v_pk_max_i16 v37, v37, 0
    v_mul_f32_e64 v40, v40, |v40|
    v_mul_f32_e64 v41, v41, |v41|
    v_mul_f32_e64 v42, v42, |v42|
    v_mul_f32_e64 v43, v43, |v43|
    v_cvt_pk_bf16_f32 v38, v40, v41
    v_cvt_pk_bf16_f32 v39, v42, v43
    v_pk_max_i16 v38, v38, 0
    v_pk_max_i16 v39, v39, 0
    ds_write_b128 v4, v[36:39]
    v_mul_f32_e64 v44, v44, |v44|
    v_mul_f32_e64 v45, v45, |v45|
    v_mul_f32_e64 v46, v46, |v46|
    v_mul_f32_e64 v47, v47, |v47|
    v_cvt_pk_bf16_f32 v44, v44, v45
    v_cvt_pk_bf16_f32 v45, v46, v47
    v_pk_max_i16 v44, v44, 0
    v_pk_max_i16 v45, v45, 0
    ds_write_b64 v13, v[44:45]
    v_fmac_f32 v33, v114, v114
    v_add_f32 v32, v32, v115
    v_fmac_f32 v33, v115, v115
    v_add_f32 v32, v32, v116
    v_fmac_f32 v33, v116, v116
    v_add_f32 v32, v32, v117
    v_fmac_f32 v33, v117, v117
    v_add_f32 v32, v32, v118
    v_fmac_f32 v33, v118, v118
    v_add_f32 v32, v32, v119
    ds_read_b128 v[84:87], v12 offset:14336
    s_waitcnt lgkmcnt(7)
    v_mfma_f32_16x16x32_bf16 v[52:55], v[96:99], v[36:39], 0
    ds_read_b128 v[40:43], v12 offset:15360
    v_fmac_f32 v33, v119, v119
    v_mfma_f32_16x16x32_bf16 v[56:59], v[100:103], v[36:39], 0
    s_waitcnt lgkmcnt(2)
    s_barrier
    ds_read_b128 v[100:103], v3 offset:57344
    v_mfma_f32_16x16x32_bf16 v[60:63], v[88:91], v[36:39], 0
    ds_read_b128 v[44:47], v3 offset:58368
    v_permlane32_swap_b32 v32, v33
    v_mfma_f32_16x16x32_bf16 v[64:67], v[108:111], v[36:39], 0
    ds_read_b128 v[96:99], v10 offset:0
    v_add_f32 v32, v32, v33
    v_mfma_f32_16x16x32_bf16 v[68:71], v[104:107], v[36:39], 0
    ds_read_b128 v[108:111], v3 offset:59392
    v_add_f32_dpp v32, v32, v32 quad_perm:[1,0,3,2] row_mask:0xf bank_mask:0xf
    v_mfma_f32_16x16x32_bf16 v[72:75], v[92:95], v[36:39], 0
    ds_read_b128 v[104:107], v3 offset:62464
    s_waitcnt lgkmcnt(5)
    v_mfma_f32_16x16x32_bf16 v[76:79], v[84:87], v[36:39], 0
    v_add_f32_dpp v32, v32, v32 quad_perm:[2,3,0,1] row_mask:0xf bank_mask:0xf
    v_mfma_f32_16x16x32_bf16 v[80:83], v[40:43], v[36:39], 0
    ds_read_b128 v[40:43], v12 offset:8192
    s_waitcnt lgkmcnt(5)
    v_mfma_f32_16x16x32_bf16 v[52:55], v[128:131], v[100:103], v[52:55]
    ds_read_b128 v[36:39], v12 offset:20480
    v_add_f32_dpp v32, v32, v32 row_half_mirror row_mask:0xf bank_mask:0xf
    v_mfma_f32_16x16x32_bf16 v[56:59], v[132:135], v[100:103], v[56:59]
    s_nop 0
    v_add_f32_dpp v32, v32, v32 row_mirror row_mask:0xf bank_mask:0xf
    v_mfma_f32_16x16x32_bf16 v[60:63], v[136:139], v[100:103], v[60:63]
    s_nop 0
    v_add_f32_dpp v32, v32, v32 row_bcast:15 row_mask:0xa bank_mask:0xf
    v_mul_f32 v32, 0x3b000000, v32
    v_mfma_f32_16x16x32_bf16 v[64:67], v[140:143], v[100:103], v[64:67]
    ds_read_b128 v[84:87], v12 offset:4096
    v_readlane_b32 s72, v32, 31
    v_mfma_f32_16x16x32_bf16 v[68:71], v[144:147], v[100:103], v[68:71]
    ds_read_b128 v[92:95], v12 offset:16384
    v_readlane_b32 s73, v32, 63
    v_mfma_f32_16x16x32_bf16 v[72:75], v[148:151], v[100:103], v[72:75]
    s_waitcnt vmcnt(0)
    v_cmp_ne_u32 vcc, s84, v11
    s_nop 0
    s_cbranch_vccnz L_ops_53
L_opb_54:
    v_mfma_f32_16x16x32_bf16 v[76:79], v[152:155], v[100:103], v[76:79]
    buffer_load_dwordx4 a[200:203], v7, s[44:47], s86 offen offset:0 sc1
    v_mov_b32 v33, s72
    v_fma_f32 v32, -v33, v33, s73
    v_mfma_f32_16x16x32_bf16 v[80:83], v[156:159], v[100:103], v[80:83]
    buffer_load_dwordx4 a[204:207], v7, s[44:47], s86 offen offset:512 sc1
    ds_read_b128 v[100:103], v3 offset:60416
    s_waitcnt lgkmcnt(8)
    v_mfma_f32_16x16x32_bf16 v[52:55], v[160:163], v[44:47], v[52:55]
    buffer_load_dwordx4 a[208:211], v7, s[44:47], s86 offen offset:1024 sc1
    v_xor_b32 v8, 0x4000, v8
    v_max_f32 v32, 0, v32
    v_mfma_f32_16x16x32_bf16 v[68:71], v[176:179], v[44:47], v[68:71]
    buffer_load_dwordx4 a[212:215], v7, s[44:47], s86 offen offset:1536 sc1
    ds_read_b128 v[88:91], v12 offset:9216
    s_waitcnt lgkmcnt(4)
    v_mfma_f32_16x16x32_bf16 v[52:55], v[40:43], v[96:99], v[52:55]
    buffer_load_dwordx4 a[216:219], v7, s[44:47], s87 offen offset:0 sc1
    ds_read_b128 v[40:43], v12 offset:21504
    v_mfma_f32_16x16x32_bf16 v[68:71], v[36:39], v[96:99], v[68:71]
    buffer_load_dwordx4 a[220:223], v7, s[44:47], s87 offen offset:512 sc1
    v_add_f32 v32, 0x3727c5ac, v32
    v_mfma_f32_16x16x32_bf16 v[52:55], v[192:195], v[108:111], v[52:55]
    buffer_load_dwordx4 a[224:227], v7, s[44:47], s87 offen offset:1024 sc1
    v_xor_b32 v34, 0x4000, v34
    v_mfma_f32_16x16x32_bf16 v[68:71], v[208:211], v[108:111], v[68:71]
    buffer_load_dwordx4 a[228:231], v7, s[44:47], s87 offen offset:1536 sc1
    ds_read_b128 v[36:39], v12 offset:5120
    s_waitcnt lgkmcnt(4)
    v_mfma_f32_16x16x32_bf16 v[52:55], v[84:87], v[104:107], v[52:55]
    ds_read_b128 v[84:87], v12 offset:17408
    v_mfma_f32_16x16x32_bf16 v[68:71], v[92:95], v[104:107], v[68:71]
    v_rsq_f32 v32, v32
    s_waitcnt lgkmcnt(4)
    v_mfma_f32_16x16x32_bf16 v[52:55], v[224:227], v[100:103], v[52:55]
    v_mul_f32_e64 v33, -v33, v32
    v_fma_f32 v16, v112, v32, v33
    v_mfma_f32_16x16x32_bf16 v[68:71], v[240:243], v[100:103], v[68:71]
    v_fma_f32 v17, v113, v32, v33
    v_cvt_pk_bf16_f32 v48, v16, v17
    v_mfma_f32_16x16x32_bf16 v[56:59], v[164:167], v[44:47], v[56:59]
    v_fma_f32 v18, v114, v32, v33
    v_fma_f32 v19, v115, v32, v33
    v_mfma_f32_16x16x32_bf16 v[72:75], v[180:183], v[44:47], v[72:75]
    ds_read_b128 v[92:95], v12 offset:10240
    s_waitcnt lgkmcnt(3)
    v_mfma_f32_16x16x32_bf16 v[56:59], v[88:91], v[96:99], v[56:59]
    ds_read_b128 v[88:91], v12 offset:22528
    v_cvt_pk_bf16_f32 v52, v52, v53
    v_mfma_f32_16x16x32_bf16 v[72:75], v[40:43], v[96:99], v[72:75]
    v_cvt_pk_bf16_f32 v53, v54, v55
    v_cvt_pk_bf16_f32 v49, v18, v19
    v_mfma_f32_16x16x32_bf16 v[56:59], v[196:199], v[108:111], v[56:59]
    v_cvt_pk_bf16_f32 v54, v68, v69
    v_fma_f32 v16, v116, v32, v33
    v_mfma_f32_16x16x32_bf16 v[72:75], v[212:215], v[108:111], v[72:75]
    s_barrier
    ds_read_b128 v[40:43], v12 offset:6144
    s_waitcnt lgkmcnt(3)
    v_cvt_pk_bf16_f32 v55, v70, v71
    v_mfma_f32_16x16x32_bf16 v[56:59], v[36:39], v[104:107], v[56:59]
    buffer_store_dwordx4 v[52:55], v5, s[44:47], s82 offen offset:0 sc1
    ds_read_b128 v[36:39], v12 offset:18432
    v_mfma_f32_16x16x32_bf16 v[72:75], v[84:87], v[104:107], v[72:75]
    v_fma_f32 v17, v117, v32, v33
    v_cvt_pk_bf16_f32 v50, v16, v17
    v_mfma_f32_16x16x32_bf16 v[56:59], v[228:231], v[100:103], v[56:59]
    v_fma_f32 v18, v118, v32, v33
    v_fma_f32 v19, v119, v32, v33
    v_mfma_f32_16x16x32_bf16 v[72:75], v[244:247], v[100:103], v[72:75]
    v_cvt_pk_bf16_f32 v51, v18, v19
    v_mfma_f32_16x16x32_bf16 v[60:63], v[168:171], v[44:47], v[60:63]
    buffer_store_dwordx4 v[48:51], v15, s[20:23], s88 offen sc1
    v_add_f32 v112, v112, v120
    v_mfma_f32_16x16x32_bf16 v[76:79], v[184:187], v[44:47], v[76:79]
    s_waitcnt lgkmcnt(2)
    v_add_f32 v113, v113, v121
    v_add_f32 v114, v114, v122
    v_mfma_f32_16x16x32_bf16 v[60:63], v[92:95], v[96:99], v[60:63]
    ds_read_b128 v[92:95], v12 offset:11264
    v_cvt_pk_bf16_f32 v56, v56, v57
    v_mfma_f32_16x16x32_bf16 v[76:79], v[88:91], v[96:99], v[76:79]
    v_cvt_pk_bf16_f32 v57, v58, v59
    v_add_f32 v115, v115, v123
    v_mfma_f32_16x16x32_bf16 v[60:63], v[200:203], v[108:111], v[60:63]
    v_cvt_pk_bf16_f32 v58, v72, v73
    v_add_f32 v116, v116, v124
    v_mfma_f32_16x16x32_bf16 v[76:79], v[216:219], v[108:111], v[76:79]
    s_waitcnt lgkmcnt(1)
    v_cvt_pk_bf16_f32 v59, v74, v75
    v_add_f32 v117, v117, v125
    v_mfma_f32_16x16x32_bf16 v[60:63], v[40:43], v[104:107], v[60:63]
    buffer_store_dwordx4 v[56:59], v5, s[44:47], s82 offen offset:128 sc1
    ds_read_b128 v[40:43], v12 offset:23552
    v_mfma_f32_16x16x32_bf16 v[76:79], v[36:39], v[104:107], v[76:79]
    ds_read_b128 v[36:39], v12 offset:7168
    v_add_f32 v118, v118, v126
    v_mfma_f32_16x16x32_bf16 v[60:63], v[232:235], v[100:103], v[60:63]
    v_add_f32 v119, v119, v127
    v_mfma_f32_16x16x32_bf16 v[76:79], v[248:251], v[100:103], v[76:79]
    ds_write_b128 v14, v[112:115] offset:24576
    v_mfma_f32_16x16x32_bf16 v[64:67], v[172:175], v[44:47], v[64:67]
    ds_write_b128 v14, v[116:119] offset:25600
    v_mfma_f32_16x16x32_bf16 v[80:83], v[188:191], v[44:47], v[80:83]
    ds_read_b128 v[44:47], v12 offset:19456
    ds_read_b128 v[84:87], v8 offset:0
    s_waitcnt lgkmcnt(5)
    v_mfma_f32_16x16x32_bf16 v[64:67], v[92:95], v[96:99], v[64:67]
    v_cvt_pk_bf16_f32 v60, v60, v61
    v_mfma_f32_16x16x32_bf16 v[80:83], v[40:43], v[96:99], v[80:83]
    ds_read_b128 v[88:91], v34 offset:0
    v_cvt_pk_bf16_f32 v61, v62, v63
    v_mfma_f32_16x16x32_bf16 v[64:67], v[204:207], v[108:111], v[64:67]
    v_cvt_pk_bf16_f32 v62, v76, v77
    v_mfma_f32_16x16x32_bf16 v[80:83], v[220:223], v[108:111], v[80:83]
    s_waitcnt lgkmcnt(2)
    v_cvt_pk_bf16_f32 v63, v78, v79
    v_mfma_f32_16x16x32_bf16 v[64:67], v[36:39], v[104:107], v[64:67]
    buffer_store_dwordx4 v[60:63], v5, s[44:47], s82 offen offset:256 sc1
    v_mfma_f32_16x16x32_bf16 v[80:83], v[44:47], v[104:107], v[80:83]
    v_mfma_f32_16x16x32_bf16 v[64:67], v[236:239], v[100:103], v[64:67]
    v_mfma_f32_16x16x32_bf16 v[80:83], v[252:255], v[100:103], v[80:83]
    s_add_u32 s80, s80, 1
    s_cmp_lt_u32 s80, 8
    s_cbranch_scc1 L_pass_52
    s_nop 3
    v_cvt_pk_bf16_f32 v64, v64, v65
    v_cvt_pk_bf16_f32 v65, v66, v67
    v_cvt_pk_bf16_f32 v66, v80, v81
    v_cvt_pk_bf16_f32 v67, v82, v83
    buffer_store_dwordx4 v[64:67], v5, s[44:47], s82 offen offset:384 sc1
    s_mov_b32 s89, 1048576
    ds_read_b128 v[112:115], v12 offset:28672
    ds_read_b128 v[116:119], v12 offset:29696
    s_waitcnt vmcnt(12) lgkmcnt(1)
    v_mfma_f32_16x16x32_bf16 v[112:115], a[192:195], a[200:203], v[112:115]
    s_waitcnt vmcnt(10) lgkmcnt(0)
    v_mfma_f32_16x16x32_bf16 v[116:119], a[192:195], a[208:211], v[116:119]
    v_mfma_f32_16x16x32_bf16 v[112:115], a[196:199], a[204:207], v[112:115]
    s_waitcnt vmcnt(9)
    v_mfma_f32_16x16x32_bf16 v[116:119], a[196:199], a[212:215], v[116:119]
    s_waitcnt vmcnt(8)
    v_mfma_f32_16x16x32_bf16 v[112:115], a[192:195], a[216:219], v[112:115]
    s_waitcnt vmcnt(6)
    v_mfma_f32_16x16x32_bf16 v[116:119], a[192:195], a[224:227], v[116:119]
    v_mfma_f32_16x16x32_bf16 v[112:115], a[196:199], a[220:223], v[112:115]
    s_waitcnt vmcnt(5)
    v_mfma_f32_16x16x32_bf16 v[116:119], a[196:199], a[228:231], v[116:119]
    s_nop 5
    v_cvt_pk_bf16_f32 v16, v112, v113
    v_cvt_pk_bf16_f32 v17, v114, v115
    v_cvt_pk_bf16_f32 v18, v116, v117
    v_cvt_pk_bf16_f32 v19, v118, v119
    buffer_store_dwordx2 v[16:17], v35, s[40:43], s89 offen
    buffer_store_dwordx2 v[18:19], v35, s[40:43], s89 offen offset:512
    s_waitcnt vmcnt(2)
    buffer_store_dword v1, v2, s[20:23], s83 offen sc1
    s_mov_b32 s89, 1049600
    ds_read_b128 v[112:115], v12 offset:30720
    ds_read_b128 v[116:119], v12 offset:31744
    s_mov_b32 s86, 131072
    s_mov_b32 s87, 139264
    s_mov_b32 s64, 50048
    s_mov_b32 s10, 400000
L_poll_55:
    buffer_load_dword v11, v6, s[20:23], s64 offen offset:0 sc1
    s_waitcnt vmcnt(0)
    v_cmp_ne_u32 vcc, s8, v11
    s_nop 0
    s_cbranch_vccz L_polld_56
    s_sleep 2
    s_sub_u32 s10, s10, 1
    s_cmp_lg_u32 s10, 0
    s_cbranch_scc1 L_poll_55
L_polld_56:
    buffer_load_dwordx4 a[200:203], v7, s[44:47], s86 offen offset:0 sc1
    buffer_load_dwordx4 a[204:207], v7, s[44:47], s86 offen offset:512 sc1
    buffer_load_dwordx4 a[208:211], v7, s[44:47], s86 offen offset:1024 sc1
    buffer_load_dwordx4 a[212:215], v7, s[44:47], s86 offen offset:1536 sc1
    buffer_load_dwordx4 a[216:219], v7, s[44:47], s87 offen offset:0 sc1
    buffer_load_dwordx4 a[220:223], v7, s[44:47], s87 offen offset:512 sc1
    buffer_load_dwordx4 a[224:227], v7, s[44:47], s87 offen offset:1024 sc1
    buffer_load_dwordx4 a[228:231], v7, s[44:47], s87 offen offset:1536 sc1
    s_waitcnt vmcnt(7) lgkmcnt(1)
    v_mfma_f32_16x16x32_bf16 v[112:115], a[192:195], a[200:203], v[112:115]
    s_waitcnt vmcnt(5) lgkmcnt(0)
    v_mfma_f32_16x16x32_bf16 v[116:119], a[192:195], a[208:211], v[116:119]
    v_mfma_f32_16x16x32_bf16 v[112:115], a[196:199], a[204:207], v[112:115]
    s_waitcnt vmcnt(4)
    v_mfma_f32_16x16x32_bf16 v[116:119], a[196:199], a[212:215], v[116:119]
    s_waitcnt vmcnt(3)
    v_mfma_f32_16x16x32_bf16 v[112:115], a[192:195], a[216:219], v[112:115]
    s_waitcnt vmcnt(1)
    v_mfma_f32_16x16x32_bf16 v[116:119], a[192:195], a[224:227], v[116:119]
    v_mfma_f32_16x16x32_bf16 v[112:115], a[196:199], a[220:223], v[112:115]
    s_waitcnt vmcnt(0)
    v_mfma_f32_16x16x32_bf16 v[116:119], a[196:199], a[228:231], v[116:119]
    s_nop 5
    v_cvt_pk_bf16_f32 v16, v112, v113
    v_cvt_pk_bf16_f32 v17, v114, v115
    v_cvt_pk_bf16_f32 v18, v116, v117
    v_cvt_pk_bf16_f32 v19, v118, v119
    buffer_store_dwordx2 v[16:17], v35, s[40:43], s89 offen
    buffer_store_dwordx2 v[18:19], v35, s[40:43], s89 offen offset:512
    s_waitcnt vmcnt(0)
    s_endpgm
L_pe_29:
L_ops_53:
    s_add_u32 s94, s94, 1
    s_mov_b32 s10, 400000
L_ops_53_l:
    buffer_load_dword v11, v6, s[20:23], s85 offen offset:0 sc1
    s_waitcnt vmcnt(0)
    v_cmp_ne_u32 vcc, s84, v11
    s_nop 1
    s_cbranch_vccz L_opb_54
    s_sub_u32 s10, s10, 1
    s_cmp_lg_u32 s10, 0
    s_cbranch_scc1 L_ops_53_l
    s_branch L_opb_54
L_end:
    s_endpgm
.section .rodata,"a"
.p2align 6
.amdhsa_kernel interleave_layers__ssm_conv_h3__dense_activation_squared_relu__prompt_kernel
  .amdhsa_next_free_vgpr 512
  .amdhsa_next_free_sgpr 102
  .amdhsa_accum_offset 256
  .amdhsa_group_segment_fixed_size 0
  .amdhsa_kernarg_size 112
  .amdhsa_user_sgpr_count 2
  .amdhsa_user_sgpr_kernarg_segment_ptr 1
  .amdhsa_system_sgpr_workgroup_id_x 1
.end_amdhsa_kernel
```
